```python
import torch

def _softmax(x, axis=-1):
    return torch.softmax(x, dim=axis)
def _gelu(x):
    return torch.nn.functional.gelu(x, approximate="tanh")
def _silu(x):
    return torch.nn.functional.silu(x)
def _sigmoid(x):
    return torch.sigmoid(x)
def _layernorm(x, axis=-1, eps=1e-5):
    m = x.mean(dim=axis, keepdim=True)
    v = x.var(dim=axis, keepdim=True, unbiased=False)
    return (x - m) / torch.sqrt(v + eps)
def _scatter_add(tgt, idx, src, axis=0):
    return tgt.clone().index_add_(axis, idx, src)
def _segment_sum(src, seg, n):
    out = torch.zeros((n,) + src.shape[1:], dtype=src.dtype)
    return out.index_add_(0, seg, src)
def _pad(x, pw):
    flat = tuple(v for pair in reversed(pw) for v in pair)
    return torch.nn.functional.pad(x, flat)

kernel_name = 'concat_heads__mha_block_cached__gqa_block_cached__near_ridge'

def setup_inputs():

    _w = (lambda a: (lambda t: t.to(torch.bfloat16) if t.is_floating_point() else t)(torch.as_tensor(a)))
    def _A_setup():
        B, Sq, D = 8, 112, 1024
        H, Sk, Dh = 32, 512, 128
        return {
            "x": _w((lambda *s: torch.randn(*s, dtype=torch.bfloat16) * 0.8)(B, Sq, D)),
            "k_cache": _w((lambda *s: torch.randn(*s, dtype=torch.bfloat16) * 0.8)(B, H, Sk, Dh)),
            "v_cache": _w((lambda *s: torch.randn(*s, dtype=torch.bfloat16) * 0.05)(B, H, Sk, Dh)),
            "wq": _w((lambda *s: torch.randn(*s, dtype=torch.bfloat16) * 0.8)(D, H * Dh) * (D ** -0.5)),
            "wo": _w((lambda *s: torch.randn(*s, dtype=torch.bfloat16) * 0.05)(H * Dh, D) * ((H * Dh) ** -0.5)),
        }
    _A_in = _A_setup()

    def _B_setup():
        B, Sq, D = 8, 112, 1024
        Hq, Hkv, Sk, Dh = 32, 32, 512, 128
        assert Hq % Hkv == 0, (Hq, Hkv)
        return {
            "x": _w((lambda *s: torch.randn(*s, dtype=torch.bfloat16) * 0.8)(B, Sq, D)),
            "k_cache": _w((lambda *s: torch.randn(*s, dtype=torch.bfloat16) * 0.8)(B, Hkv, Sk, Dh)),
            "v_cache": _w((lambda *s: torch.randn(*s, dtype=torch.bfloat16) * 0.05)(B, Hkv, Sk, Dh)),
            "wq": _w((lambda *s: torch.randn(*s, dtype=torch.bfloat16) * 0.8)(D, Hq * Dh) * (D ** -0.5)),
            "wo": _w((lambda *s: torch.randn(*s, dtype=torch.bfloat16) * 0.05)(Hq * Dh, D) * ((Hq * Dh) ** -0.5)),
        }
    _B_in = _B_setup()

    return {
        "A_x": _A_in["x"],
        "A_k_cache": _A_in["k_cache"],
        "A_v_cache": _A_in["v_cache"],
        "A_wq": _A_in["wq"],
        "A_wo": _A_in["wo"],
        "B_x": _B_in["x"],
        "B_k_cache": _B_in["k_cache"],
        "B_v_cache": _B_in["v_cache"],
        "B_wq": _B_in["wq"],
        "B_wo": _B_in["wo"],
    }

def reference(A_x, A_k_cache, A_v_cache, A_wq, A_wo, B_x, B_k_cache, B_v_cache, B_wq, B_wo):
    def _A_ref(x, k_cache, v_cache, wq, wo):
        B, Sq, D = x.shape
        H, Dh = 32, 128
        q = (lambda x, *d: x.permute(*d))((x @ wq).reshape(B, Sq, H, Dh), 0, 2, 1, 3)
        scores = torch.einsum("bhqd,bhkd->bhqk", q, k_cache) * (Dh ** -0.5)
        p = _softmax(scores, axis=-1)
        o = torch.einsum("bhqk,bhkd->bhqd", p, v_cache)
        return (lambda x, *d: x.permute(*d))(o, 0, 2, 1, 3).reshape(B, Sq, H * Dh) @ wo

    def _B_ref(x, k_cache, v_cache, wq, wo):
        B, Sq, D = x.shape
        Hq, Dh = 32, 128
        Hkv = k_cache.shape[1]
        rep = Hq // Hkv
        q = (lambda x, *d: x.permute(*d))((x @ wq).reshape(B, Sq, Hq, Dh), 0, 2, 1, 3)
        k = (lambda x, n, axis: torch.repeat_interleave(x, n, dim=axis))(k_cache, rep, axis=1)
        v = (lambda x, n, axis: torch.repeat_interleave(x, n, dim=axis))(v_cache, rep, axis=1)
        scores = torch.einsum("bhqd,bhkd->bhqk", q, k) * (Dh ** -0.5)
        p = _softmax(scores, axis=-1)
        o = torch.einsum("bhqk,bhkd->bhqd", p, v)
        return (lambda x, *d: x.permute(*d))(o, 0, 2, 1, 3).reshape(B, Sq, Hq * Dh) @ wo

    a = _A_ref(A_x, A_k_cache, A_v_cache, A_wq, A_wo)
    b = _B_ref(B_x, B_k_cache, B_v_cache, B_wq, B_wo)
    return torch.concatenate([a, b], axis=-1)
```

```asm
; @launch grid=(256,1,1) block=(256,1,1) lds=163840
.amdgcn_target "amdgcn-amd-amdhsa--gfx950"
.text
.globl concat_heads__mha_block_cached__gqa_block_cached__near_ridge_kernel
.p2align 8
.type concat_heads__mha_block_cached__gqa_block_cached__near_ridge_kernel,@function
concat_heads__mha_block_cached__gqa_block_cached__near_ridge_kernel:
 s_cmp_ge_u32 s2, 256
 s_cbranch_scc1 L_end
 s_load_dwordx16 s[64:79], s[0:1], 0
 s_load_dwordx8 s[80:87], s[0:1], 64
 s_load_dwordx2 s[88:89], s[0:1], 96
 s_getpc_b64 s[38:39]
 s_and_b32 s38, s38, 0xffffff00
 s_lshr_b32 s52, s2, 3
 s_mul_i32 s52, s52, 1792
 v_lshlrev_b32 v185, 6, v0
 v_min_u32 v185, 1728, v185
 v_add_u32 v185, s52, v185
 v_min_u32 v185, 55296, v185
 global_load_dword v191, v185, s[38:39]
 v_and_b32 v184, 63, v0
 v_lshrrev_b32 v185, 6, v0
 s_nop 0
 v_readfirstlane_b32 s30, v185
 s_and_b32 s49, s2, 3
 s_bfe_u32 s48, s2, 0x10002
 s_bfe_u32 s50, s2, 0x30003
 s_lshr_b32 s51, s2, 6
 s_xor_b32 s37, s50, 1
 s_lshl_b32 s31, s30, 11
 s_mul_i32 s32, s30, 3072
 s_lshl_b32 s33, s30, 12
 v_lshrrev_b32 v185, 4, v184
 v_bfe_u32 v186, v184, 1, 3
 v_and_b32 v187, 1, v184
 v_xor_b32 v186, v186, v185
 v_lshl_add_u32 v186, v186, 1, v187
 v_lshlrev_b32 v186, 4, v186
 v_lshl_add_u32 v186, v185, 13, v186
 v_xor_b32 v187, 128, v186
 s_mul_i32 s54, s30, 131072
 v_add_u32 v199, s54, v186
 s_add_u32 s54, s54, 31744
 v_add_u32 v200, s54, v186
 s_add_u32 s54, s54, 31744
 v_add_u32 v201, s54, v187
 s_add_u32 s54, s54, 31744
 v_add_u32 v202, s54, v187
 s_lshr_b32 s52, s30, 1
 s_and_b32 s53, s30, 1
 v_lshrrev_b32 v186, 3, v184
 v_and_b32 v187, 7, v184
 v_xor_b32 v187, v187, v185
 v_lshlrev_b32 v187, 4, v187
 v_lshl_add_u32 v186, v186, 11, v187
 v_xor_b32 v187, 64, v186
 s_cmp_eq_u32 s53, 0
 s_cselect_b64 vcc, -1, 0
 v_cndmask_b32 v188, v187, v186, vcc
 v_xor_b32 v185, 64, v188
 s_mul_i32 s54, s52, 229376
 s_mul_i32 s55, s53, 49152
 s_add_u32 s55, s55, s54
 v_add_u32 v192, s55, v188
 s_add_u32 s55, s55, 15360
 v_add_u32 v193, s55, v185
 s_add_u32 s55, s55, 15360
 v_add_u32 v194, s55, v188
 s_mul_i32 s55, s53, 65536
 s_add_u32 s55, s55, s54
 s_add_u32 s55, s55, 98304
 v_add_u32 v195, s55, v186
 s_add_u32 s55, s55, 15360
 v_add_u32 v196, s55, v187
 s_add_u32 s55, s55, 15360
 v_add_u32 v197, s55, v186
 s_add_u32 s55, s55, 15360
 v_add_u32 v198, s55, v187
 s_mov_b32 s52, s50
 s_mov_b32 s53, s51
 s_add_u32 s52, s53, s52
 s_and_b32 s53, s2, 3
 s_add_u32 s52, s52, s53
 s_and_b32 s52, s52, 3
 s_lshl_b32 s52, s52, 2
 s_lshr_b32 s54, 0x32103210, s52
 s_and_b32 s54, s54, 0xffff
 s_mul_i32 s54, s54, 0x10001
 s_lshl_b32 s53, s53, 2
 s_mov_b32 s4, 0x44440000
 s_mov_b32 s5, 0xcccc8888
 s_lshr_b64 s[4:5], s[4:5], s53
 s_or_b32 s4, s4, s54
 s_or_b32 s5, s5, s54
 s_waitcnt lgkmcnt(0)
 s_cmp_eq_u32 s48, 0
 s_cselect_b64 s[64:65], s[64:65], s[74:75]
 s_cselect_b64 s[66:67], s[66:67], s[76:77]
 s_cselect_b64 s[68:69], s[68:69], s[78:79]
 s_cselect_b64 s[70:71], s[70:71], s[80:81]
 s_cselect_b64 s[72:73], s[72:73], s[82:83]
 s_mul_i32 s52, s51, 458752
 s_add_u32 s8, s64, s52
 s_addc_u32 s9, s65, 0
 s_mov_b32 s10, 458752
 s_mov_b32 s11, 0x20000
 s_lshl_b32 s53, s49, 3
 s_add_u32 s53, s53, s50
 s_lshl_b32 s52, s53, 8
 s_add_u32 s12, s70, s52
 s_addc_u32 s13, s71, 0
 s_mov_b32 s14, 8380672
 s_mov_b32 s15, 0x20000
 s_add_u32 m0, s33, 131072
 s_bfe_u32 s29, s4, 262144
 s_lshl_b32 s29, s29, 19
 buffer_load_dwordx4 v199, s[12:15], s29 offen lds
 buffer_load_dwordx4 v200, s[12:15], s29 offen offset:1024 lds
 buffer_load_dwordx4 v201, s[12:15], s29 offen offset:2048 lds
 buffer_load_dwordx4 v202, s[12:15], s29 offen offset:3072 lds
 s_add_u32 m0, s32, 73728
 s_bfe_u32 s28, s4, 262144
 s_lshl_b32 s28, s28, 7
 buffer_load_dwordx4 v192, s[8:11], s28 offen lds
 buffer_load_dwordx4 v193, s[8:11], s28 offen offset:1024 lds
 buffer_load_dwordx4 v194, s[8:11], s28 offen offset:2048 lds
 s_add_u32 m0, s33, 98304
 s_nop 0
 buffer_load_dwordx4 v195, s[8:11], s28 offen lds
 buffer_load_dwordx4 v196, s[8:11], s28 offen offset:1024 lds
 buffer_load_dwordx4 v197, s[8:11], s28 offen offset:2048 lds
 buffer_load_dwordx4 v198, s[8:11], s28 offen offset:3072 lds
 s_add_u32 m0, s33, 147456
 s_bfe_u32 s29, s4, 262148
 s_lshl_b32 s29, s29, 19
 buffer_load_dwordx4 v199, s[12:15], s29 offen lds
 buffer_load_dwordx4 v200, s[12:15], s29 offen offset:1024 lds
 buffer_load_dwordx4 v201, s[12:15], s29 offen offset:2048 lds
 buffer_load_dwordx4 v202, s[12:15], s29 offen offset:3072 lds
 s_add_u32 m0, s32, 86016
 s_bfe_u32 s28, s4, 262148
 s_lshl_b32 s28, s28, 7
 buffer_load_dwordx4 v192, s[8:11], s28 offen lds
 buffer_load_dwordx4 v193, s[8:11], s28 offen offset:1024 lds
 buffer_load_dwordx4 v194, s[8:11], s28 offen offset:2048 lds
 s_add_u32 m0, s33, 114688
 s_nop 0
 buffer_load_dwordx4 v195, s[8:11], s28 offen lds
 buffer_load_dwordx4 v196, s[8:11], s28 offen offset:1024 lds
 buffer_load_dwordx4 v197, s[8:11], s28 offen offset:2048 lds
 buffer_load_dwordx4 v198, s[8:11], s28 offen offset:3072 lds
 s_lshl_b32 s52, s51, 6
 s_add_u32 s52, s52, s53
 s_lshl_b32 s52, s52, 17
 s_add_u32 s16, s66, s52
 s_addc_u32 s17, s67, 0
 s_mov_b32 s18, 4325376
 s_mov_b32 s19, 0x20000
 s_add_u32 s20, s68, s52
 s_addc_u32 s21, s69, 0
 s_mov_b32 s22, 4325376
 s_mov_b32 s23, 0x20000
 s_cmp_lg_u32 s2, 0
 s_cbranch_scc1 L_noclear
 s_mov_b32 s52, 67108864
 s_add_u32 s92, s88, s52
 s_addc_u32 s93, s89, 0
 s_mov_b32 s94, 12288
 s_mov_b32 s95, 0x20000
 v_lshlrev_b32 v185, 4, v184
 v_add_u32 v185, s32, v185
 v_mov_b32 v244, 0
 v_mov_b32 v245, 0
 v_mov_b32 v246, 0
 v_mov_b32 v247, 0
 buffer_store_dwordx4 v[244:247], v185, s[92:95], 0 offen offset:0 sc1
 buffer_store_dwordx4 v[244:247], v185, s[92:95], 0 offen offset:1024 sc1
 buffer_store_dwordx4 v[244:247], v185, s[92:95], 0 offen offset:2048 sc1
 s_nop 1
L_noclear:
 s_mov_b32 s92, s86
 s_mov_b32 s93, s87
 s_mov_b32 s94, 4
 s_mov_b32 s95, 0x20000
 s_lshl_b32 s52, s48, 2
 s_add_u32 s52, s52, s51
 s_lshl_b32 s52, s52, 3
 s_add_u32 s52, s52, s37
 s_mul_i32 s52, s52, 172032
 s_add_u32 s52, s52, 16777216
 s_add_u32 s44, s88, s52
 s_addc_u32 s45, s89, 0
 s_mov_b32 s46, 172032
 s_mov_b32 s47, 0x20000
 s_lshr_b32 s52, s30, 1
 s_and_b32 s53, s30, 1
 s_mul_i32 s54, s52, 6144
 s_add_u32 s54, s54, 73728
 s_lshl_b32 s55, s52, 13
 s_add_u32 s55, s55, 98304
 v_lshrrev_b32 v186, 4, v184
 v_and_b32 v185, 15, v184
 v_lshrrev_b32 v187, 1, v185
 v_xor_b32 v187, v187, v186
 v_lshlrev_b32 v187, 4, v187
 v_lshl_add_u32 v187, v185, 7, v187
 v_xor_b32 v188, 64, v187
 v_add_u32 v203, s54, v187
 v_add_u32 v204, s54, v188
 v_add_u32 v205, s55, v187
 v_add_u32 v206, s55, v188
 v_bfe_u32 v186, v184, 2, 2
 v_bfe_u32 v187, v184, 4, 1
 v_lshrrev_b32 v185, 4, v184
 v_lshl_add_u32 v185, v185, 3, v186
 v_lshl_add_u32 v186, v187, 2, v186
 v_and_b32 v187, 3, v184
 v_lshlrev_b32 v187, 3, v187
 v_lshl_add_u32 v187, v185, 8, v187
 v_add_u32 v187, 131072, v187
 s_lshl_b32 s54, s53, 2
 s_add_u32 s54, s54, 0
 v_xor_b32 v188, s54, v186
 v_lshl_add_u32 v207, v188, 5, v187
 s_lshl_b32 s54, s53, 2
 s_add_u32 s54, s54, 1
 v_xor_b32 v188, s54, v186
 v_lshl_add_u32 v208, v188, 5, v187
 s_lshl_b32 s54, s53, 2
 s_add_u32 s54, s54, 2
 v_xor_b32 v188, s54, v186
 v_lshl_add_u32 v209, v188, 5, v187
 s_lshl_b32 s54, s53, 2
 s_add_u32 s54, s54, 3
 v_xor_b32 v188, s54, v186
 v_lshl_add_u32 v210, v188, 5, v187
 v_lshrrev_b32 v185, 4, v184
 v_and_b32 v186, 15, v184
 s_lshl_b32 s52, s30, 3
 v_add_u32 v187, s52, v185
 v_and_b32 v188, 15, v187
 v_xor_b32 v188, v188, v186
 v_lshlrev_b32 v188, 4, v188
 v_lshl_add_u32 v211, v187, 8, v188
 v_xor_b32 v212, 64, v211
 v_lshlrev_b32 v188, 2, v185
 v_xor_b32 v188, v188, v186
 v_lshlrev_b32 v188, 4, v188
 v_lshl_add_u32 v213, v187, 8, v188
 v_and_b32 v187, 31, v184
 v_lshrrev_b32 v188, 5, v184
 v_xor_b32 v188, v188, v186
 v_lshlrev_b32 v188, 4, v188
 v_lshl_add_u32 v220, v187, 8, v188
 v_xor_b32 v221, 32, v220
 v_xor_b32 v222, 64, v220
 v_xor_b32 v223, 96, v220
 v_xor_b32 v224, 128, v220
 v_xor_b32 v225, 160, v220
 v_xor_b32 v226, 192, v220
 v_xor_b32 v227, 224, v220
 v_add_u32 v228, 0x10000, v220
 v_add_u32 v168, 0x20000, v220
 v_add_u32 v229, 0x10000, v221
 v_add_u32 v169, 0x20000, v221
 v_add_u32 v230, 0x10000, v222
 v_add_u32 v170, 0x20000, v222
 v_add_u32 v231, 0x10000, v223
 v_add_u32 v171, 0x20000, v223
 v_add_u32 v232, 0x10000, v224
 v_add_u32 v172, 0x20000, v224
 v_add_u32 v233, 0x10000, v225
 v_add_u32 v173, 0x20000, v225
 v_add_u32 v234, 0x10000, v226
 v_add_u32 v174, 0x20000, v226
 v_add_u32 v235, 0x10000, v227
 v_add_u32 v175, 0x20000, v227
 v_bfe_u32 v185, v184, 2, 2
 v_lshrrev_b32 v186, 5, v184
 v_lshl_add_u32 v186, v186, 2, v185
 v_bfe_u32 v187, v184, 4, 1
 v_lshlrev_b32 v187, 5, v187
 v_lshl_add_u32 v187, v186, 8, v187
 v_and_b32 v188, 3, v184
 v_lshl_add_u32 v187, v188, 3, v187
 v_lshl_add_u32 v236, v185, 6, v187
 v_xor_b32 v237, 64, v236
 v_xor_b32 v238, 128, v236
 v_xor_b32 v239, 192, v236
 v_add_u32 v240, 0x10000, v236
 v_add_u32 v176, 0x20000, v236
 v_add_u32 v241, 0x10000, v237
 v_add_u32 v177, 0x20000, v237
 v_add_u32 v242, 0x10000, v238
 v_add_u32 v178, 0x20000, v238
 v_add_u32 v243, 0x10000, v239
 v_add_u32 v179, 0x20000, v239
 v_lshlrev_b32 v180, 4, v184
 v_add_u32 v180, s31, v180
 v_add_u32 v181, 0x10000, v180
 v_add_u32 v182, 0x20000, v180
 v_bfe_u32 v185, v184, 4, 1
 s_lshl_b32 s52, s30, 1
 v_add_u32 v185, s52, v185
 v_lshrrev_b32 v186, 5, v184
 v_and_b32 v187, 15, v184
 v_lshl_add_u32 v186, v186, 4, v187
 v_lshlrev_b32 v186, 4, v186
 v_lshl_add_u32 v214, v185, 11, v186
 v_cmp_eq_u32 vcc, 7, v185
 v_mov_b32 v186, 0x40000000
 s_nop 0
 v_cndmask_b32 v214, v214, v186, vcc
 s_mov_b32 s56, 0
 s_mov_b32 s57, 28672
 s_mov_b32 s58, 14336
 s_mov_b32 s59, 43008
 s_lshr_b32 s52, s30, 1
 s_and_b32 s53, s30, 1
 s_mul_i32 s52, s52, 28672
 s_add_u32 s52, s52, 73728
 v_and_b32 v185, 15, v184
 v_lshrrev_b32 v186, 5, v184
 v_bfe_u32 v187, v184, 4, 1
 v_lshlrev_b32 v187, 3, v187
 v_lshl_add_u32 v187, v185, 8, v187
 v_add_u32 v187, s52, v187
 s_lshl_b32 s53, s53, 3
 v_add_u32 v186, s53, v186
 v_xor_b32 v186, v186, v185
 v_xor_b32 v188, 0, v186
 v_lshl_add_u32 v244, v188, 4, v187
 v_xor_b32 v188, 2, v186
 v_lshl_add_u32 v245, v188, 4, v187
 v_xor_b32 v188, 4, v186
 v_lshl_add_u32 v246, v188, 4, v187
 v_xor_b32 v188, 6, v186
 v_lshl_add_u32 v247, v188, 4, v187
 v_mov_b32 v248, 0x3e0293ee
 v_mov_b32 v249, 0x3e0293ee
 v_bfe_u32 v185, v184, 4, 1
 s_lshl_b32 s52, s30, 1
 v_add_u32 v185, s52, v185
 s_lshl_b32 s52, s30, 13
 s_add_u32 s52, s52, 73728
 v_mov_b32 v186, s52
 v_subrev_u32 v187, 4096, v186
 v_cmp_eq_u32 vcc, 7, v185
 s_nop 1
 v_cndmask_b32 v250, v186, v187, vcc
 s_waitcnt vmcnt(15)
 s_barrier
 ds_read_b64_tr_b16 a[0:1], v207 offset:0
 ds_read_b64_tr_b16 a[2:3], v207 offset:1024
 ds_read_b64_tr_b16 a[4:5], v208 offset:0
 ds_read_b64_tr_b16 a[6:7], v208 offset:1024
 ds_read_b64_tr_b16 a[8:9], v209 offset:0
 ds_read_b64_tr_b16 a[10:11], v209 offset:1024
 ds_read_b64_tr_b16 a[12:13], v210 offset:0
 ds_read_b64_tr_b16 a[14:15], v210 offset:1024
 ds_read_b64_tr_b16 a[16:17], v207 offset:8192
 ds_read_b64_tr_b16 a[18:19], v207 offset:9216
 ds_read_b64_tr_b16 a[20:21], v208 offset:8192
 ds_read_b64_tr_b16 a[22:23], v208 offset:9216
 ds_read_b64_tr_b16 a[24:25], v209 offset:8192
 ds_read_b64_tr_b16 a[26:27], v209 offset:9216
 ds_read_b64_tr_b16 a[28:29], v210 offset:8192
 ds_read_b64_tr_b16 a[30:31], v210 offset:9216
 ds_read_b128 v[112:115], v203 offset:0
 ds_read_b128 v[116:119], v204 offset:0
 ds_read_b128 v[120:123], v203 offset:2048
 ds_read_b128 v[124:127], v204 offset:2048
 ds_read_b128 v[128:131], v203 offset:4096
 ds_read_b128 v[132:135], v204 offset:4096
 s_waitcnt vmcnt(11) lgkmcnt(0)
 s_barrier
 v_mfma_f32_16x16x32_bf16 v[0:3], a[0:3], v[112:115], 0
 ds_read_b128 v[136:139], v205 offset:0
 s_add_u32 m0, s33, 131072
 v_mfma_f32_16x16x32_bf16 v[0:3], a[16:19], v[116:119], v[0:3]
 s_bfe_u32 s29, s4, 262152
 v_mfma_f32_16x16x32_bf16 v[4:7], a[4:7], v[112:115], 0
 ds_read_b128 v[140:143], v206 offset:0
 s_lshl_b32 s29, s29, 19
 v_mfma_f32_16x16x32_bf16 v[4:7], a[20:23], v[116:119], v[4:7]
 v_mfma_f32_16x16x32_bf16 v[8:11], a[8:11], v[112:115], 0
 ds_read_b128 v[144:147], v205 offset:2048
 buffer_load_dwordx4 v199, s[12:15], s29 offen lds
 v_mfma_f32_16x16x32_bf16 v[8:11], a[24:27], v[116:119], v[8:11]
 v_mfma_f32_16x16x32_bf16 v[12:15], a[12:15], v[112:115], 0
 ds_read_b128 v[148:151], v206 offset:2048
 v_mfma_f32_16x16x32_bf16 v[12:15], a[28:31], v[116:119], v[12:15]
 buffer_load_dwordx4 v200, s[12:15], s29 offen offset:1024 lds
 v_mfma_f32_16x16x32_bf16 v[16:19], a[0:3], v[120:123], 0
 ds_read_b128 v[152:155], v205 offset:4096
 v_mfma_f32_16x16x32_bf16 v[16:19], a[16:19], v[124:127], v[16:19]
 v_mfma_f32_16x16x32_bf16 v[20:23], a[4:7], v[120:123], 0
 ds_read_b128 v[156:159], v206 offset:4096
 buffer_load_dwordx4 v201, s[12:15], s29 offen offset:2048 lds
 v_mfma_f32_16x16x32_bf16 v[20:23], a[20:23], v[124:127], v[20:23]
 v_mfma_f32_16x16x32_bf16 v[24:27], a[8:11], v[120:123], 0
 ds_read_b128 v[160:163], v205 offset:6144
 v_mfma_f32_16x16x32_bf16 v[24:27], a[24:27], v[124:127], v[24:27]
 buffer_load_dwordx4 v202, s[12:15], s29 offen offset:3072 lds
 v_mfma_f32_16x16x32_bf16 v[28:31], a[12:15], v[120:123], 0
 ds_read_b128 v[164:167], v206 offset:6144
 v_mfma_f32_16x16x32_bf16 v[28:31], a[28:31], v[124:127], v[28:31]
 s_add_u32 m0, s32, 73728
 v_mfma_f32_16x16x32_bf16 v[32:35], a[0:3], v[128:131], 0
 s_bfe_u32 s28, s4, 262152
 s_lshl_b32 s28, s28, 7
 v_mfma_f32_16x16x32_bf16 v[32:35], a[16:19], v[132:135], v[32:35]
 v_mfma_f32_16x16x32_bf16 v[36:39], a[4:7], v[128:131], 0
 buffer_load_dwordx4 v192, s[8:11], s28 offen lds
 v_mfma_f32_16x16x32_bf16 v[36:39], a[20:23], v[132:135], v[36:39]
 v_mfma_f32_16x16x32_bf16 v[40:43], a[8:11], v[128:131], 0
 buffer_load_dwordx4 v193, s[8:11], s28 offen offset:1024 lds
 v_mfma_f32_16x16x32_bf16 v[40:43], a[24:27], v[132:135], v[40:43]
 v_mfma_f32_16x16x32_bf16 v[44:47], a[12:15], v[128:131], 0
 buffer_load_dwordx4 v194, s[8:11], s28 offen offset:2048 lds
 v_mfma_f32_16x16x32_bf16 v[44:47], a[28:31], v[132:135], v[44:47]
 s_waitcnt vmcnt(11) lgkmcnt(0)
 s_barrier
 v_mfma_f32_16x16x32_bf16 v[48:51], a[0:3], v[136:139], 0
 ds_read_b64_tr_b16 a[32:33], v207 offset:16384
 v_mfma_f32_16x16x32_bf16 v[48:51], a[16:19], v[140:143], v[48:51]
 ds_read_b64_tr_b16 a[34:35], v207 offset:17408
 v_mfma_f32_16x16x32_bf16 v[52:55], a[4:7], v[136:139], 0
 ds_read_b64_tr_b16 a[36:37], v208 offset:16384
 v_mfma_f32_16x16x32_bf16 v[52:55], a[20:23], v[140:143], v[52:55]
 ds_read_b64_tr_b16 a[38:39], v208 offset:17408
 s_add_u32 m0, s33, 98304
 v_mfma_f32_16x16x32_bf16 v[56:59], a[8:11], v[136:139], 0
 ds_read_b64_tr_b16 a[40:41], v209 offset:16384
 v_mfma_f32_16x16x32_bf16 v[56:59], a[24:27], v[140:143], v[56:59]
 ds_read_b64_tr_b16 a[42:43], v209 offset:17408
 v_mfma_f32_16x16x32_bf16 v[60:63], a[12:15], v[136:139], 0
 v_mfma_f32_16x16x32_bf16 v[60:63], a[28:31], v[140:143], v[60:63]
 ds_read_b64_tr_b16 a[44:45], v210 offset:16384
 v_mfma_f32_16x16x32_bf16 v[64:67], a[0:3], v[144:147], 0
 ds_read_b64_tr_b16 a[46:47], v210 offset:17408
 v_mfma_f32_16x16x32_bf16 v[64:67], a[16:19], v[148:151], v[64:67]
 ds_read_b64_tr_b16 a[48:49], v207 offset:24576
 v_mfma_f32_16x16x32_bf16 v[68:71], a[4:7], v[144:147], 0
 ds_read_b64_tr_b16 a[50:51], v207 offset:25600
 v_mfma_f32_16x16x32_bf16 v[68:71], a[20:23], v[148:151], v[68:71]
 ds_read_b64_tr_b16 a[52:53], v208 offset:24576
 buffer_load_dwordx4 v195, s[8:11], s28 offen lds
 v_mfma_f32_16x16x32_bf16 v[72:75], a[8:11], v[144:147], 0
 v_mfma_f32_16x16x32_bf16 v[72:75], a[24:27], v[148:151], v[72:75]
 ds_read_b64_tr_b16 a[54:55], v208 offset:25600
 v_mfma_f32_16x16x32_bf16 v[76:79], a[12:15], v[144:147], 0
 ds_read_b64_tr_b16 a[56:57], v209 offset:24576
 v_mfma_f32_16x16x32_bf16 v[76:79], a[28:31], v[148:151], v[76:79]
 ds_read_b64_tr_b16 a[58:59], v209 offset:25600
 v_mfma_f32_16x16x32_bf16 v[80:83], a[0:3], v[152:155], 0
 ds_read_b64_tr_b16 a[60:61], v210 offset:24576
 v_mfma_f32_16x16x32_bf16 v[80:83], a[16:19], v[156:159], v[80:83]
 ds_read_b64_tr_b16 a[62:63], v210 offset:25600
 v_mfma_f32_16x16x32_bf16 v[84:87], a[4:7], v[152:155], 0
 ds_read_b128 v[112:115], v203 offset:12288
 v_mfma_f32_16x16x32_bf16 v[84:87], a[20:23], v[156:159], v[84:87]
 buffer_load_dwordx4 v196, s[8:11], s28 offen offset:1024 lds
 v_mfma_f32_16x16x32_bf16 v[88:91], a[8:11], v[152:155], 0
 ds_read_b128 v[116:119], v204 offset:12288
 v_mfma_f32_16x16x32_bf16 v[88:91], a[24:27], v[156:159], v[88:91]
 ds_read_b128 v[120:123], v203 offset:14336
 v_mfma_f32_16x16x32_bf16 v[92:95], a[12:15], v[152:155], 0
 ds_read_b128 v[124:127], v204 offset:14336
 v_mfma_f32_16x16x32_bf16 v[92:95], a[28:31], v[156:159], v[92:95]
 ds_read_b128 v[128:131], v203 offset:16384
 v_mfma_f32_16x16x32_bf16 v[96:99], a[0:3], v[160:163], 0
 ds_read_b128 v[132:135], v204 offset:16384
 v_mfma_f32_16x16x32_bf16 v[96:99], a[16:19], v[164:167], v[96:99]
 v_mfma_f32_16x16x32_bf16 v[100:103], a[4:7], v[160:163], 0
 v_mfma_f32_16x16x32_bf16 v[100:103], a[20:23], v[164:167], v[100:103]
 buffer_load_dwordx4 v197, s[8:11], s28 offen offset:2048 lds
 v_mfma_f32_16x16x32_bf16 v[104:107], a[8:11], v[160:163], 0
 v_mfma_f32_16x16x32_bf16 v[104:107], a[24:27], v[164:167], v[104:107]
 buffer_load_dwordx4 v198, s[8:11], s28 offen offset:3072 lds
 v_mfma_f32_16x16x32_bf16 v[108:111], a[12:15], v[160:163], 0
 v_mfma_f32_16x16x32_bf16 v[108:111], a[28:31], v[164:167], v[108:111]
 s_waitcnt vmcnt(11) lgkmcnt(0)
 s_barrier
 v_mfma_f32_16x16x32_bf16 v[0:3], a[32:35], v[112:115], v[0:3]
 ds_read_b128 v[136:139], v205 offset:16384
 s_add_u32 m0, s33, 147456
 v_mfma_f32_16x16x32_bf16 v[0:3], a[48:51], v[116:119], v[0:3]
 s_bfe_u32 s29, s4, 262156
 v_mfma_f32_16x16x32_bf16 v[4:7], a[36:39], v[112:115], v[4:7]
 ds_read_b128 v[140:143], v206 offset:16384
 s_lshl_b32 s29, s29, 19
 v_mfma_f32_16x16x32_bf16 v[4:7], a[52:55], v[116:119], v[4:7]
 v_mfma_f32_16x16x32_bf16 v[8:11], a[40:43], v[112:115], v[8:11]
 ds_read_b128 v[144:147], v205 offset:18432
 buffer_load_dwordx4 v199, s[12:15], s29 offen lds
 v_mfma_f32_16x16x32_bf16 v[8:11], a[56:59], v[116:119], v[8:11]
 v_mfma_f32_16x16x32_bf16 v[12:15], a[44:47], v[112:115], v[12:15]
 ds_read_b128 v[148:151], v206 offset:18432
 v_mfma_f32_16x16x32_bf16 v[12:15], a[60:63], v[116:119], v[12:15]
 buffer_load_dwordx4 v200, s[12:15], s29 offen offset:1024 lds
 v_mfma_f32_16x16x32_bf16 v[16:19], a[32:35], v[120:123], v[16:19]
 ds_read_b128 v[152:155], v205 offset:20480
 v_mfma_f32_16x16x32_bf16 v[16:19], a[48:51], v[124:127], v[16:19]
 v_mfma_f32_16x16x32_bf16 v[20:23], a[36:39], v[120:123], v[20:23]
 ds_read_b128 v[156:159], v206 offset:20480
 buffer_load_dwordx4 v201, s[12:15], s29 offen offset:2048 lds
 v_mfma_f32_16x16x32_bf16 v[20:23], a[52:55], v[124:127], v[20:23]
 v_mfma_f32_16x16x32_bf16 v[24:27], a[40:43], v[120:123], v[24:27]
 ds_read_b128 v[160:163], v205 offset:22528
 v_mfma_f32_16x16x32_bf16 v[24:27], a[56:59], v[124:127], v[24:27]
 buffer_load_dwordx4 v202, s[12:15], s29 offen offset:3072 lds
 v_mfma_f32_16x16x32_bf16 v[28:31], a[44:47], v[120:123], v[28:31]
 ds_read_b128 v[164:167], v206 offset:22528
 v_mfma_f32_16x16x32_bf16 v[28:31], a[60:63], v[124:127], v[28:31]
 s_add_u32 m0, s32, 86016
 v_mfma_f32_16x16x32_bf16 v[32:35], a[32:35], v[128:131], v[32:35]
 s_bfe_u32 s28, s4, 262156
 s_lshl_b32 s28, s28, 7
 v_mfma_f32_16x16x32_bf16 v[32:35], a[48:51], v[132:135], v[32:35]
 v_mfma_f32_16x16x32_bf16 v[36:39], a[36:39], v[128:131], v[36:39]
 buffer_load_dwordx4 v192, s[8:11], s28 offen lds
 v_mfma_f32_16x16x32_bf16 v[36:39], a[52:55], v[132:135], v[36:39]
 v_mfma_f32_16x16x32_bf16 v[40:43], a[40:43], v[128:131], v[40:43]
 buffer_load_dwordx4 v193, s[8:11], s28 offen offset:1024 lds
 v_mfma_f32_16x16x32_bf16 v[40:43], a[56:59], v[132:135], v[40:43]
 v_mfma_f32_16x16x32_bf16 v[44:47], a[44:47], v[128:131], v[44:47]
 buffer_load_dwordx4 v194, s[8:11], s28 offen offset:2048 lds
 v_mfma_f32_16x16x32_bf16 v[44:47], a[60:63], v[132:135], v[44:47]
 s_waitcnt vmcnt(11) lgkmcnt(0)
 s_barrier
 v_mfma_f32_16x16x32_bf16 v[48:51], a[32:35], v[136:139], v[48:51]
 ds_read_b64_tr_b16 a[0:1], v207 offset:0
 s_add_u32 m0, s33, 114688
 v_mfma_f32_16x16x32_bf16 v[48:51], a[48:51], v[140:143], v[48:51]
 ds_read_b64_tr_b16 a[2:3], v207 offset:1024
 v_mfma_f32_16x16x32_bf16 v[52:55], a[36:39], v[136:139], v[52:55]
 ds_read_b64_tr_b16 a[4:5], v208 offset:0
 v_mfma_f32_16x16x32_bf16 v[52:55], a[52:55], v[140:143], v[52:55]
 ds_read_b64_tr_b16 a[6:7], v208 offset:1024
 buffer_load_dwordx4 v195, s[8:11], s28 offen lds
 v_mfma_f32_16x16x32_bf16 v[56:59], a[40:43], v[136:139], v[56:59]
 ds_read_b64_tr_b16 a[8:9], v209 offset:0
 v_mfma_f32_16x16x32_bf16 v[56:59], a[56:59], v[140:143], v[56:59]
 ds_read_b64_tr_b16 a[10:11], v209 offset:1024
 v_mfma_f32_16x16x32_bf16 v[60:63], a[44:47], v[136:139], v[60:63]
 buffer_load_dwordx4 v196, s[8:11], s28 offen offset:1024 lds
 v_mfma_f32_16x16x32_bf16 v[60:63], a[60:63], v[140:143], v[60:63]
 ds_read_b64_tr_b16 a[12:13], v210 offset:0
 v_mfma_f32_16x16x32_bf16 v[64:67], a[32:35], v[144:147], v[64:67]
 ds_read_b64_tr_b16 a[14:15], v210 offset:1024
 v_mfma_f32_16x16x32_bf16 v[64:67], a[48:51], v[148:151], v[64:67]
 ds_read_b64_tr_b16 a[16:17], v207 offset:8192
 v_mfma_f32_16x16x32_bf16 v[68:71], a[36:39], v[144:147], v[68:71]
 ds_read_b64_tr_b16 a[18:19], v207 offset:9216
 v_mfma_f32_16x16x32_bf16 v[68:71], a[52:55], v[148:151], v[68:71]
 ds_read_b64_tr_b16 a[20:21], v208 offset:8192
 buffer_load_dwordx4 v197, s[8:11], s28 offen offset:2048 lds
 v_mfma_f32_16x16x32_bf16 v[72:75], a[40:43], v[144:147], v[72:75]
 v_mfma_f32_16x16x32_bf16 v[72:75], a[56:59], v[148:151], v[72:75]
 ds_read_b64_tr_b16 a[22:23], v208 offset:9216
 v_mfma_f32_16x16x32_bf16 v[76:79], a[44:47], v[144:147], v[76:79]
 ds_read_b64_tr_b16 a[24:25], v209 offset:8192
 buffer_load_dwordx4 v198, s[8:11], s28 offen offset:3072 lds
 v_mfma_f32_16x16x32_bf16 v[76:79], a[60:63], v[148:151], v[76:79]
 ds_read_b64_tr_b16 a[26:27], v209 offset:9216
 v_mfma_f32_16x16x32_bf16 v[80:83], a[32:35], v[152:155], v[80:83]
 ds_read_b64_tr_b16 a[28:29], v210 offset:8192
 v_mfma_f32_16x16x32_bf16 v[80:83], a[48:51], v[156:159], v[80:83]
 ds_read_b64_tr_b16 a[30:31], v210 offset:9216
 s_add_u32 m0, s31, 0
 v_mfma_f32_16x16x32_bf16 v[84:87], a[36:39], v[152:155], v[84:87]
 ds_read_b128 v[112:115], v203 offset:0
 v_mfma_f32_16x16x32_bf16 v[84:87], a[52:55], v[156:159], v[84:87]
 s_mov_b32 s34, 0
 v_mfma_f32_16x16x32_bf16 v[88:91], a[40:43], v[152:155], v[88:91]
 ds_read_b128 v[116:119], v204 offset:0
 buffer_load_dwordx4 v211, s[16:19], s34 offen nt lds
 v_mfma_f32_16x16x32_bf16 v[88:91], a[56:59], v[156:159], v[88:91]
 ds_read_b128 v[120:123], v203 offset:2048
 v_mfma_f32_16x16x32_bf16 v[92:95], a[44:47], v[152:155], v[92:95]
 ds_read_b128 v[124:127], v204 offset:2048
 v_mfma_f32_16x16x32_bf16 v[92:95], a[60:63], v[156:159], v[92:95]
 ds_read_b128 v[128:131], v203 offset:4096
 v_mfma_f32_16x16x32_bf16 v[96:99], a[32:35], v[160:163], v[96:99]
 ds_read_b128 v[132:135], v204 offset:4096
 v_mfma_f32_16x16x32_bf16 v[96:99], a[48:51], v[164:167], v[96:99]
 buffer_load_dwordx4 v212, s[16:19], s34 offen offset:1024 nt lds
 v_mfma_f32_16x16x32_bf16 v[100:103], a[36:39], v[160:163], v[100:103]
 s_add_u32 m0, s31, 8192
 v_mfma_f32_16x16x32_bf16 v[100:103], a[52:55], v[164:167], v[100:103]
 s_mov_b32 s34, 8192
 v_mfma_f32_16x16x32_bf16 v[104:107], a[40:43], v[160:163], v[104:107]
 buffer_load_dwordx4 v211, s[16:19], s34 offen nt lds
 v_mfma_f32_16x16x32_bf16 v[104:107], a[56:59], v[164:167], v[104:107]
 v_mfma_f32_16x16x32_bf16 v[108:111], a[44:47], v[160:163], v[108:111]
 buffer_load_dwordx4 v212, s[16:19], s34 offen offset:1024 nt lds
 v_mfma_f32_16x16x32_bf16 v[108:111], a[60:63], v[164:167], v[108:111]
 s_waitcnt vmcnt(15) lgkmcnt(0)
 s_barrier
 v_mfma_f32_16x16x32_bf16 v[0:3], a[0:3], v[112:115], v[0:3]
 ds_read_b128 v[136:139], v205 offset:0
 s_add_u32 m0, s33, 131072
 v_mfma_f32_16x16x32_bf16 v[0:3], a[16:19], v[116:119], v[0:3]
 s_bfe_u32 s29, s4, 262160
 v_mfma_f32_16x16x32_bf16 v[4:7], a[4:7], v[112:115], v[4:7]
 ds_read_b128 v[140:143], v206 offset:0
 s_lshl_b32 s29, s29, 19
 v_mfma_f32_16x16x32_bf16 v[4:7], a[20:23], v[116:119], v[4:7]
 v_mfma_f32_16x16x32_bf16 v[8:11], a[8:11], v[112:115], v[8:11]
 ds_read_b128 v[144:147], v205 offset:2048
 buffer_load_dwordx4 v199, s[12:15], s29 offen lds
 v_mfma_f32_16x16x32_bf16 v[8:11], a[24:27], v[116:119], v[8:11]
 v_mfma_f32_16x16x32_bf16 v[12:15], a[12:15], v[112:115], v[12:15]
 ds_read_b128 v[148:151], v206 offset:2048
 v_mfma_f32_16x16x32_bf16 v[12:15], a[28:31], v[116:119], v[12:15]
 buffer_load_dwordx4 v200, s[12:15], s29 offen offset:1024 lds
 v_mfma_f32_16x16x32_bf16 v[16:19], a[0:3], v[120:123], v[16:19]
 ds_read_b128 v[152:155], v205 offset:4096
 v_mfma_f32_16x16x32_bf16 v[16:19], a[16:19], v[124:127], v[16:19]
 v_mfma_f32_16x16x32_bf16 v[20:23], a[4:7], v[120:123], v[20:23]
 ds_read_b128 v[156:159], v206 offset:4096
 buffer_load_dwordx4 v201, s[12:15], s29 offen offset:2048 lds
 v_mfma_f32_16x16x32_bf16 v[20:23], a[20:23], v[124:127], v[20:23]
 v_mfma_f32_16x16x32_bf16 v[24:27], a[8:11], v[120:123], v[24:27]
 ds_read_b128 v[160:163], v205 offset:6144
 v_mfma_f32_16x16x32_bf16 v[24:27], a[24:27], v[124:127], v[24:27]
 buffer_load_dwordx4 v202, s[12:15], s29 offen offset:3072 lds
 v_mfma_f32_16x16x32_bf16 v[28:31], a[12:15], v[120:123], v[28:31]
 ds_read_b128 v[164:167], v206 offset:6144
 v_mfma_f32_16x16x32_bf16 v[28:31], a[28:31], v[124:127], v[28:31]
 s_add_u32 m0, s32, 73728
 v_mfma_f32_16x16x32_bf16 v[32:35], a[0:3], v[128:131], v[32:35]
 s_bfe_u32 s28, s4, 262160
 s_lshl_b32 s28, s28, 7
 v_mfma_f32_16x16x32_bf16 v[32:35], a[16:19], v[132:135], v[32:35]
 v_mfma_f32_16x16x32_bf16 v[36:39], a[4:7], v[128:131], v[36:39]
 buffer_load_dwordx4 v192, s[8:11], s28 offen lds
 v_mfma_f32_16x16x32_bf16 v[36:39], a[20:23], v[132:135], v[36:39]
 v_mfma_f32_16x16x32_bf16 v[40:43], a[8:11], v[128:131], v[40:43]
 buffer_load_dwordx4 v193, s[8:11], s28 offen offset:1024 lds
 v_mfma_f32_16x16x32_bf16 v[40:43], a[24:27], v[132:135], v[40:43]
 v_mfma_f32_16x16x32_bf16 v[44:47], a[12:15], v[128:131], v[44:47]
 buffer_load_dwordx4 v194, s[8:11], s28 offen offset:2048 lds
 v_mfma_f32_16x16x32_bf16 v[44:47], a[28:31], v[132:135], v[44:47]
 s_waitcnt vmcnt(15) lgkmcnt(0)
 s_barrier
 v_mfma_f32_16x16x32_bf16 v[48:51], a[0:3], v[136:139], v[48:51]
 ds_read_b64_tr_b16 a[32:33], v207 offset:16384
 s_add_u32 m0, s33, 98304
 v_mfma_f32_16x16x32_bf16 v[48:51], a[16:19], v[140:143], v[48:51]
 ds_read_b64_tr_b16 a[34:35], v207 offset:17408
 v_mfma_f32_16x16x32_bf16 v[52:55], a[4:7], v[136:139], v[52:55]
 ds_read_b64_tr_b16 a[36:37], v208 offset:16384
 v_mfma_f32_16x16x32_bf16 v[52:55], a[20:23], v[140:143], v[52:55]
 ds_read_b64_tr_b16 a[38:39], v208 offset:17408
 buffer_load_dwordx4 v195, s[8:11], s28 offen lds
 v_mfma_f32_16x16x32_bf16 v[56:59], a[8:11], v[136:139], v[56:59]
 ds_read_b64_tr_b16 a[40:41], v209 offset:16384
 v_mfma_f32_16x16x32_bf16 v[56:59], a[24:27], v[140:143], v[56:59]
 ds_read_b64_tr_b16 a[42:43], v209 offset:17408
 v_mfma_f32_16x16x32_bf16 v[60:63], a[12:15], v[136:139], v[60:63]
 buffer_load_dwordx4 v196, s[8:11], s28 offen offset:1024 lds
 v_mfma_f32_16x16x32_bf16 v[60:63], a[28:31], v[140:143], v[60:63]
 ds_read_b64_tr_b16 a[44:45], v210 offset:16384
 v_mfma_f32_16x16x32_bf16 v[64:67], a[0:3], v[144:147], v[64:67]
 ds_read_b64_tr_b16 a[46:47], v210 offset:17408
 v_mfma_f32_16x16x32_bf16 v[64:67], a[16:19], v[148:151], v[64:67]
 ds_read_b64_tr_b16 a[48:49], v207 offset:24576
 v_mfma_f32_16x16x32_bf16 v[68:71], a[4:7], v[144:147], v[68:71]
 ds_read_b64_tr_b16 a[50:51], v207 offset:25600
 v_mfma_f32_16x16x32_bf16 v[68:71], a[20:23], v[148:151], v[68:71]
 ds_read_b64_tr_b16 a[52:53], v208 offset:24576
 buffer_load_dwordx4 v197, s[8:11], s28 offen offset:2048 lds
 v_mfma_f32_16x16x32_bf16 v[72:75], a[8:11], v[144:147], v[72:75]
 v_mfma_f32_16x16x32_bf16 v[72:75], a[24:27], v[148:151], v[72:75]
 ds_read_b64_tr_b16 a[54:55], v208 offset:25600
 v_mfma_f32_16x16x32_bf16 v[76:79], a[12:15], v[144:147], v[76:79]
 ds_read_b64_tr_b16 a[56:57], v209 offset:24576
 buffer_load_dwordx4 v198, s[8:11], s28 offen offset:3072 lds
 v_mfma_f32_16x16x32_bf16 v[76:79], a[28:31], v[148:151], v[76:79]
 ds_read_b64_tr_b16 a[58:59], v209 offset:25600
 v_mfma_f32_16x16x32_bf16 v[80:83], a[0:3], v[152:155], v[80:83]
 ds_read_b64_tr_b16 a[60:61], v210 offset:24576
 v_mfma_f32_16x16x32_bf16 v[80:83], a[16:19], v[156:159], v[80:83]
 ds_read_b64_tr_b16 a[62:63], v210 offset:25600
 s_add_u32 m0, s31, 16384
 v_mfma_f32_16x16x32_bf16 v[84:87], a[4:7], v[152:155], v[84:87]
 ds_read_b128 v[112:115], v203 offset:12288
 v_mfma_f32_16x16x32_bf16 v[84:87], a[20:23], v[156:159], v[84:87]
 s_mov_b32 s34, 16384
 v_mfma_f32_16x16x32_bf16 v[88:91], a[8:11], v[152:155], v[88:91]
 ds_read_b128 v[116:119], v204 offset:12288
 buffer_load_dwordx4 v211, s[16:19], s34 offen nt lds
 v_mfma_f32_16x16x32_bf16 v[88:91], a[24:27], v[156:159], v[88:91]
 ds_read_b128 v[120:123], v203 offset:14336
 v_mfma_f32_16x16x32_bf16 v[92:95], a[12:15], v[152:155], v[92:95]
 ds_read_b128 v[124:127], v204 offset:14336
 v_mfma_f32_16x16x32_bf16 v[92:95], a[28:31], v[156:159], v[92:95]
 ds_read_b128 v[128:131], v203 offset:16384
 v_mfma_f32_16x16x32_bf16 v[96:99], a[0:3], v[160:163], v[96:99]
 ds_read_b128 v[132:135], v204 offset:16384
 v_mfma_f32_16x16x32_bf16 v[96:99], a[16:19], v[164:167], v[96:99]
 buffer_load_dwordx4 v212, s[16:19], s34 offen offset:1024 nt lds
 v_mfma_f32_16x16x32_bf16 v[100:103], a[4:7], v[160:163], v[100:103]
 s_add_u32 m0, s31, 24576
 v_mfma_f32_16x16x32_bf16 v[100:103], a[20:23], v[164:167], v[100:103]
 s_mov_b32 s34, 0
 v_mfma_f32_16x16x32_bf16 v[104:107], a[8:11], v[160:163], v[104:107]
 buffer_load_dwordx4 v213, s[20:23], s34 offen nt lds
 v_mfma_f32_16x16x32_bf16 v[104:107], a[24:27], v[164:167], v[104:107]
 v_mfma_f32_16x16x32_bf16 v[108:111], a[12:15], v[160:163], v[108:111]
 buffer_load_dwordx4 v213, s[20:23], s34 offen offset:1024 nt lds
 v_mfma_f32_16x16x32_bf16 v[108:111], a[28:31], v[164:167], v[108:111]
 s_waitcnt vmcnt(19) lgkmcnt(0)
 s_barrier
 v_mfma_f32_16x16x32_bf16 v[0:3], a[32:35], v[112:115], v[0:3]
 ds_read_b128 v[136:139], v205 offset:16384
 s_add_u32 m0, s33, 147456
 v_mfma_f32_16x16x32_bf16 v[0:3], a[48:51], v[116:119], v[0:3]
 s_bfe_u32 s29, s4, 262164
 v_mfma_f32_16x16x32_bf16 v[4:7], a[36:39], v[112:115], v[4:7]
 ds_read_b128 v[140:143], v206 offset:16384
 s_lshl_b32 s29, s29, 19
 v_mfma_f32_16x16x32_bf16 v[4:7], a[52:55], v[116:119], v[4:7]
 v_mfma_f32_16x16x32_bf16 v[8:11], a[40:43], v[112:115], v[8:11]
 ds_read_b128 v[144:147], v205 offset:18432
 buffer_load_dwordx4 v199, s[12:15], s29 offen lds
 v_mfma_f32_16x16x32_bf16 v[8:11], a[56:59], v[116:119], v[8:11]
 v_mfma_f32_16x16x32_bf16 v[12:15], a[44:47], v[112:115], v[12:15]
 ds_read_b128 v[148:151], v206 offset:18432
 v_mfma_f32_16x16x32_bf16 v[12:15], a[60:63], v[116:119], v[12:15]
 buffer_load_dwordx4 v200, s[12:15], s29 offen offset:1024 lds
 v_mfma_f32_16x16x32_bf16 v[16:19], a[32:35], v[120:123], v[16:19]
 ds_read_b128 v[152:155], v205 offset:20480
 v_mfma_f32_16x16x32_bf16 v[16:19], a[48:51], v[124:127], v[16:19]
 v_mfma_f32_16x16x32_bf16 v[20:23], a[36:39], v[120:123], v[20:23]
 ds_read_b128 v[156:159], v206 offset:20480
 buffer_load_dwordx4 v201, s[12:15], s29 offen offset:2048 lds
 v_mfma_f32_16x16x32_bf16 v[20:23], a[52:55], v[124:127], v[20:23]
 v_mfma_f32_16x16x32_bf16 v[24:27], a[40:43], v[120:123], v[24:27]
 ds_read_b128 v[160:163], v205 offset:22528
 v_mfma_f32_16x16x32_bf16 v[24:27], a[56:59], v[124:127], v[24:27]
 buffer_load_dwordx4 v202, s[12:15], s29 offen offset:3072 lds
 v_mfma_f32_16x16x32_bf16 v[28:31], a[44:47], v[120:123], v[28:31]
 ds_read_b128 v[164:167], v206 offset:22528
 v_mfma_f32_16x16x32_bf16 v[28:31], a[60:63], v[124:127], v[28:31]
 s_add_u32 m0, s32, 86016
 v_mfma_f32_16x16x32_bf16 v[32:35], a[32:35], v[128:131], v[32:35]
 s_bfe_u32 s28, s4, 262164
 s_lshl_b32 s28, s28, 7
 v_mfma_f32_16x16x32_bf16 v[32:35], a[48:51], v[132:135], v[32:35]
 v_mfma_f32_16x16x32_bf16 v[36:39], a[36:39], v[128:131], v[36:39]
 buffer_load_dwordx4 v192, s[8:11], s28 offen lds
 v_mfma_f32_16x16x32_bf16 v[36:39], a[52:55], v[132:135], v[36:39]
 v_mfma_f32_16x16x32_bf16 v[40:43], a[40:43], v[128:131], v[40:43]
 buffer_load_dwordx4 v193, s[8:11], s28 offen offset:1024 lds
 v_mfma_f32_16x16x32_bf16 v[40:43], a[56:59], v[132:135], v[40:43]
 v_mfma_f32_16x16x32_bf16 v[44:47], a[44:47], v[128:131], v[44:47]
 buffer_load_dwordx4 v194, s[8:11], s28 offen offset:2048 lds
 v_mfma_f32_16x16x32_bf16 v[44:47], a[60:63], v[132:135], v[44:47]
 s_waitcnt vmcnt(15) lgkmcnt(0)
 s_barrier
 v_mfma_f32_16x16x32_bf16 v[48:51], a[32:35], v[136:139], v[48:51]
 ds_read_b64_tr_b16 a[0:1], v207 offset:0
 v_mfma_f32_16x16x32_bf16 v[48:51], a[48:51], v[140:143], v[48:51]
 ds_read_b64_tr_b16 a[2:3], v207 offset:1024
 s_add_u32 m0, s33, 114688
 v_mfma_f32_16x16x32_bf16 v[52:55], a[36:39], v[136:139], v[52:55]
 ds_read_b64_tr_b16 a[4:5], v208 offset:0
 v_mfma_f32_16x16x32_bf16 v[52:55], a[52:55], v[140:143], v[52:55]
 ds_read_b64_tr_b16 a[6:7], v208 offset:1024
 v_mfma_f32_16x16x32_bf16 v[56:59], a[40:43], v[136:139], v[56:59]
 ds_read_b64_tr_b16 a[8:9], v209 offset:0
 v_mfma_f32_16x16x32_bf16 v[56:59], a[56:59], v[140:143], v[56:59]
 ds_read_b64_tr_b16 a[10:11], v209 offset:1024
 v_mfma_f32_16x16x32_bf16 v[60:63], a[44:47], v[136:139], v[60:63]
 buffer_load_dwordx4 v195, s[8:11], s28 offen lds
 v_mfma_f32_16x16x32_bf16 v[60:63], a[60:63], v[140:143], v[60:63]
 ds_read_b64_tr_b16 a[12:13], v210 offset:0
 v_mfma_f32_16x16x32_bf16 v[64:67], a[32:35], v[144:147], v[64:67]
 ds_read_b64_tr_b16 a[14:15], v210 offset:1024
 v_mfma_f32_16x16x32_bf16 v[64:67], a[48:51], v[148:151], v[64:67]
 ds_read_b64_tr_b16 a[16:17], v207 offset:8192
 v_mfma_f32_16x16x32_bf16 v[68:71], a[36:39], v[144:147], v[68:71]
 ds_read_b64_tr_b16 a[18:19], v207 offset:9216
 v_mfma_f32_16x16x32_bf16 v[68:71], a[52:55], v[148:151], v[68:71]
 ds_read_b64_tr_b16 a[20:21], v208 offset:8192
 buffer_load_dwordx4 v196, s[8:11], s28 offen offset:1024 lds
 v_mfma_f32_16x16x32_bf16 v[72:75], a[40:43], v[144:147], v[72:75]
 v_mfma_f32_16x16x32_bf16 v[72:75], a[56:59], v[148:151], v[72:75]
 ds_read_b64_tr_b16 a[22:23], v208 offset:9216
 v_mfma_f32_16x16x32_bf16 v[76:79], a[44:47], v[144:147], v[76:79]
 ds_read_b64_tr_b16 a[24:25], v209 offset:8192
 v_mfma_f32_16x16x32_bf16 v[76:79], a[60:63], v[148:151], v[76:79]
 ds_read_b64_tr_b16 a[26:27], v209 offset:9216
 v_mfma_f32_16x16x32_bf16 v[80:83], a[32:35], v[152:155], v[80:83]
 ds_read_b64_tr_b16 a[28:29], v210 offset:8192
 buffer_load_dwordx4 v197, s[8:11], s28 offen offset:2048 lds
 v_mfma_f32_16x16x32_bf16 v[80:83], a[48:51], v[156:159], v[80:83]
 ds_read_b64_tr_b16 a[30:31], v210 offset:9216
 v_mfma_f32_16x16x32_bf16 v[84:87], a[36:39], v[152:155], v[84:87]
 ds_read_b128 v[112:115], v203 offset:0
 v_mfma_f32_16x16x32_bf16 v[84:87], a[52:55], v[156:159], v[84:87]
 v_mfma_f32_16x16x32_bf16 v[88:91], a[40:43], v[152:155], v[88:91]
 ds_read_b128 v[116:119], v204 offset:0
 v_mfma_f32_16x16x32_bf16 v[88:91], a[56:59], v[156:159], v[88:91]
 ds_read_b128 v[120:123], v203 offset:2048
 buffer_load_dwordx4 v198, s[8:11], s28 offen offset:3072 lds
 v_mfma_f32_16x16x32_bf16 v[92:95], a[44:47], v[152:155], v[92:95]
 ds_read_b128 v[124:127], v204 offset:2048
 v_mfma_f32_16x16x32_bf16 v[92:95], a[60:63], v[156:159], v[92:95]
 ds_read_b128 v[128:131], v203 offset:4096
 v_mfma_f32_16x16x32_bf16 v[96:99], a[32:35], v[160:163], v[96:99]
 ds_read_b128 v[132:135], v204 offset:4096
 v_mfma_f32_16x16x32_bf16 v[96:99], a[48:51], v[164:167], v[96:99]
 s_add_u32 m0, s31, 32768
 v_mfma_f32_16x16x32_bf16 v[100:103], a[36:39], v[160:163], v[100:103]
 s_mov_b32 s34, 24576
 v_mfma_f32_16x16x32_bf16 v[100:103], a[52:55], v[164:167], v[100:103]
 buffer_load_dwordx4 v211, s[16:19], s34 offen nt lds
 v_mfma_f32_16x16x32_bf16 v[104:107], a[40:43], v[160:163], v[104:107]
 v_mfma_f32_16x16x32_bf16 v[104:107], a[56:59], v[164:167], v[104:107]
 buffer_load_dwordx4 v212, s[16:19], s34 offen offset:1024 nt lds
 v_mfma_f32_16x16x32_bf16 v[108:111], a[44:47], v[160:163], v[108:111]
 v_mfma_f32_16x16x32_bf16 v[108:111], a[60:63], v[164:167], v[108:111]
 s_waitcnt vmcnt(17) lgkmcnt(0)
 s_barrier
 v_mfma_f32_16x16x32_bf16 v[0:3], a[0:3], v[112:115], v[0:3]
 ds_read_b128 v[136:139], v205 offset:0
 s_add_u32 m0, s33, 131072
 v_mfma_f32_16x16x32_bf16 v[0:3], a[16:19], v[116:119], v[0:3]
 s_bfe_u32 s29, s4, 262168
 v_mfma_f32_16x16x32_bf16 v[4:7], a[4:7], v[112:115], v[4:7]
 ds_read_b128 v[140:143], v206 offset:0
 s_lshl_b32 s29, s29, 19
 v_mfma_f32_16x16x32_bf16 v[4:7], a[20:23], v[116:119], v[4:7]
 v_mfma_f32_16x16x32_bf16 v[8:11], a[8:11], v[112:115], v[8:11]
 ds_read_b128 v[144:147], v205 offset:2048
 buffer_load_dwordx4 v199, s[12:15], s29 offen lds
 v_mfma_f32_16x16x32_bf16 v[8:11], a[24:27], v[116:119], v[8:11]
 v_mfma_f32_16x16x32_bf16 v[12:15], a[12:15], v[112:115], v[12:15]
 ds_read_b128 v[148:151], v206 offset:2048
 v_mfma_f32_16x16x32_bf16 v[12:15], a[28:31], v[116:119], v[12:15]
 buffer_load_dwordx4 v200, s[12:15], s29 offen offset:1024 lds
 v_mfma_f32_16x16x32_bf16 v[16:19], a[0:3], v[120:123], v[16:19]
 ds_read_b128 v[152:155], v205 offset:4096
 v_mfma_f32_16x16x32_bf16 v[16:19], a[16:19], v[124:127], v[16:19]
 v_mfma_f32_16x16x32_bf16 v[20:23], a[4:7], v[120:123], v[20:23]
 ds_read_b128 v[156:159], v206 offset:4096
 buffer_load_dwordx4 v201, s[12:15], s29 offen offset:2048 lds
 v_mfma_f32_16x16x32_bf16 v[20:23], a[20:23], v[124:127], v[20:23]
 v_mfma_f32_16x16x32_bf16 v[24:27], a[8:11], v[120:123], v[24:27]
 ds_read_b128 v[160:163], v205 offset:6144
 v_mfma_f32_16x16x32_bf16 v[24:27], a[24:27], v[124:127], v[24:27]
 buffer_load_dwordx4 v202, s[12:15], s29 offen offset:3072 lds
 v_mfma_f32_16x16x32_bf16 v[28:31], a[12:15], v[120:123], v[28:31]
 ds_read_b128 v[164:167], v206 offset:6144
 v_mfma_f32_16x16x32_bf16 v[28:31], a[28:31], v[124:127], v[28:31]
 s_add_u32 m0, s32, 73728
 v_mfma_f32_16x16x32_bf16 v[32:35], a[0:3], v[128:131], v[32:35]
 s_bfe_u32 s28, s4, 262168
 s_lshl_b32 s28, s28, 7
 v_mfma_f32_16x16x32_bf16 v[32:35], a[16:19], v[132:135], v[32:35]
 v_mfma_f32_16x16x32_bf16 v[36:39], a[4:7], v[128:131], v[36:39]
 buffer_load_dwordx4 v192, s[8:11], s28 offen lds
 v_mfma_f32_16x16x32_bf16 v[36:39], a[20:23], v[132:135], v[36:39]
 v_mfma_f32_16x16x32_bf16 v[40:43], a[8:11], v[128:131], v[40:43]
 buffer_load_dwordx4 v193, s[8:11], s28 offen offset:1024 lds
 v_mfma_f32_16x16x32_bf16 v[40:43], a[24:27], v[132:135], v[40:43]
 v_mfma_f32_16x16x32_bf16 v[44:47], a[12:15], v[128:131], v[44:47]
 buffer_load_dwordx4 v194, s[8:11], s28 offen offset:2048 lds
 v_mfma_f32_16x16x32_bf16 v[44:47], a[28:31], v[132:135], v[44:47]
 s_waitcnt vmcnt(13) lgkmcnt(0)
 s_barrier
 v_mfma_f32_16x16x32_bf16 v[48:51], a[0:3], v[136:139], v[48:51]
 ds_read_b64_tr_b16 a[32:33], v207 offset:16384
 v_mfma_f32_16x16x32_bf16 v[48:51], a[16:19], v[140:143], v[48:51]
 ds_read_b64_tr_b16 a[34:35], v207 offset:17408
 v_mfma_f32_16x16x32_bf16 v[52:55], a[4:7], v[136:139], v[52:55]
 ds_read_b64_tr_b16 a[36:37], v208 offset:16384
 v_mfma_f32_16x16x32_bf16 v[52:55], a[20:23], v[140:143], v[52:55]
 ds_read_b64_tr_b16 a[38:39], v208 offset:17408
 s_add_u32 m0, s33, 98304
 v_mfma_f32_16x16x32_bf16 v[56:59], a[8:11], v[136:139], v[56:59]
 ds_read_b64_tr_b16 a[40:41], v209 offset:16384
 v_mfma_f32_16x16x32_bf16 v[56:59], a[24:27], v[140:143], v[56:59]
 ds_read_b64_tr_b16 a[42:43], v209 offset:17408
 v_mfma_f32_16x16x32_bf16 v[60:63], a[12:15], v[136:139], v[60:63]
 v_mfma_f32_16x16x32_bf16 v[60:63], a[28:31], v[140:143], v[60:63]
 ds_read_b64_tr_b16 a[44:45], v210 offset:16384
 v_mfma_f32_16x16x32_bf16 v[64:67], a[0:3], v[144:147], v[64:67]
 ds_read_b64_tr_b16 a[46:47], v210 offset:17408
 v_mfma_f32_16x16x32_bf16 v[64:67], a[16:19], v[148:151], v[64:67]
 ds_read_b64_tr_b16 a[48:49], v207 offset:24576
 v_mfma_f32_16x16x32_bf16 v[68:71], a[4:7], v[144:147], v[68:71]
 ds_read_b64_tr_b16 a[50:51], v207 offset:25600
 v_mfma_f32_16x16x32_bf16 v[68:71], a[20:23], v[148:151], v[68:71]
 ds_read_b64_tr_b16 a[52:53], v208 offset:24576
 buffer_load_dwordx4 v195, s[8:11], s28 offen lds
 v_mfma_f32_16x16x32_bf16 v[72:75], a[8:11], v[144:147], v[72:75]
 v_mfma_f32_16x16x32_bf16 v[72:75], a[24:27], v[148:151], v[72:75]
 ds_read_b64_tr_b16 a[54:55], v208 offset:25600
 v_mfma_f32_16x16x32_bf16 v[76:79], a[12:15], v[144:147], v[76:79]
 ds_read_b64_tr_b16 a[56:57], v209 offset:24576
 v_mfma_f32_16x16x32_bf16 v[76:79], a[28:31], v[148:151], v[76:79]
 ds_read_b64_tr_b16 a[58:59], v209 offset:25600
 v_mfma_f32_16x16x32_bf16 v[80:83], a[0:3], v[152:155], v[80:83]
 ds_read_b64_tr_b16 a[60:61], v210 offset:24576
 v_mfma_f32_16x16x32_bf16 v[80:83], a[16:19], v[156:159], v[80:83]
 ds_read_b64_tr_b16 a[62:63], v210 offset:25600
 v_mfma_f32_16x16x32_bf16 v[84:87], a[4:7], v[152:155], v[84:87]
 ds_read_b128 v[112:115], v203 offset:12288
 v_mfma_f32_16x16x32_bf16 v[84:87], a[20:23], v[156:159], v[84:87]
 buffer_load_dwordx4 v196, s[8:11], s28 offen offset:1024 lds
 v_mfma_f32_16x16x32_bf16 v[88:91], a[8:11], v[152:155], v[88:91]
 ds_read_b128 v[116:119], v204 offset:12288
 v_mfma_f32_16x16x32_bf16 v[88:91], a[24:27], v[156:159], v[88:91]
 ds_read_b128 v[120:123], v203 offset:14336
 v_mfma_f32_16x16x32_bf16 v[92:95], a[12:15], v[152:155], v[92:95]
 ds_read_b128 v[124:127], v204 offset:14336
 v_mfma_f32_16x16x32_bf16 v[92:95], a[28:31], v[156:159], v[92:95]
 ds_read_b128 v[128:131], v203 offset:16384
 v_mfma_f32_16x16x32_bf16 v[96:99], a[0:3], v[160:163], v[96:99]
 ds_read_b128 v[132:135], v204 offset:16384
 v_mfma_f32_16x16x32_bf16 v[96:99], a[16:19], v[164:167], v[96:99]
 v_mfma_f32_16x16x32_bf16 v[100:103], a[4:7], v[160:163], v[100:103]
 v_mfma_f32_16x16x32_bf16 v[100:103], a[20:23], v[164:167], v[100:103]
 buffer_load_dwordx4 v197, s[8:11], s28 offen offset:2048 lds
 v_mfma_f32_16x16x32_bf16 v[104:107], a[8:11], v[160:163], v[104:107]
 v_mfma_f32_16x16x32_bf16 v[104:107], a[24:27], v[164:167], v[104:107]
 buffer_load_dwordx4 v198, s[8:11], s28 offen offset:3072 lds
 v_mfma_f32_16x16x32_bf16 v[108:111], a[12:15], v[160:163], v[108:111]
 v_mfma_f32_16x16x32_bf16 v[108:111], a[28:31], v[164:167], v[108:111]
 s_waitcnt vmcnt(13) lgkmcnt(0)
 s_barrier
 v_mfma_f32_16x16x32_bf16 v[0:3], a[32:35], v[112:115], v[0:3]
 ds_read_b128 v[136:139], v205 offset:16384
 s_add_u32 m0, s33, 147456
 v_mfma_f32_16x16x32_bf16 v[0:3], a[48:51], v[116:119], v[0:3]
 s_bfe_u32 s29, s4, 262172
 v_mfma_f32_16x16x32_bf16 v[4:7], a[36:39], v[112:115], v[4:7]
 ds_read_b128 v[140:143], v206 offset:16384
 s_lshl_b32 s29, s29, 19
 v_mfma_f32_16x16x32_bf16 v[4:7], a[52:55], v[116:119], v[4:7]
 v_mfma_f32_16x16x32_bf16 v[8:11], a[40:43], v[112:115], v[8:11]
 ds_read_b128 v[144:147], v205 offset:18432
 buffer_load_dwordx4 v199, s[12:15], s29 offen lds
 v_mfma_f32_16x16x32_bf16 v[8:11], a[56:59], v[116:119], v[8:11]
 v_mfma_f32_16x16x32_bf16 v[12:15], a[44:47], v[112:115], v[12:15]
 ds_read_b128 v[148:151], v206 offset:18432
 v_mfma_f32_16x16x32_bf16 v[12:15], a[60:63], v[116:119], v[12:15]
 buffer_load_dwordx4 v200, s[12:15], s29 offen offset:1024 lds
 v_mfma_f32_16x16x32_bf16 v[16:19], a[32:35], v[120:123], v[16:19]
 ds_read_b128 v[152:155], v205 offset:20480
 v_mfma_f32_16x16x32_bf16 v[16:19], a[48:51], v[124:127], v[16:19]
 v_mfma_f32_16x16x32_bf16 v[20:23], a[36:39], v[120:123], v[20:23]
 ds_read_b128 v[156:159], v206 offset:20480
 buffer_load_dwordx4 v201, s[12:15], s29 offen offset:2048 lds
 v_mfma_f32_16x16x32_bf16 v[20:23], a[52:55], v[124:127], v[20:23]
 v_mfma_f32_16x16x32_bf16 v[24:27], a[40:43], v[120:123], v[24:27]
 ds_read_b128 v[160:163], v205 offset:22528
 v_mfma_f32_16x16x32_bf16 v[24:27], a[56:59], v[124:127], v[24:27]
 buffer_load_dwordx4 v202, s[12:15], s29 offen offset:3072 lds
 v_mfma_f32_16x16x32_bf16 v[28:31], a[44:47], v[120:123], v[28:31]
 ds_read_b128 v[164:167], v206 offset:22528
 v_mfma_f32_16x16x32_bf16 v[28:31], a[60:63], v[124:127], v[28:31]
 s_add_u32 m0, s32, 86016
 v_mfma_f32_16x16x32_bf16 v[32:35], a[32:35], v[128:131], v[32:35]
 s_bfe_u32 s28, s4, 262172
 s_lshl_b32 s28, s28, 7
 v_mfma_f32_16x16x32_bf16 v[32:35], a[48:51], v[132:135], v[32:35]
 v_mfma_f32_16x16x32_bf16 v[36:39], a[36:39], v[128:131], v[36:39]
 buffer_load_dwordx4 v192, s[8:11], s28 offen lds
 v_mfma_f32_16x16x32_bf16 v[36:39], a[52:55], v[132:135], v[36:39]
 v_mfma_f32_16x16x32_bf16 v[40:43], a[40:43], v[128:131], v[40:43]
 buffer_load_dwordx4 v193, s[8:11], s28 offen offset:1024 lds
 v_mfma_f32_16x16x32_bf16 v[40:43], a[56:59], v[132:135], v[40:43]
 v_mfma_f32_16x16x32_bf16 v[44:47], a[44:47], v[128:131], v[44:47]
 buffer_load_dwordx4 v194, s[8:11], s28 offen offset:2048 lds
 v_mfma_f32_16x16x32_bf16 v[44:47], a[60:63], v[132:135], v[44:47]
 s_waitcnt vmcnt(11) lgkmcnt(0)
 s_barrier
 v_mfma_f32_16x16x32_bf16 v[48:51], a[32:35], v[136:139], v[48:51]
 ds_read_b64_tr_b16 a[0:1], v207 offset:0
 s_add_u32 m0, s33, 114688
 v_mfma_f32_16x16x32_bf16 v[48:51], a[48:51], v[140:143], v[48:51]
 ds_read_b64_tr_b16 a[2:3], v207 offset:1024
 v_mfma_f32_16x16x32_bf16 v[52:55], a[36:39], v[136:139], v[52:55]
 ds_read_b64_tr_b16 a[4:5], v208 offset:0
 v_mfma_f32_16x16x32_bf16 v[52:55], a[52:55], v[140:143], v[52:55]
 ds_read_b64_tr_b16 a[6:7], v208 offset:1024
 buffer_load_dwordx4 v195, s[8:11], s28 offen lds
 v_mfma_f32_16x16x32_bf16 v[56:59], a[40:43], v[136:139], v[56:59]
 ds_read_b64_tr_b16 a[8:9], v209 offset:0
 v_mfma_f32_16x16x32_bf16 v[56:59], a[56:59], v[140:143], v[56:59]
 ds_read_b64_tr_b16 a[10:11], v209 offset:1024
 v_mfma_f32_16x16x32_bf16 v[60:63], a[44:47], v[136:139], v[60:63]
 buffer_load_dwordx4 v196, s[8:11], s28 offen offset:1024 lds
 v_mfma_f32_16x16x32_bf16 v[60:63], a[60:63], v[140:143], v[60:63]
 ds_read_b64_tr_b16 a[12:13], v210 offset:0
 v_mfma_f32_16x16x32_bf16 v[64:67], a[32:35], v[144:147], v[64:67]
 ds_read_b64_tr_b16 a[14:15], v210 offset:1024
 v_mfma_f32_16x16x32_bf16 v[64:67], a[48:51], v[148:151], v[64:67]
 ds_read_b64_tr_b16 a[16:17], v207 offset:8192
 v_mfma_f32_16x16x32_bf16 v[68:71], a[36:39], v[144:147], v[68:71]
 ds_read_b64_tr_b16 a[18:19], v207 offset:9216
 v_mfma_f32_16x16x32_bf16 v[68:71], a[52:55], v[148:151], v[68:71]
 ds_read_b64_tr_b16 a[20:21], v208 offset:8192
 buffer_load_dwordx4 v197, s[8:11], s28 offen offset:2048 lds
 v_mfma_f32_16x16x32_bf16 v[72:75], a[40:43], v[144:147], v[72:75]
 v_mfma_f32_16x16x32_bf16 v[72:75], a[56:59], v[148:151], v[72:75]
 ds_read_b64_tr_b16 a[22:23], v208 offset:9216
 v_mfma_f32_16x16x32_bf16 v[76:79], a[44:47], v[144:147], v[76:79]
 ds_read_b64_tr_b16 a[24:25], v209 offset:8192
 buffer_load_dwordx4 v198, s[8:11], s28 offen offset:3072 lds
 v_mfma_f32_16x16x32_bf16 v[76:79], a[60:63], v[148:151], v[76:79]
 ds_read_b64_tr_b16 a[26:27], v209 offset:9216
 v_mfma_f32_16x16x32_bf16 v[80:83], a[32:35], v[152:155], v[80:83]
 ds_read_b64_tr_b16 a[28:29], v210 offset:8192
 v_mfma_f32_16x16x32_bf16 v[80:83], a[48:51], v[156:159], v[80:83]
 ds_read_b64_tr_b16 a[30:31], v210 offset:9216
 s_add_u32 m0, s31, 40960
 v_mfma_f32_16x16x32_bf16 v[84:87], a[36:39], v[152:155], v[84:87]
 ds_read_b128 v[112:115], v203 offset:0
 v_mfma_f32_16x16x32_bf16 v[84:87], a[52:55], v[156:159], v[84:87]
 s_mov_b32 s34, 8192
 v_mfma_f32_16x16x32_bf16 v[88:91], a[40:43], v[152:155], v[88:91]
 ds_read_b128 v[116:119], v204 offset:0
 buffer_load_dwordx4 v213, s[20:23], s34 offen nt lds
 v_mfma_f32_16x16x32_bf16 v[88:91], a[56:59], v[156:159], v[88:91]
 ds_read_b128 v[120:123], v203 offset:2048
 v_mfma_f32_16x16x32_bf16 v[92:95], a[44:47], v[152:155], v[92:95]
 ds_read_b128 v[124:127], v204 offset:2048
 v_mfma_f32_16x16x32_bf16 v[92:95], a[60:63], v[156:159], v[92:95]
 ds_read_b128 v[128:131], v203 offset:4096
 v_mfma_f32_16x16x32_bf16 v[96:99], a[32:35], v[160:163], v[96:99]
 ds_read_b128 v[132:135], v204 offset:4096
 v_mfma_f32_16x16x32_bf16 v[96:99], a[48:51], v[164:167], v[96:99]
 buffer_load_dwordx4 v213, s[20:23], s34 offen offset:1024 nt lds
 v_mfma_f32_16x16x32_bf16 v[100:103], a[36:39], v[160:163], v[100:103]
 s_add_u32 m0, s31, 49152
 v_mfma_f32_16x16x32_bf16 v[100:103], a[52:55], v[164:167], v[100:103]
 s_mov_b32 s34, 32768
 v_mfma_f32_16x16x32_bf16 v[104:107], a[40:43], v[160:163], v[104:107]
 buffer_load_dwordx4 v211, s[16:19], s34 offen nt lds
 v_mfma_f32_16x16x32_bf16 v[104:107], a[56:59], v[164:167], v[104:107]
 v_mfma_f32_16x16x32_bf16 v[108:111], a[44:47], v[160:163], v[108:111]
 buffer_load_dwordx4 v212, s[16:19], s34 offen offset:1024 nt lds
 v_mfma_f32_16x16x32_bf16 v[108:111], a[60:63], v[164:167], v[108:111]
 s_waitcnt vmcnt(15) lgkmcnt(0)
 s_barrier
 v_mfma_f32_16x16x32_bf16 v[0:3], a[0:3], v[112:115], v[0:3]
 ds_read_b128 v[136:139], v205 offset:0
 s_add_u32 m0, s33, 131072
 v_mfma_f32_16x16x32_bf16 v[0:3], a[16:19], v[116:119], v[0:3]
 s_bfe_u32 s29, s5, 262144
 v_mfma_f32_16x16x32_bf16 v[4:7], a[4:7], v[112:115], v[4:7]
 ds_read_b128 v[140:143], v206 offset:0
 s_lshl_b32 s29, s29, 19
 v_mfma_f32_16x16x32_bf16 v[4:7], a[20:23], v[116:119], v[4:7]
 v_mfma_f32_16x16x32_bf16 v[8:11], a[8:11], v[112:115], v[8:11]
 ds_read_b128 v[144:147], v205 offset:2048
 buffer_load_dwordx4 v199, s[12:15], s29 offen lds
 v_mfma_f32_16x16x32_bf16 v[8:11], a[24:27], v[116:119], v[8:11]
 v_mfma_f32_16x16x32_bf16 v[12:15], a[12:15], v[112:115], v[12:15]
 ds_read_b128 v[148:151], v206 offset:2048
 v_mfma_f32_16x16x32_bf16 v[12:15], a[28:31], v[116:119], v[12:15]
 buffer_load_dwordx4 v200, s[12:15], s29 offen offset:1024 lds
 v_mfma_f32_16x16x32_bf16 v[16:19], a[0:3], v[120:123], v[16:19]
 ds_read_b128 v[152:155], v205 offset:4096
 v_mfma_f32_16x16x32_bf16 v[16:19], a[16:19], v[124:127], v[16:19]
 v_mfma_f32_16x16x32_bf16 v[20:23], a[4:7], v[120:123], v[20:23]
 ds_read_b128 v[156:159], v206 offset:4096
 buffer_load_dwordx4 v201, s[12:15], s29 offen offset:2048 lds
 v_mfma_f32_16x16x32_bf16 v[20:23], a[20:23], v[124:127], v[20:23]
 v_mfma_f32_16x16x32_bf16 v[24:27], a[8:11], v[120:123], v[24:27]
 ds_read_b128 v[160:163], v205 offset:6144
 v_mfma_f32_16x16x32_bf16 v[24:27], a[24:27], v[124:127], v[24:27]
 buffer_load_dwordx4 v202, s[12:15], s29 offen offset:3072 lds
 v_mfma_f32_16x16x32_bf16 v[28:31], a[12:15], v[120:123], v[28:31]
 ds_read_b128 v[164:167], v206 offset:6144
 v_mfma_f32_16x16x32_bf16 v[28:31], a[28:31], v[124:127], v[28:31]
 s_add_u32 m0, s32, 73728
 v_mfma_f32_16x16x32_bf16 v[32:35], a[0:3], v[128:131], v[32:35]
 s_bfe_u32 s28, s5, 262144
 s_lshl_b32 s28, s28, 7
 v_mfma_f32_16x16x32_bf16 v[32:35], a[16:19], v[132:135], v[32:35]
 v_mfma_f32_16x16x32_bf16 v[36:39], a[4:7], v[128:131], v[36:39]
 buffer_load_dwordx4 v192, s[8:11], s28 offen lds
 v_mfma_f32_16x16x32_bf16 v[36:39], a[20:23], v[132:135], v[36:39]
 v_mfma_f32_16x16x32_bf16 v[40:43], a[8:11], v[128:131], v[40:43]
 buffer_load_dwordx4 v193, s[8:11], s28 offen offset:1024 lds
 v_mfma_f32_16x16x32_bf16 v[40:43], a[24:27], v[132:135], v[40:43]
 v_mfma_f32_16x16x32_bf16 v[44:47], a[12:15], v[128:131], v[44:47]
 buffer_load_dwordx4 v194, s[8:11], s28 offen offset:2048 lds
 v_mfma_f32_16x16x32_bf16 v[44:47], a[28:31], v[132:135], v[44:47]
 s_waitcnt vmcnt(15) lgkmcnt(0)
 s_barrier
 v_mfma_f32_16x16x32_bf16 v[48:51], a[0:3], v[136:139], v[48:51]
 ds_read_b64_tr_b16 a[32:33], v207 offset:16384
 s_add_u32 m0, s33, 98304
 v_mfma_f32_16x16x32_bf16 v[48:51], a[16:19], v[140:143], v[48:51]
 ds_read_b64_tr_b16 a[34:35], v207 offset:17408
 v_mfma_f32_16x16x32_bf16 v[52:55], a[4:7], v[136:139], v[52:55]
 ds_read_b64_tr_b16 a[36:37], v208 offset:16384
 v_mfma_f32_16x16x32_bf16 v[52:55], a[20:23], v[140:143], v[52:55]
 ds_read_b64_tr_b16 a[38:39], v208 offset:17408
 buffer_load_dwordx4 v195, s[8:11], s28 offen lds
 v_mfma_f32_16x16x32_bf16 v[56:59], a[8:11], v[136:139], v[56:59]
 ds_read_b64_tr_b16 a[40:41], v209 offset:16384
 v_mfma_f32_16x16x32_bf16 v[56:59], a[24:27], v[140:143], v[56:59]
 ds_read_b64_tr_b16 a[42:43], v209 offset:17408
 v_mfma_f32_16x16x32_bf16 v[60:63], a[12:15], v[136:139], v[60:63]
 buffer_load_dwordx4 v196, s[8:11], s28 offen offset:1024 lds
 v_mfma_f32_16x16x32_bf16 v[60:63], a[28:31], v[140:143], v[60:63]
 ds_read_b64_tr_b16 a[44:45], v210 offset:16384
 v_mfma_f32_16x16x32_bf16 v[64:67], a[0:3], v[144:147], v[64:67]
 ds_read_b64_tr_b16 a[46:47], v210 offset:17408
 v_mfma_f32_16x16x32_bf16 v[64:67], a[16:19], v[148:151], v[64:67]
 ds_read_b64_tr_b16 a[48:49], v207 offset:24576
 v_mfma_f32_16x16x32_bf16 v[68:71], a[4:7], v[144:147], v[68:71]
 ds_read_b64_tr_b16 a[50:51], v207 offset:25600
 v_mfma_f32_16x16x32_bf16 v[68:71], a[20:23], v[148:151], v[68:71]
 ds_read_b64_tr_b16 a[52:53], v208 offset:24576
 buffer_load_dwordx4 v197, s[8:11], s28 offen offset:2048 lds
 v_mfma_f32_16x16x32_bf16 v[72:75], a[8:11], v[144:147], v[72:75]
 v_mfma_f32_16x16x32_bf16 v[72:75], a[24:27], v[148:151], v[72:75]
 ds_read_b64_tr_b16 a[54:55], v208 offset:25600
 v_mfma_f32_16x16x32_bf16 v[76:79], a[12:15], v[144:147], v[76:79]
 ds_read_b64_tr_b16 a[56:57], v209 offset:24576
 buffer_load_dwordx4 v198, s[8:11], s28 offen offset:3072 lds
 v_mfma_f32_16x16x32_bf16 v[76:79], a[28:31], v[148:151], v[76:79]
 ds_read_b64_tr_b16 a[58:59], v209 offset:25600
 v_mfma_f32_16x16x32_bf16 v[80:83], a[0:3], v[152:155], v[80:83]
 ds_read_b64_tr_b16 a[60:61], v210 offset:24576
 v_mfma_f32_16x16x32_bf16 v[80:83], a[16:19], v[156:159], v[80:83]
 ds_read_b64_tr_b16 a[62:63], v210 offset:25600
 s_add_u32 m0, s31, 57344
 v_mfma_f32_16x16x32_bf16 v[84:87], a[4:7], v[152:155], v[84:87]
 ds_read_b128 v[112:115], v203 offset:12288
 v_mfma_f32_16x16x32_bf16 v[84:87], a[20:23], v[156:159], v[84:87]
 s_mov_b32 s34, 16384
 v_mfma_f32_16x16x32_bf16 v[88:91], a[8:11], v[152:155], v[88:91]
 ds_read_b128 v[116:119], v204 offset:12288
 buffer_load_dwordx4 v213, s[20:23], s34 offen nt lds
 v_mfma_f32_16x16x32_bf16 v[88:91], a[24:27], v[156:159], v[88:91]
 ds_read_b128 v[120:123], v203 offset:14336
 v_mfma_f32_16x16x32_bf16 v[92:95], a[12:15], v[152:155], v[92:95]
 ds_read_b128 v[124:127], v204 offset:14336
 v_mfma_f32_16x16x32_bf16 v[92:95], a[28:31], v[156:159], v[92:95]
 ds_read_b128 v[128:131], v203 offset:16384
 v_mfma_f32_16x16x32_bf16 v[96:99], a[0:3], v[160:163], v[96:99]
 ds_read_b128 v[132:135], v204 offset:16384
 v_mfma_f32_16x16x32_bf16 v[96:99], a[16:19], v[164:167], v[96:99]
 buffer_load_dwordx4 v213, s[20:23], s34 offen offset:1024 nt lds
 v_mfma_f32_16x16x32_bf16 v[100:103], a[4:7], v[160:163], v[100:103]
 s_add_u32 m0, s31, 65536
 v_mfma_f32_16x16x32_bf16 v[100:103], a[20:23], v[164:167], v[100:103]
 s_mov_b32 s34, 40960
 v_mfma_f32_16x16x32_bf16 v[104:107], a[8:11], v[160:163], v[104:107]
 buffer_load_dwordx4 v211, s[16:19], s34 offen nt lds
 v_mfma_f32_16x16x32_bf16 v[104:107], a[24:27], v[164:167], v[104:107]
 v_mfma_f32_16x16x32_bf16 v[108:111], a[12:15], v[160:163], v[108:111]
 buffer_load_dwordx4 v212, s[16:19], s34 offen offset:1024 nt lds
 v_mfma_f32_16x16x32_bf16 v[108:111], a[28:31], v[164:167], v[108:111]
 s_waitcnt vmcnt(19) lgkmcnt(0)
 s_barrier
 v_mfma_f32_16x16x32_bf16 v[0:3], a[32:35], v[112:115], v[0:3]
 ds_read_b128 v[136:139], v205 offset:16384
 s_add_u32 m0, s33, 147456
 v_mfma_f32_16x16x32_bf16 v[0:3], a[48:51], v[116:119], v[0:3]
 s_bfe_u32 s29, s5, 262148
 v_mfma_f32_16x16x32_bf16 v[4:7], a[36:39], v[112:115], v[4:7]
 ds_read_b128 v[140:143], v206 offset:16384
 s_lshl_b32 s29, s29, 19
 v_mfma_f32_16x16x32_bf16 v[4:7], a[52:55], v[116:119], v[4:7]
 v_mfma_f32_16x16x32_bf16 v[8:11], a[40:43], v[112:115], v[8:11]
 ds_read_b128 v[144:147], v205 offset:18432
 buffer_load_dwordx4 v199, s[12:15], s29 offen lds
 v_mfma_f32_16x16x32_bf16 v[8:11], a[56:59], v[116:119], v[8:11]
 v_mfma_f32_16x16x32_bf16 v[12:15], a[44:47], v[112:115], v[12:15]
 ds_read_b128 v[148:151], v206 offset:18432
 v_mfma_f32_16x16x32_bf16 v[12:15], a[60:63], v[116:119], v[12:15]
 buffer_load_dwordx4 v200, s[12:15], s29 offen offset:1024 lds
 v_mfma_f32_16x16x32_bf16 v[16:19], a[32:35], v[120:123], v[16:19]
 ds_read_b128 v[152:155], v205 offset:20480
 v_mfma_f32_16x16x32_bf16 v[16:19], a[48:51], v[124:127], v[16:19]
 v_mfma_f32_16x16x32_bf16 v[20:23], a[36:39], v[120:123], v[20:23]
 ds_read_b128 v[156:159], v206 offset:20480
 buffer_load_dwordx4 v201, s[12:15], s29 offen offset:2048 lds
 v_mfma_f32_16x16x32_bf16 v[20:23], a[52:55], v[124:127], v[20:23]
 v_mfma_f32_16x16x32_bf16 v[24:27], a[40:43], v[120:123], v[24:27]
 ds_read_b128 v[160:163], v205 offset:22528
 v_mfma_f32_16x16x32_bf16 v[24:27], a[56:59], v[124:127], v[24:27]
 buffer_load_dwordx4 v202, s[12:15], s29 offen offset:3072 lds
 v_mfma_f32_16x16x32_bf16 v[28:31], a[44:47], v[120:123], v[28:31]
 ds_read_b128 v[164:167], v206 offset:22528
 v_mfma_f32_16x16x32_bf16 v[28:31], a[60:63], v[124:127], v[28:31]
 s_add_u32 m0, s32, 86016
 v_mfma_f32_16x16x32_bf16 v[32:35], a[32:35], v[128:131], v[32:35]
 s_bfe_u32 s28, s5, 262148
 s_lshl_b32 s28, s28, 7
 v_mfma_f32_16x16x32_bf16 v[32:35], a[48:51], v[132:135], v[32:35]
 v_mfma_f32_16x16x32_bf16 v[36:39], a[36:39], v[128:131], v[36:39]
 buffer_load_dwordx4 v192, s[8:11], s28 offen lds
 v_mfma_f32_16x16x32_bf16 v[36:39], a[52:55], v[132:135], v[36:39]
 v_mfma_f32_16x16x32_bf16 v[40:43], a[40:43], v[128:131], v[40:43]
 buffer_load_dwordx4 v193, s[8:11], s28 offen offset:1024 lds
 v_mfma_f32_16x16x32_bf16 v[40:43], a[56:59], v[132:135], v[40:43]
 v_mfma_f32_16x16x32_bf16 v[44:47], a[44:47], v[128:131], v[44:47]
 buffer_load_dwordx4 v194, s[8:11], s28 offen offset:2048 lds
 v_mfma_f32_16x16x32_bf16 v[44:47], a[60:63], v[132:135], v[44:47]
 s_waitcnt vmcnt(15) lgkmcnt(0)
 s_barrier
 v_mfma_f32_16x16x32_bf16 v[48:51], a[32:35], v[136:139], v[48:51]
 ds_read_b64_tr_b16 a[0:1], v207 offset:0
 s_add_u32 m0, s33, 114688
 v_mfma_f32_16x16x32_bf16 v[48:51], a[48:51], v[140:143], v[48:51]
 ds_read_b64_tr_b16 a[2:3], v207 offset:1024
 v_mfma_f32_16x16x32_bf16 v[52:55], a[36:39], v[136:139], v[52:55]
 ds_read_b64_tr_b16 a[4:5], v208 offset:0
 v_mfma_f32_16x16x32_bf16 v[52:55], a[52:55], v[140:143], v[52:55]
 ds_read_b64_tr_b16 a[6:7], v208 offset:1024
 v_mfma_f32_16x16x32_bf16 v[56:59], a[40:43], v[136:139], v[56:59]
 ds_read_b64_tr_b16 a[8:9], v209 offset:0
 buffer_load_dwordx4 v195, s[8:11], s28 offen lds
 v_mfma_f32_16x16x32_bf16 v[56:59], a[56:59], v[140:143], v[56:59]
 ds_read_b64_tr_b16 a[10:11], v209 offset:1024
 v_mfma_f32_16x16x32_bf16 v[60:63], a[44:47], v[136:139], v[60:63]
 v_mfma_f32_16x16x32_bf16 v[60:63], a[60:63], v[140:143], v[60:63]
 ds_read_b64_tr_b16 a[12:13], v210 offset:0
 buffer_load_dwordx4 v196, s[8:11], s28 offen offset:1024 lds
 v_mfma_f32_16x16x32_bf16 v[64:67], a[32:35], v[144:147], v[64:67]
 ds_read_b64_tr_b16 a[14:15], v210 offset:1024
 v_mfma_f32_16x16x32_bf16 v[64:67], a[48:51], v[148:151], v[64:67]
 ds_read_b64_tr_b16 a[16:17], v207 offset:8192
 v_mfma_f32_16x16x32_bf16 v[68:71], a[36:39], v[144:147], v[68:71]
 ds_read_b64_tr_b16 a[18:19], v207 offset:9216
 v_mfma_f32_16x16x32_bf16 v[68:71], a[52:55], v[148:151], v[68:71]
 ds_read_b64_tr_b16 a[20:21], v208 offset:8192
 v_mfma_f32_16x16x32_bf16 v[72:75], a[40:43], v[144:147], v[72:75]
 buffer_load_dwordx4 v197, s[8:11], s28 offen offset:2048 lds
 v_mfma_f32_16x16x32_bf16 v[72:75], a[56:59], v[148:151], v[72:75]
 ds_read_b64_tr_b16 a[22:23], v208 offset:9216
 v_mfma_f32_16x16x32_bf16 v[76:79], a[44:47], v[144:147], v[76:79]
 ds_read_b64_tr_b16 a[24:25], v209 offset:8192
 v_mfma_f32_16x16x32_bf16 v[76:79], a[60:63], v[148:151], v[76:79]
 ds_read_b64_tr_b16 a[26:27], v209 offset:9216
 v_mfma_f32_16x16x32_bf16 v[80:83], a[32:35], v[152:155], v[80:83]
 ds_read_b64_tr_b16 a[28:29], v210 offset:8192
 buffer_load_dwordx4 v198, s[8:11], s28 offen offset:3072 lds
 v_mfma_f32_16x16x32_bf16 v[80:83], a[48:51], v[156:159], v[80:83]
 ds_read_b64_tr_b16 a[30:31], v210 offset:9216
 v_mfma_f32_16x16x32_bf16 v[84:87], a[36:39], v[152:155], v[84:87]
 ds_read_b128 v[112:115], v203 offset:0
 v_mfma_f32_16x16x32_bf16 v[84:87], a[52:55], v[156:159], v[84:87]
 s_mov_b32 s34, 24576
 v_mfma_f32_16x16x32_bf16 v[88:91], a[40:43], v[152:155], v[88:91]
 ds_read_b128 v[116:119], v204 offset:0
 v_mfma_f32_16x16x32_bf16 v[88:91], a[56:59], v[156:159], v[88:91]
 ds_read_b128 v[120:123], v203 offset:2048
 buffer_load_dwordx4 a[128:131], v213, s[20:23], s34 offen nt
 v_mfma_f32_16x16x32_bf16 v[92:95], a[44:47], v[152:155], v[92:95]
 ds_read_b128 v[124:127], v204 offset:2048
 v_mfma_f32_16x16x32_bf16 v[92:95], a[60:63], v[156:159], v[92:95]
 ds_read_b128 v[128:131], v203 offset:4096
 v_mfma_f32_16x16x32_bf16 v[96:99], a[32:35], v[160:163], v[96:99]
 ds_read_b128 v[132:135], v204 offset:4096
 v_mfma_f32_16x16x32_bf16 v[96:99], a[48:51], v[164:167], v[96:99]
 buffer_load_dwordx4 a[132:135], v213, s[20:23], s34 offen offset:1024 nt
 v_mfma_f32_16x16x32_bf16 v[100:103], a[36:39], v[160:163], v[100:103]
 s_mov_b32 s34, 49152
 v_mfma_f32_16x16x32_bf16 v[100:103], a[52:55], v[164:167], v[100:103]
 v_mfma_f32_16x16x32_bf16 v[104:107], a[40:43], v[160:163], v[104:107]
 buffer_load_dwordx4 a[136:139], v211, s[16:19], s34 offen nt
 v_mfma_f32_16x16x32_bf16 v[104:107], a[56:59], v[164:167], v[104:107]
 v_mfma_f32_16x16x32_bf16 v[108:111], a[44:47], v[160:163], v[108:111]
 buffer_load_dwordx4 a[140:143], v212, s[16:19], s34 offen offset:1024 nt
 v_mfma_f32_16x16x32_bf16 v[108:111], a[60:63], v[164:167], v[108:111]
 s_waitcnt vmcnt(19) lgkmcnt(0)
 s_barrier
 v_mfma_f32_16x16x32_bf16 v[0:3], a[0:3], v[112:115], v[0:3]
 ds_read_b128 v[136:139], v205 offset:0
 s_add_u32 m0, s33, 131072
 v_mfma_f32_16x16x32_bf16 v[0:3], a[16:19], v[116:119], v[0:3]
 s_bfe_u32 s29, s5, 262152
 v_mfma_f32_16x16x32_bf16 v[4:7], a[4:7], v[112:115], v[4:7]
 ds_read_b128 v[140:143], v206 offset:0
 s_lshl_b32 s29, s29, 19
 v_mfma_f32_16x16x32_bf16 v[4:7], a[20:23], v[116:119], v[4:7]
 v_mfma_f32_16x16x32_bf16 v[8:11], a[8:11], v[112:115], v[8:11]
 ds_read_b128 v[144:147], v205 offset:2048
 buffer_load_dwordx4 v199, s[12:15], s29 offen lds
 v_mfma_f32_16x16x32_bf16 v[8:11], a[24:27], v[116:119], v[8:11]
 v_mfma_f32_16x16x32_bf16 v[12:15], a[12:15], v[112:115], v[12:15]
 ds_read_b128 v[148:151], v206 offset:2048
 v_mfma_f32_16x16x32_bf16 v[12:15], a[28:31], v[116:119], v[12:15]
 buffer_load_dwordx4 v200, s[12:15], s29 offen offset:1024 lds
 v_mfma_f32_16x16x32_bf16 v[16:19], a[0:3], v[120:123], v[16:19]
 ds_read_b128 v[152:155], v205 offset:4096
 v_mfma_f32_16x16x32_bf16 v[16:19], a[16:19], v[124:127], v[16:19]
 v_mfma_f32_16x16x32_bf16 v[20:23], a[4:7], v[120:123], v[20:23]
 ds_read_b128 v[156:159], v206 offset:4096
 buffer_load_dwordx4 v201, s[12:15], s29 offen offset:2048 lds
 v_mfma_f32_16x16x32_bf16 v[20:23], a[20:23], v[124:127], v[20:23]
 v_mfma_f32_16x16x32_bf16 v[24:27], a[8:11], v[120:123], v[24:27]
 ds_read_b128 v[160:163], v205 offset:6144
 v_mfma_f32_16x16x32_bf16 v[24:27], a[24:27], v[124:127], v[24:27]
 buffer_load_dwordx4 v202, s[12:15], s29 offen offset:3072 lds
 v_mfma_f32_16x16x32_bf16 v[28:31], a[12:15], v[120:123], v[28:31]
 ds_read_b128 v[164:167], v206 offset:6144
 v_mfma_f32_16x16x32_bf16 v[28:31], a[28:31], v[124:127], v[28:31]
 s_add_u32 m0, s32, 73728
 v_mfma_f32_16x16x32_bf16 v[32:35], a[0:3], v[128:131], v[32:35]
 s_bfe_u32 s28, s5, 262152
 s_lshl_b32 s28, s28, 7
 v_mfma_f32_16x16x32_bf16 v[32:35], a[16:19], v[132:135], v[32:35]
 v_mfma_f32_16x16x32_bf16 v[36:39], a[4:7], v[128:131], v[36:39]
 buffer_load_dwordx4 v192, s[8:11], s28 offen lds
 v_mfma_f32_16x16x32_bf16 v[36:39], a[20:23], v[132:135], v[36:39]
 v_mfma_f32_16x16x32_bf16 v[40:43], a[8:11], v[128:131], v[40:43]
 buffer_load_dwordx4 v193, s[8:11], s28 offen offset:1024 lds
 v_mfma_f32_16x16x32_bf16 v[40:43], a[24:27], v[132:135], v[40:43]
 v_mfma_f32_16x16x32_bf16 v[44:47], a[12:15], v[128:131], v[44:47]
 buffer_load_dwordx4 v194, s[8:11], s28 offen offset:2048 lds
 v_mfma_f32_16x16x32_bf16 v[44:47], a[28:31], v[132:135], v[44:47]
 s_waitcnt vmcnt(15) lgkmcnt(0)
 s_barrier
 v_mfma_f32_16x16x32_bf16 v[48:51], a[0:3], v[136:139], v[48:51]
 ds_read_b64_tr_b16 a[32:33], v207 offset:16384
 v_mfma_f32_16x16x32_bf16 v[48:51], a[16:19], v[140:143], v[48:51]
 ds_read_b64_tr_b16 a[34:35], v207 offset:17408
 v_mfma_f32_16x16x32_bf16 v[52:55], a[4:7], v[136:139], v[52:55]
 ds_read_b64_tr_b16 a[36:37], v208 offset:16384
 v_mfma_f32_16x16x32_bf16 v[52:55], a[20:23], v[140:143], v[52:55]
 ds_read_b64_tr_b16 a[38:39], v208 offset:17408
 s_add_u32 m0, s33, 98304
 v_mfma_f32_16x16x32_bf16 v[56:59], a[8:11], v[136:139], v[56:59]
 ds_read_b64_tr_b16 a[40:41], v209 offset:16384
 v_mfma_f32_16x16x32_bf16 v[56:59], a[24:27], v[140:143], v[56:59]
 ds_read_b64_tr_b16 a[42:43], v209 offset:17408
 v_mfma_f32_16x16x32_bf16 v[60:63], a[12:15], v[136:139], v[60:63]
 v_mfma_f32_16x16x32_bf16 v[60:63], a[28:31], v[140:143], v[60:63]
 ds_read_b64_tr_b16 a[44:45], v210 offset:16384
 v_mfma_f32_16x16x32_bf16 v[64:67], a[0:3], v[144:147], v[64:67]
 ds_read_b64_tr_b16 a[46:47], v210 offset:17408
 v_mfma_f32_16x16x32_bf16 v[64:67], a[16:19], v[148:151], v[64:67]
 ds_read_b64_tr_b16 a[48:49], v207 offset:24576
 v_mfma_f32_16x16x32_bf16 v[68:71], a[4:7], v[144:147], v[68:71]
 ds_read_b64_tr_b16 a[50:51], v207 offset:25600
 v_mfma_f32_16x16x32_bf16 v[68:71], a[20:23], v[148:151], v[68:71]
 ds_read_b64_tr_b16 a[52:53], v208 offset:24576
 buffer_load_dwordx4 v195, s[8:11], s28 offen lds
 v_mfma_f32_16x16x32_bf16 v[72:75], a[8:11], v[144:147], v[72:75]
 v_mfma_f32_16x16x32_bf16 v[72:75], a[24:27], v[148:151], v[72:75]
 ds_read_b64_tr_b16 a[54:55], v208 offset:25600
 v_mfma_f32_16x16x32_bf16 v[76:79], a[12:15], v[144:147], v[76:79]
 ds_read_b64_tr_b16 a[56:57], v209 offset:24576
 v_mfma_f32_16x16x32_bf16 v[76:79], a[28:31], v[148:151], v[76:79]
 ds_read_b64_tr_b16 a[58:59], v209 offset:25600
 v_mfma_f32_16x16x32_bf16 v[80:83], a[0:3], v[152:155], v[80:83]
 ds_read_b64_tr_b16 a[60:61], v210 offset:24576
 v_mfma_f32_16x16x32_bf16 v[80:83], a[16:19], v[156:159], v[80:83]
 ds_read_b64_tr_b16 a[62:63], v210 offset:25600
 v_mfma_f32_16x16x32_bf16 v[84:87], a[4:7], v[152:155], v[84:87]
 ds_read_b128 v[112:115], v203 offset:12288
 v_mfma_f32_16x16x32_bf16 v[84:87], a[20:23], v[156:159], v[84:87]
 buffer_load_dwordx4 v196, s[8:11], s28 offen offset:1024 lds
 v_mfma_f32_16x16x32_bf16 v[88:91], a[8:11], v[152:155], v[88:91]
 ds_read_b128 v[116:119], v204 offset:12288
 v_mfma_f32_16x16x32_bf16 v[88:91], a[24:27], v[156:159], v[88:91]
 ds_read_b128 v[120:123], v203 offset:14336
 v_mfma_f32_16x16x32_bf16 v[92:95], a[12:15], v[152:155], v[92:95]
 ds_read_b128 v[124:127], v204 offset:14336
 v_mfma_f32_16x16x32_bf16 v[92:95], a[28:31], v[156:159], v[92:95]
 ds_read_b128 v[128:131], v203 offset:16384
 v_mfma_f32_16x16x32_bf16 v[96:99], a[0:3], v[160:163], v[96:99]
 ds_read_b128 v[132:135], v204 offset:16384
 v_mfma_f32_16x16x32_bf16 v[96:99], a[16:19], v[164:167], v[96:99]
 v_mfma_f32_16x16x32_bf16 v[100:103], a[4:7], v[160:163], v[100:103]
 v_mfma_f32_16x16x32_bf16 v[100:103], a[20:23], v[164:167], v[100:103]
 buffer_load_dwordx4 v197, s[8:11], s28 offen offset:2048 lds
 v_mfma_f32_16x16x32_bf16 v[104:107], a[8:11], v[160:163], v[104:107]
 v_mfma_f32_16x16x32_bf16 v[104:107], a[24:27], v[164:167], v[104:107]
 buffer_load_dwordx4 v198, s[8:11], s28 offen offset:3072 lds
 v_mfma_f32_16x16x32_bf16 v[108:111], a[12:15], v[160:163], v[108:111]
 v_mfma_f32_16x16x32_bf16 v[108:111], a[28:31], v[164:167], v[108:111]
 s_waitcnt vmcnt(15) lgkmcnt(0)
 s_barrier
 v_mfma_f32_16x16x32_bf16 v[0:3], a[32:35], v[112:115], v[0:3]
 ds_read_b128 v[136:139], v205 offset:16384
 s_add_u32 m0, s33, 147456
 v_mfma_f32_16x16x32_bf16 v[0:3], a[48:51], v[116:119], v[0:3]
 s_bfe_u32 s29, s5, 262156
 v_mfma_f32_16x16x32_bf16 v[4:7], a[36:39], v[112:115], v[4:7]
 ds_read_b128 v[140:143], v206 offset:16384
 s_lshl_b32 s29, s29, 19
 v_mfma_f32_16x16x32_bf16 v[4:7], a[52:55], v[116:119], v[4:7]
 v_mfma_f32_16x16x32_bf16 v[8:11], a[40:43], v[112:115], v[8:11]
 ds_read_b128 v[144:147], v205 offset:18432
 buffer_load_dwordx4 v199, s[12:15], s29 offen lds
 v_mfma_f32_16x16x32_bf16 v[8:11], a[56:59], v[116:119], v[8:11]
 v_mfma_f32_16x16x32_bf16 v[12:15], a[44:47], v[112:115], v[12:15]
 ds_read_b128 v[148:151], v206 offset:18432
 v_mfma_f32_16x16x32_bf16 v[12:15], a[60:63], v[116:119], v[12:15]
 buffer_load_dwordx4 v200, s[12:15], s29 offen offset:1024 lds
 v_mfma_f32_16x16x32_bf16 v[16:19], a[32:35], v[120:123], v[16:19]
 ds_read_b128 v[152:155], v205 offset:20480
 v_mfma_f32_16x16x32_bf16 v[16:19], a[48:51], v[124:127], v[16:19]
 v_mfma_f32_16x16x32_bf16 v[20:23], a[36:39], v[120:123], v[20:23]
 ds_read_b128 v[156:159], v206 offset:20480
 buffer_load_dwordx4 v201, s[12:15], s29 offen offset:2048 lds
 v_mfma_f32_16x16x32_bf16 v[20:23], a[52:55], v[124:127], v[20:23]
 v_mfma_f32_16x16x32_bf16 v[24:27], a[40:43], v[120:123], v[24:27]
 ds_read_b128 v[160:163], v205 offset:22528
 v_mfma_f32_16x16x32_bf16 v[24:27], a[56:59], v[124:127], v[24:27]
 buffer_load_dwordx4 v202, s[12:15], s29 offen offset:3072 lds
 v_mfma_f32_16x16x32_bf16 v[28:31], a[44:47], v[120:123], v[28:31]
 ds_read_b128 v[164:167], v206 offset:22528
 v_mfma_f32_16x16x32_bf16 v[28:31], a[60:63], v[124:127], v[28:31]
 s_add_u32 m0, s32, 86016
 v_mfma_f32_16x16x32_bf16 v[32:35], a[32:35], v[128:131], v[32:35]
 s_bfe_u32 s28, s5, 262156
 s_lshl_b32 s28, s28, 7
 v_mfma_f32_16x16x32_bf16 v[32:35], a[48:51], v[132:135], v[32:35]
 v_mfma_f32_16x16x32_bf16 v[36:39], a[36:39], v[128:131], v[36:39]
 buffer_load_dwordx4 v192, s[8:11], s28 offen lds
 v_mfma_f32_16x16x32_bf16 v[36:39], a[52:55], v[132:135], v[36:39]
 v_mfma_f32_16x16x32_bf16 v[40:43], a[40:43], v[128:131], v[40:43]
 buffer_load_dwordx4 v193, s[8:11], s28 offen offset:1024 lds
 v_mfma_f32_16x16x32_bf16 v[40:43], a[56:59], v[132:135], v[40:43]
 v_mfma_f32_16x16x32_bf16 v[44:47], a[44:47], v[128:131], v[44:47]
 buffer_load_dwordx4 v194, s[8:11], s28 offen offset:2048 lds
 v_mfma_f32_16x16x32_bf16 v[44:47], a[60:63], v[132:135], v[44:47]
 s_waitcnt vmcnt(11) lgkmcnt(0)
 s_barrier
 v_mfma_f32_16x16x32_bf16 v[48:51], a[32:35], v[136:139], v[48:51]
 ds_read_b64_tr_b16 a[0:1], v207 offset:0
 s_add_u32 m0, s33, 114688
 v_mfma_f32_16x16x32_bf16 v[48:51], a[48:51], v[140:143], v[48:51]
 ds_read_b64_tr_b16 a[2:3], v207 offset:1024
 v_mfma_f32_16x16x32_bf16 v[52:55], a[36:39], v[136:139], v[52:55]
 ds_read_b64_tr_b16 a[4:5], v208 offset:0
 v_mfma_f32_16x16x32_bf16 v[52:55], a[52:55], v[140:143], v[52:55]
 ds_read_b64_tr_b16 a[6:7], v208 offset:1024
 v_mfma_f32_16x16x32_bf16 v[56:59], a[40:43], v[136:139], v[56:59]
 ds_read_b64_tr_b16 a[8:9], v209 offset:0
 buffer_load_dwordx4 v195, s[8:11], s28 offen lds
 v_mfma_f32_16x16x32_bf16 v[56:59], a[56:59], v[140:143], v[56:59]
 ds_read_b64_tr_b16 a[10:11], v209 offset:1024
 v_mfma_f32_16x16x32_bf16 v[60:63], a[44:47], v[136:139], v[60:63]
 v_mfma_f32_16x16x32_bf16 v[60:63], a[60:63], v[140:143], v[60:63]
 ds_read_b64_tr_b16 a[12:13], v210 offset:0
 buffer_load_dwordx4 v196, s[8:11], s28 offen offset:1024 lds
 v_mfma_f32_16x16x32_bf16 v[64:67], a[32:35], v[144:147], v[64:67]
 ds_read_b64_tr_b16 a[14:15], v210 offset:1024
 v_mfma_f32_16x16x32_bf16 v[64:67], a[48:51], v[148:151], v[64:67]
 ds_read_b64_tr_b16 a[16:17], v207 offset:8192
 v_mfma_f32_16x16x32_bf16 v[68:71], a[36:39], v[144:147], v[68:71]
 ds_read_b64_tr_b16 a[18:19], v207 offset:9216
 v_mfma_f32_16x16x32_bf16 v[68:71], a[52:55], v[148:151], v[68:71]
 ds_read_b64_tr_b16 a[20:21], v208 offset:8192
 v_mfma_f32_16x16x32_bf16 v[72:75], a[40:43], v[144:147], v[72:75]
 buffer_load_dwordx4 v197, s[8:11], s28 offen offset:2048 lds
 v_mfma_f32_16x16x32_bf16 v[72:75], a[56:59], v[148:151], v[72:75]
 ds_read_b64_tr_b16 a[22:23], v208 offset:9216
 v_mfma_f32_16x16x32_bf16 v[76:79], a[44:47], v[144:147], v[76:79]
 ds_read_b64_tr_b16 a[24:25], v209 offset:8192
 v_mfma_f32_16x16x32_bf16 v[76:79], a[60:63], v[148:151], v[76:79]
 ds_read_b64_tr_b16 a[26:27], v209 offset:9216
 v_mfma_f32_16x16x32_bf16 v[80:83], a[32:35], v[152:155], v[80:83]
 ds_read_b64_tr_b16 a[28:29], v210 offset:8192
 buffer_load_dwordx4 v198, s[8:11], s28 offen offset:3072 lds
 v_mfma_f32_16x16x32_bf16 v[80:83], a[48:51], v[156:159], v[80:83]
 ds_read_b64_tr_b16 a[30:31], v210 offset:9216
 v_mfma_f32_16x16x32_bf16 v[84:87], a[36:39], v[152:155], v[84:87]
 ds_read_b128 v[112:115], v203 offset:0
 v_mfma_f32_16x16x32_bf16 v[84:87], a[52:55], v[156:159], v[84:87]
 s_mov_b32 s34, 32768
 v_mfma_f32_16x16x32_bf16 v[88:91], a[40:43], v[152:155], v[88:91]
 ds_read_b128 v[116:119], v204 offset:0
 v_mfma_f32_16x16x32_bf16 v[88:91], a[56:59], v[156:159], v[88:91]
 ds_read_b128 v[120:123], v203 offset:2048
 buffer_load_dwordx4 a[144:147], v213, s[20:23], s34 offen nt
 v_mfma_f32_16x16x32_bf16 v[92:95], a[44:47], v[152:155], v[92:95]
 ds_read_b128 v[124:127], v204 offset:2048
 v_mfma_f32_16x16x32_bf16 v[92:95], a[60:63], v[156:159], v[92:95]
 ds_read_b128 v[128:131], v203 offset:4096
 v_mfma_f32_16x16x32_bf16 v[96:99], a[32:35], v[160:163], v[96:99]
 ds_read_b128 v[132:135], v204 offset:4096
 v_mfma_f32_16x16x32_bf16 v[96:99], a[48:51], v[164:167], v[96:99]
 buffer_load_dwordx4 a[148:151], v213, s[20:23], s34 offen offset:1024 nt
 v_mfma_f32_16x16x32_bf16 v[100:103], a[36:39], v[160:163], v[100:103]
 s_mov_b32 s34, 57344
 v_mfma_f32_16x16x32_bf16 v[100:103], a[52:55], v[164:167], v[100:103]
 v_mfma_f32_16x16x32_bf16 v[104:107], a[40:43], v[160:163], v[104:107]
 buffer_load_dwordx4 a[152:155], v211, s[16:19], s34 offen nt
 v_mfma_f32_16x16x32_bf16 v[104:107], a[56:59], v[164:167], v[104:107]
 v_mfma_f32_16x16x32_bf16 v[108:111], a[44:47], v[160:163], v[108:111]
 buffer_load_dwordx4 a[156:159], v212, s[16:19], s34 offen offset:1024 nt
 v_mfma_f32_16x16x32_bf16 v[108:111], a[60:63], v[164:167], v[108:111]
 s_waitcnt vmcnt(15) lgkmcnt(0)
 s_barrier
 v_mfma_f32_16x16x32_bf16 v[0:3], a[0:3], v[112:115], v[0:3]
 ds_read_b128 v[136:139], v205 offset:0
 s_add_u32 m0, s33, 131072
 v_mfma_f32_16x16x32_bf16 v[0:3], a[16:19], v[116:119], v[0:3]
 s_bfe_u32 s29, s5, 262160
 v_mfma_f32_16x16x32_bf16 v[4:7], a[4:7], v[112:115], v[4:7]
 ds_read_b128 v[140:143], v206 offset:0
 s_lshl_b32 s29, s29, 19
 v_mfma_f32_16x16x32_bf16 v[4:7], a[20:23], v[116:119], v[4:7]
 v_mfma_f32_16x16x32_bf16 v[8:11], a[8:11], v[112:115], v[8:11]
 ds_read_b128 v[144:147], v205 offset:2048
 buffer_load_dwordx4 v199, s[12:15], s29 offen lds
 v_mfma_f32_16x16x32_bf16 v[8:11], a[24:27], v[116:119], v[8:11]
 v_mfma_f32_16x16x32_bf16 v[12:15], a[12:15], v[112:115], v[12:15]
 ds_read_b128 v[148:151], v206 offset:2048
 v_mfma_f32_16x16x32_bf16 v[12:15], a[28:31], v[116:119], v[12:15]
 buffer_load_dwordx4 v200, s[12:15], s29 offen offset:1024 lds
 v_mfma_f32_16x16x32_bf16 v[16:19], a[0:3], v[120:123], v[16:19]
 ds_read_b128 v[152:155], v205 offset:4096
 v_mfma_f32_16x16x32_bf16 v[16:19], a[16:19], v[124:127], v[16:19]
 v_mfma_f32_16x16x32_bf16 v[20:23], a[4:7], v[120:123], v[20:23]
 ds_read_b128 v[156:159], v206 offset:4096
 buffer_load_dwordx4 v201, s[12:15], s29 offen offset:2048 lds
 v_mfma_f32_16x16x32_bf16 v[20:23], a[20:23], v[124:127], v[20:23]
 v_mfma_f32_16x16x32_bf16 v[24:27], a[8:11], v[120:123], v[24:27]
 ds_read_b128 v[160:163], v205 offset:6144
 v_mfma_f32_16x16x32_bf16 v[24:27], a[24:27], v[124:127], v[24:27]
 buffer_load_dwordx4 v202, s[12:15], s29 offen offset:3072 lds
 v_mfma_f32_16x16x32_bf16 v[28:31], a[12:15], v[120:123], v[28:31]
 ds_read_b128 v[164:167], v206 offset:6144
 v_mfma_f32_16x16x32_bf16 v[28:31], a[28:31], v[124:127], v[28:31]
 s_add_u32 m0, s32, 73728
 v_mfma_f32_16x16x32_bf16 v[32:35], a[0:3], v[128:131], v[32:35]
 s_bfe_u32 s28, s5, 262160
 s_lshl_b32 s28, s28, 7
 v_mfma_f32_16x16x32_bf16 v[32:35], a[16:19], v[132:135], v[32:35]
 v_mfma_f32_16x16x32_bf16 v[36:39], a[4:7], v[128:131], v[36:39]
 buffer_load_dwordx4 v192, s[8:11], s28 offen lds
 v_mfma_f32_16x16x32_bf16 v[36:39], a[20:23], v[132:135], v[36:39]
 v_mfma_f32_16x16x32_bf16 v[40:43], a[8:11], v[128:131], v[40:43]
 buffer_load_dwordx4 v193, s[8:11], s28 offen offset:1024 lds
 v_mfma_f32_16x16x32_bf16 v[40:43], a[24:27], v[132:135], v[40:43]
 v_mfma_f32_16x16x32_bf16 v[44:47], a[12:15], v[128:131], v[44:47]
 buffer_load_dwordx4 v194, s[8:11], s28 offen offset:2048 lds
 v_mfma_f32_16x16x32_bf16 v[44:47], a[28:31], v[132:135], v[44:47]
 s_waitcnt vmcnt(15) lgkmcnt(0)
 s_barrier
 v_mfma_f32_16x16x32_bf16 v[48:51], a[0:3], v[136:139], v[48:51]
 ds_read_b64_tr_b16 a[32:33], v207 offset:16384
 s_add_u32 m0, s33, 98304
 v_mfma_f32_16x16x32_bf16 v[48:51], a[16:19], v[140:143], v[48:51]
 ds_read_b64_tr_b16 a[34:35], v207 offset:17408
 v_mfma_f32_16x16x32_bf16 v[52:55], a[4:7], v[136:139], v[52:55]
 ds_read_b64_tr_b16 a[36:37], v208 offset:16384
 v_mfma_f32_16x16x32_bf16 v[52:55], a[20:23], v[140:143], v[52:55]
 ds_read_b64_tr_b16 a[38:39], v208 offset:17408
 v_mfma_f32_16x16x32_bf16 v[56:59], a[8:11], v[136:139], v[56:59]
 ds_read_b64_tr_b16 a[40:41], v209 offset:16384
 buffer_load_dwordx4 v195, s[8:11], s28 offen lds
 v_mfma_f32_16x16x32_bf16 v[56:59], a[24:27], v[140:143], v[56:59]
 ds_read_b64_tr_b16 a[42:43], v209 offset:17408
 v_mfma_f32_16x16x32_bf16 v[60:63], a[12:15], v[136:139], v[60:63]
 v_mfma_f32_16x16x32_bf16 v[60:63], a[28:31], v[140:143], v[60:63]
 ds_read_b64_tr_b16 a[44:45], v210 offset:16384
 buffer_load_dwordx4 v196, s[8:11], s28 offen offset:1024 lds
 v_mfma_f32_16x16x32_bf16 v[64:67], a[0:3], v[144:147], v[64:67]
 ds_read_b64_tr_b16 a[46:47], v210 offset:17408
 v_mfma_f32_16x16x32_bf16 v[64:67], a[16:19], v[148:151], v[64:67]
 ds_read_b64_tr_b16 a[48:49], v207 offset:24576
 v_mfma_f32_16x16x32_bf16 v[68:71], a[4:7], v[144:147], v[68:71]
 ds_read_b64_tr_b16 a[50:51], v207 offset:25600
 v_mfma_f32_16x16x32_bf16 v[68:71], a[20:23], v[148:151], v[68:71]
 ds_read_b64_tr_b16 a[52:53], v208 offset:24576
 v_mfma_f32_16x16x32_bf16 v[72:75], a[8:11], v[144:147], v[72:75]
 buffer_load_dwordx4 v197, s[8:11], s28 offen offset:2048 lds
 v_mfma_f32_16x16x32_bf16 v[72:75], a[24:27], v[148:151], v[72:75]
 ds_read_b64_tr_b16 a[54:55], v208 offset:25600
 v_mfma_f32_16x16x32_bf16 v[76:79], a[12:15], v[144:147], v[76:79]
 ds_read_b64_tr_b16 a[56:57], v209 offset:24576
 v_mfma_f32_16x16x32_bf16 v[76:79], a[28:31], v[148:151], v[76:79]
 ds_read_b64_tr_b16 a[58:59], v209 offset:25600
 v_mfma_f32_16x16x32_bf16 v[80:83], a[0:3], v[152:155], v[80:83]
 ds_read_b64_tr_b16 a[60:61], v210 offset:24576
 buffer_load_dwordx4 v198, s[8:11], s28 offen offset:3072 lds
 v_mfma_f32_16x16x32_bf16 v[80:83], a[16:19], v[156:159], v[80:83]
 ds_read_b64_tr_b16 a[62:63], v210 offset:25600
 v_mfma_f32_16x16x32_bf16 v[84:87], a[4:7], v[152:155], v[84:87]
 ds_read_b128 v[112:115], v203 offset:12288
 v_mfma_f32_16x16x32_bf16 v[84:87], a[20:23], v[156:159], v[84:87]
 s_mov_b32 s34, 40960
 v_mfma_f32_16x16x32_bf16 v[88:91], a[8:11], v[152:155], v[88:91]
 ds_read_b128 v[116:119], v204 offset:12288
 v_mfma_f32_16x16x32_bf16 v[88:91], a[24:27], v[156:159], v[88:91]
 ds_read_b128 v[120:123], v203 offset:14336
 buffer_load_dwordx4 a[160:163], v213, s[20:23], s34 offen nt
 v_mfma_f32_16x16x32_bf16 v[92:95], a[12:15], v[152:155], v[92:95]
 ds_read_b128 v[124:127], v204 offset:14336
 v_mfma_f32_16x16x32_bf16 v[92:95], a[28:31], v[156:159], v[92:95]
 ds_read_b128 v[128:131], v203 offset:16384
 v_mfma_f32_16x16x32_bf16 v[96:99], a[0:3], v[160:163], v[96:99]
 ds_read_b128 v[132:135], v204 offset:16384
 v_mfma_f32_16x16x32_bf16 v[96:99], a[16:19], v[164:167], v[96:99]
 buffer_load_dwordx4 a[164:167], v213, s[20:23], s34 offen offset:1024 nt
 v_mfma_f32_16x16x32_bf16 v[100:103], a[4:7], v[160:163], v[100:103]
 s_mov_b32 s34, 65536
 v_mfma_f32_16x16x32_bf16 v[100:103], a[20:23], v[164:167], v[100:103]
 v_mfma_f32_16x16x32_bf16 v[104:107], a[8:11], v[160:163], v[104:107]
 buffer_load_dwordx4 a[168:171], v211, s[16:19], s34 offen nt
 v_mfma_f32_16x16x32_bf16 v[104:107], a[24:27], v[164:167], v[104:107]
 v_mfma_f32_16x16x32_bf16 v[108:111], a[12:15], v[160:163], v[108:111]
 buffer_load_dwordx4 a[172:175], v212, s[16:19], s34 offen offset:1024 nt
 v_mfma_f32_16x16x32_bf16 v[108:111], a[28:31], v[164:167], v[108:111]
 s_waitcnt vmcnt(19) lgkmcnt(0)
 s_barrier
 v_mfma_f32_16x16x32_bf16 v[0:3], a[32:35], v[112:115], v[0:3]
 ds_read_b128 v[136:139], v205 offset:16384
 s_add_u32 m0, s33, 147456
 v_mfma_f32_16x16x32_bf16 v[0:3], a[48:51], v[116:119], v[0:3]
 s_bfe_u32 s29, s5, 262164
 v_mfma_f32_16x16x32_bf16 v[4:7], a[36:39], v[112:115], v[4:7]
 ds_read_b128 v[140:143], v206 offset:16384
 s_lshl_b32 s29, s29, 19
 v_mfma_f32_16x16x32_bf16 v[4:7], a[52:55], v[116:119], v[4:7]
 v_mfma_f32_16x16x32_bf16 v[8:11], a[40:43], v[112:115], v[8:11]
 ds_read_b128 v[144:147], v205 offset:18432
 buffer_load_dwordx4 v199, s[12:15], s29 offen lds
 v_mfma_f32_16x16x32_bf16 v[8:11], a[56:59], v[116:119], v[8:11]
 v_mfma_f32_16x16x32_bf16 v[12:15], a[44:47], v[112:115], v[12:15]
 ds_read_b128 v[148:151], v206 offset:18432
 v_mfma_f32_16x16x32_bf16 v[12:15], a[60:63], v[116:119], v[12:15]
 buffer_load_dwordx4 v200, s[12:15], s29 offen offset:1024 lds
 v_mfma_f32_16x16x32_bf16 v[16:19], a[32:35], v[120:123], v[16:19]
 ds_read_b128 v[152:155], v205 offset:20480
 v_mfma_f32_16x16x32_bf16 v[16:19], a[48:51], v[124:127], v[16:19]
 v_mfma_f32_16x16x32_bf16 v[20:23], a[36:39], v[120:123], v[20:23]
 ds_read_b128 v[156:159], v206 offset:20480
 buffer_load_dwordx4 v201, s[12:15], s29 offen offset:2048 lds
 v_mfma_f32_16x16x32_bf16 v[20:23], a[52:55], v[124:127], v[20:23]
 v_mfma_f32_16x16x32_bf16 v[24:27], a[40:43], v[120:123], v[24:27]
 ds_read_b128 v[160:163], v205 offset:22528
 v_mfma_f32_16x16x32_bf16 v[24:27], a[56:59], v[124:127], v[24:27]
 buffer_load_dwordx4 v202, s[12:15], s29 offen offset:3072 lds
 v_mfma_f32_16x16x32_bf16 v[28:31], a[44:47], v[120:123], v[28:31]
 ds_read_b128 v[164:167], v206 offset:22528
 v_mfma_f32_16x16x32_bf16 v[28:31], a[60:63], v[124:127], v[28:31]
 s_add_u32 m0, s32, 86016
 v_mfma_f32_16x16x32_bf16 v[32:35], a[32:35], v[128:131], v[32:35]
 s_bfe_u32 s28, s5, 262164
 s_lshl_b32 s28, s28, 7
 v_mfma_f32_16x16x32_bf16 v[32:35], a[48:51], v[132:135], v[32:35]
 v_mfma_f32_16x16x32_bf16 v[36:39], a[36:39], v[128:131], v[36:39]
 buffer_load_dwordx4 v192, s[8:11], s28 offen lds
 v_mfma_f32_16x16x32_bf16 v[36:39], a[52:55], v[132:135], v[36:39]
 v_mfma_f32_16x16x32_bf16 v[40:43], a[40:43], v[128:131], v[40:43]
 buffer_load_dwordx4 v193, s[8:11], s28 offen offset:1024 lds
 v_mfma_f32_16x16x32_bf16 v[40:43], a[56:59], v[132:135], v[40:43]
 v_mfma_f32_16x16x32_bf16 v[44:47], a[44:47], v[128:131], v[44:47]
 buffer_load_dwordx4 v194, s[8:11], s28 offen offset:2048 lds
 v_mfma_f32_16x16x32_bf16 v[44:47], a[60:63], v[132:135], v[44:47]
 s_waitcnt vmcnt(15) lgkmcnt(0)
 s_barrier
 v_mfma_f32_16x16x32_bf16 v[48:51], a[32:35], v[136:139], v[48:51]
 ds_read_b64_tr_b16 a[0:1], v207 offset:0
 s_add_u32 m0, s33, 114688
 v_mfma_f32_16x16x32_bf16 v[48:51], a[48:51], v[140:143], v[48:51]
 ds_read_b64_tr_b16 a[2:3], v207 offset:1024
 v_mfma_f32_16x16x32_bf16 v[52:55], a[36:39], v[136:139], v[52:55]
 ds_read_b64_tr_b16 a[4:5], v208 offset:0
 v_mfma_f32_16x16x32_bf16 v[52:55], a[52:55], v[140:143], v[52:55]
 ds_read_b64_tr_b16 a[6:7], v208 offset:1024
 v_mfma_f32_16x16x32_bf16 v[56:59], a[40:43], v[136:139], v[56:59]
 ds_read_b64_tr_b16 a[8:9], v209 offset:0
 buffer_load_dwordx4 v195, s[8:11], s28 offen lds
 v_mfma_f32_16x16x32_bf16 v[56:59], a[56:59], v[140:143], v[56:59]
 ds_read_b64_tr_b16 a[10:11], v209 offset:1024
 v_mfma_f32_16x16x32_bf16 v[60:63], a[44:47], v[136:139], v[60:63]
 v_mfma_f32_16x16x32_bf16 v[60:63], a[60:63], v[140:143], v[60:63]
 ds_read_b64_tr_b16 a[12:13], v210 offset:0
 buffer_load_dwordx4 v196, s[8:11], s28 offen offset:1024 lds
 v_mfma_f32_16x16x32_bf16 v[64:67], a[32:35], v[144:147], v[64:67]
 ds_read_b64_tr_b16 a[14:15], v210 offset:1024
 v_mfma_f32_16x16x32_bf16 v[64:67], a[48:51], v[148:151], v[64:67]
 ds_read_b64_tr_b16 a[16:17], v207 offset:8192
 v_mfma_f32_16x16x32_bf16 v[68:71], a[36:39], v[144:147], v[68:71]
 ds_read_b64_tr_b16 a[18:19], v207 offset:9216
 v_mfma_f32_16x16x32_bf16 v[68:71], a[52:55], v[148:151], v[68:71]
 ds_read_b64_tr_b16 a[20:21], v208 offset:8192
 v_mfma_f32_16x16x32_bf16 v[72:75], a[40:43], v[144:147], v[72:75]
 buffer_load_dwordx4 v197, s[8:11], s28 offen offset:2048 lds
 v_mfma_f32_16x16x32_bf16 v[72:75], a[56:59], v[148:151], v[72:75]
 ds_read_b64_tr_b16 a[22:23], v208 offset:9216
 v_mfma_f32_16x16x32_bf16 v[76:79], a[44:47], v[144:147], v[76:79]
 ds_read_b64_tr_b16 a[24:25], v209 offset:8192
 v_mfma_f32_16x16x32_bf16 v[76:79], a[60:63], v[148:151], v[76:79]
 ds_read_b64_tr_b16 a[26:27], v209 offset:9216
 v_mfma_f32_16x16x32_bf16 v[80:83], a[32:35], v[152:155], v[80:83]
 ds_read_b64_tr_b16 a[28:29], v210 offset:8192
 buffer_load_dwordx4 v198, s[8:11], s28 offen offset:3072 lds
 v_mfma_f32_16x16x32_bf16 v[80:83], a[48:51], v[156:159], v[80:83]
 ds_read_b64_tr_b16 a[30:31], v210 offset:9216
 v_mfma_f32_16x16x32_bf16 v[84:87], a[36:39], v[152:155], v[84:87]
 ds_read_b128 v[112:115], v203 offset:0
 v_mfma_f32_16x16x32_bf16 v[84:87], a[52:55], v[156:159], v[84:87]
 s_mov_b32 s34, 49152
 v_mfma_f32_16x16x32_bf16 v[88:91], a[40:43], v[152:155], v[88:91]
 ds_read_b128 v[116:119], v204 offset:0
 v_mfma_f32_16x16x32_bf16 v[88:91], a[56:59], v[156:159], v[88:91]
 ds_read_b128 v[120:123], v203 offset:2048
 buffer_load_dwordx4 a[176:179], v213, s[20:23], s34 offen nt
 v_mfma_f32_16x16x32_bf16 v[92:95], a[44:47], v[152:155], v[92:95]
 ds_read_b128 v[124:127], v204 offset:2048
 v_mfma_f32_16x16x32_bf16 v[92:95], a[60:63], v[156:159], v[92:95]
 ds_read_b128 v[128:131], v203 offset:4096
 v_mfma_f32_16x16x32_bf16 v[96:99], a[32:35], v[160:163], v[96:99]
 ds_read_b128 v[132:135], v204 offset:4096
 v_mfma_f32_16x16x32_bf16 v[96:99], a[48:51], v[164:167], v[96:99]
 buffer_load_dwordx4 a[180:183], v213, s[20:23], s34 offen offset:1024 nt
 v_mfma_f32_16x16x32_bf16 v[100:103], a[36:39], v[160:163], v[100:103]
 s_mov_b32 s34, 73728
 v_mfma_f32_16x16x32_bf16 v[100:103], a[52:55], v[164:167], v[100:103]
 v_mfma_f32_16x16x32_bf16 v[104:107], a[40:43], v[160:163], v[104:107]
 buffer_load_dwordx4 a[184:187], v211, s[16:19], s34 offen nt
 v_mfma_f32_16x16x32_bf16 v[104:107], a[56:59], v[164:167], v[104:107]
 v_mfma_f32_16x16x32_bf16 v[108:111], a[44:47], v[160:163], v[108:111]
 buffer_load_dwordx4 a[188:191], v212, s[16:19], s34 offen offset:1024 nt
 v_mfma_f32_16x16x32_bf16 v[108:111], a[60:63], v[164:167], v[108:111]
 s_waitcnt vmcnt(19) lgkmcnt(0)
 s_barrier
 v_mfma_f32_16x16x32_bf16 v[0:3], a[0:3], v[112:115], v[0:3]
 ds_read_b128 v[136:139], v205 offset:0
 s_add_u32 m0, s33, 131072
 v_mfma_f32_16x16x32_bf16 v[0:3], a[16:19], v[116:119], v[0:3]
 s_bfe_u32 s29, s5, 262168
 v_mfma_f32_16x16x32_bf16 v[4:7], a[4:7], v[112:115], v[4:7]
 ds_read_b128 v[140:143], v206 offset:0
 s_lshl_b32 s29, s29, 19
 v_mfma_f32_16x16x32_bf16 v[4:7], a[20:23], v[116:119], v[4:7]
 v_mfma_f32_16x16x32_bf16 v[8:11], a[8:11], v[112:115], v[8:11]
 ds_read_b128 v[144:147], v205 offset:2048
 buffer_load_dwordx4 v199, s[12:15], s29 offen lds
 v_mfma_f32_16x16x32_bf16 v[8:11], a[24:27], v[116:119], v[8:11]
 v_mfma_f32_16x16x32_bf16 v[12:15], a[12:15], v[112:115], v[12:15]
 ds_read_b128 v[148:151], v206 offset:2048
 v_mfma_f32_16x16x32_bf16 v[12:15], a[28:31], v[116:119], v[12:15]
 buffer_load_dwordx4 v200, s[12:15], s29 offen offset:1024 lds
 v_mfma_f32_16x16x32_bf16 v[16:19], a[0:3], v[120:123], v[16:19]
 ds_read_b128 v[152:155], v205 offset:4096
 v_mfma_f32_16x16x32_bf16 v[16:19], a[16:19], v[124:127], v[16:19]
 v_mfma_f32_16x16x32_bf16 v[20:23], a[4:7], v[120:123], v[20:23]
 ds_read_b128 v[156:159], v206 offset:4096
 buffer_load_dwordx4 v201, s[12:15], s29 offen offset:2048 lds
 v_mfma_f32_16x16x32_bf16 v[20:23], a[20:23], v[124:127], v[20:23]
 v_mfma_f32_16x16x32_bf16 v[24:27], a[8:11], v[120:123], v[24:27]
 ds_read_b128 v[160:163], v205 offset:6144
 v_mfma_f32_16x16x32_bf16 v[24:27], a[24:27], v[124:127], v[24:27]
 buffer_load_dwordx4 v202, s[12:15], s29 offen offset:3072 lds
 v_mfma_f32_16x16x32_bf16 v[28:31], a[12:15], v[120:123], v[28:31]
 ds_read_b128 v[164:167], v206 offset:6144
 v_mfma_f32_16x16x32_bf16 v[28:31], a[28:31], v[124:127], v[28:31]
 s_add_u32 m0, s32, 73728
 v_mfma_f32_16x16x32_bf16 v[32:35], a[0:3], v[128:131], v[32:35]
 s_bfe_u32 s28, s5, 262168
 s_lshl_b32 s28, s28, 7
 v_mfma_f32_16x16x32_bf16 v[32:35], a[16:19], v[132:135], v[32:35]
 v_mfma_f32_16x16x32_bf16 v[36:39], a[4:7], v[128:131], v[36:39]
 buffer_load_dwordx4 v192, s[8:11], s28 offen lds
 v_mfma_f32_16x16x32_bf16 v[36:39], a[20:23], v[132:135], v[36:39]
 v_mfma_f32_16x16x32_bf16 v[40:43], a[8:11], v[128:131], v[40:43]
 buffer_load_dwordx4 v193, s[8:11], s28 offen offset:1024 lds
 v_mfma_f32_16x16x32_bf16 v[40:43], a[24:27], v[132:135], v[40:43]
 v_mfma_f32_16x16x32_bf16 v[44:47], a[12:15], v[128:131], v[44:47]
 buffer_load_dwordx4 v194, s[8:11], s28 offen offset:2048 lds
 v_mfma_f32_16x16x32_bf16 v[44:47], a[28:31], v[132:135], v[44:47]
 s_waitcnt vmcnt(15) lgkmcnt(0)
 s_barrier
 v_mfma_f32_16x16x32_bf16 v[48:51], a[0:3], v[136:139], v[48:51]
 ds_read_b64_tr_b16 a[32:33], v207 offset:16384
 v_mfma_f32_16x16x32_bf16 v[48:51], a[16:19], v[140:143], v[48:51]
 ds_read_b64_tr_b16 a[34:35], v207 offset:17408
 v_mfma_f32_16x16x32_bf16 v[52:55], a[4:7], v[136:139], v[52:55]
 ds_read_b64_tr_b16 a[36:37], v208 offset:16384
 v_mfma_f32_16x16x32_bf16 v[52:55], a[20:23], v[140:143], v[52:55]
 ds_read_b64_tr_b16 a[38:39], v208 offset:17408
 s_add_u32 m0, s33, 98304
 v_mfma_f32_16x16x32_bf16 v[56:59], a[8:11], v[136:139], v[56:59]
 ds_read_b64_tr_b16 a[40:41], v209 offset:16384
 v_mfma_f32_16x16x32_bf16 v[56:59], a[24:27], v[140:143], v[56:59]
 ds_read_b64_tr_b16 a[42:43], v209 offset:17408
 v_mfma_f32_16x16x32_bf16 v[60:63], a[12:15], v[136:139], v[60:63]
 v_mfma_f32_16x16x32_bf16 v[60:63], a[28:31], v[140:143], v[60:63]
 ds_read_b64_tr_b16 a[44:45], v210 offset:16384
 v_mfma_f32_16x16x32_bf16 v[64:67], a[0:3], v[144:147], v[64:67]
 ds_read_b64_tr_b16 a[46:47], v210 offset:17408
 v_mfma_f32_16x16x32_bf16 v[64:67], a[16:19], v[148:151], v[64:67]
 ds_read_b64_tr_b16 a[48:49], v207 offset:24576
 v_mfma_f32_16x16x32_bf16 v[68:71], a[4:7], v[144:147], v[68:71]
 ds_read_b64_tr_b16 a[50:51], v207 offset:25600
 v_mfma_f32_16x16x32_bf16 v[68:71], a[20:23], v[148:151], v[68:71]
 ds_read_b64_tr_b16 a[52:53], v208 offset:24576
 buffer_load_dwordx4 v195, s[8:11], s28 offen lds
 v_mfma_f32_16x16x32_bf16 v[72:75], a[8:11], v[144:147], v[72:75]
 v_mfma_f32_16x16x32_bf16 v[72:75], a[24:27], v[148:151], v[72:75]
 ds_read_b64_tr_b16 a[54:55], v208 offset:25600
 v_mfma_f32_16x16x32_bf16 v[76:79], a[12:15], v[144:147], v[76:79]
 ds_read_b64_tr_b16 a[56:57], v209 offset:24576
 v_mfma_f32_16x16x32_bf16 v[76:79], a[28:31], v[148:151], v[76:79]
 ds_read_b64_tr_b16 a[58:59], v209 offset:25600
 v_mfma_f32_16x16x32_bf16 v[80:83], a[0:3], v[152:155], v[80:83]
 ds_read_b64_tr_b16 a[60:61], v210 offset:24576
 v_mfma_f32_16x16x32_bf16 v[80:83], a[16:19], v[156:159], v[80:83]
 ds_read_b64_tr_b16 a[62:63], v210 offset:25600
 v_mfma_f32_16x16x32_bf16 v[84:87], a[4:7], v[152:155], v[84:87]
 ds_read_b128 v[112:115], v203 offset:12288
 v_mfma_f32_16x16x32_bf16 v[84:87], a[20:23], v[156:159], v[84:87]
 buffer_load_dwordx4 v196, s[8:11], s28 offen offset:1024 lds
 v_mfma_f32_16x16x32_bf16 v[88:91], a[8:11], v[152:155], v[88:91]
 ds_read_b128 v[116:119], v204 offset:12288
 v_mfma_f32_16x16x32_bf16 v[88:91], a[24:27], v[156:159], v[88:91]
 ds_read_b128 v[120:123], v203 offset:14336
 v_mfma_f32_16x16x32_bf16 v[92:95], a[12:15], v[152:155], v[92:95]
 ds_read_b128 v[124:127], v204 offset:14336
 v_mfma_f32_16x16x32_bf16 v[92:95], a[28:31], v[156:159], v[92:95]
 ds_read_b128 v[128:131], v203 offset:16384
 v_mfma_f32_16x16x32_bf16 v[96:99], a[0:3], v[160:163], v[96:99]
 ds_read_b128 v[132:135], v204 offset:16384
 v_mfma_f32_16x16x32_bf16 v[96:99], a[16:19], v[164:167], v[96:99]
 v_mfma_f32_16x16x32_bf16 v[100:103], a[4:7], v[160:163], v[100:103]
 v_mfma_f32_16x16x32_bf16 v[100:103], a[20:23], v[164:167], v[100:103]
 buffer_load_dwordx4 v197, s[8:11], s28 offen offset:2048 lds
 v_mfma_f32_16x16x32_bf16 v[104:107], a[8:11], v[160:163], v[104:107]
 v_mfma_f32_16x16x32_bf16 v[104:107], a[24:27], v[164:167], v[104:107]
 buffer_load_dwordx4 v198, s[8:11], s28 offen offset:3072 lds
 v_mfma_f32_16x16x32_bf16 v[108:111], a[12:15], v[160:163], v[108:111]
 v_mfma_f32_16x16x32_bf16 v[108:111], a[28:31], v[164:167], v[108:111]
 s_waitcnt vmcnt(15) lgkmcnt(0)
 s_barrier
 v_mfma_f32_16x16x32_bf16 v[0:3], a[32:35], v[112:115], v[0:3]
 ds_read_b128 v[136:139], v205 offset:16384
 s_add_u32 m0, s33, 147456
 v_mfma_f32_16x16x32_bf16 v[0:3], a[48:51], v[116:119], v[0:3]
 s_bfe_u32 s29, s5, 262172
 v_mfma_f32_16x16x32_bf16 v[4:7], a[36:39], v[112:115], v[4:7]
 ds_read_b128 v[140:143], v206 offset:16384
 s_lshl_b32 s29, s29, 19
 v_mfma_f32_16x16x32_bf16 v[4:7], a[52:55], v[116:119], v[4:7]
 v_mfma_f32_16x16x32_bf16 v[8:11], a[40:43], v[112:115], v[8:11]
 ds_read_b128 v[144:147], v205 offset:18432
 buffer_load_dwordx4 v199, s[12:15], s29 offen lds
 v_mfma_f32_16x16x32_bf16 v[8:11], a[56:59], v[116:119], v[8:11]
 v_mfma_f32_16x16x32_bf16 v[12:15], a[44:47], v[112:115], v[12:15]
 ds_read_b128 v[148:151], v206 offset:18432
 v_mfma_f32_16x16x32_bf16 v[12:15], a[60:63], v[116:119], v[12:15]
 buffer_load_dwordx4 v200, s[12:15], s29 offen offset:1024 lds
 v_mfma_f32_16x16x32_bf16 v[16:19], a[32:35], v[120:123], v[16:19]
 ds_read_b128 v[152:155], v205 offset:20480
 v_mfma_f32_16x16x32_bf16 v[16:19], a[48:51], v[124:127], v[16:19]
 v_mfma_f32_16x16x32_bf16 v[20:23], a[36:39], v[120:123], v[20:23]
 ds_read_b128 v[156:159], v206 offset:20480
 buffer_load_dwordx4 v201, s[12:15], s29 offen offset:2048 lds
 v_mfma_f32_16x16x32_bf16 v[20:23], a[52:55], v[124:127], v[20:23]
 v_mfma_f32_16x16x32_bf16 v[24:27], a[40:43], v[120:123], v[24:27]
 ds_read_b128 v[160:163], v205 offset:22528
 v_mfma_f32_16x16x32_bf16 v[24:27], a[56:59], v[124:127], v[24:27]
 buffer_load_dwordx4 v202, s[12:15], s29 offen offset:3072 lds
 v_mfma_f32_16x16x32_bf16 v[28:31], a[44:47], v[120:123], v[28:31]
 ds_read_b128 v[164:167], v206 offset:22528
 v_mfma_f32_16x16x32_bf16 v[28:31], a[60:63], v[124:127], v[28:31]
 s_add_u32 m0, s32, 86016
 v_mfma_f32_16x16x32_bf16 v[32:35], a[32:35], v[128:131], v[32:35]
 s_bfe_u32 s28, s5, 262172
 s_lshl_b32 s28, s28, 7
 v_mfma_f32_16x16x32_bf16 v[32:35], a[48:51], v[132:135], v[32:35]
 v_mfma_f32_16x16x32_bf16 v[36:39], a[36:39], v[128:131], v[36:39]
 buffer_load_dwordx4 v192, s[8:11], s28 offen lds
 v_mfma_f32_16x16x32_bf16 v[36:39], a[52:55], v[132:135], v[36:39]
 v_mfma_f32_16x16x32_bf16 v[40:43], a[40:43], v[128:131], v[40:43]
 buffer_load_dwordx4 v193, s[8:11], s28 offen offset:1024 lds
 v_mfma_f32_16x16x32_bf16 v[40:43], a[56:59], v[132:135], v[40:43]
 v_mfma_f32_16x16x32_bf16 v[44:47], a[44:47], v[128:131], v[44:47]
 buffer_load_dwordx4 v194, s[8:11], s28 offen offset:2048 lds
 v_mfma_f32_16x16x32_bf16 v[44:47], a[60:63], v[132:135], v[44:47]
 s_waitcnt vmcnt(11) lgkmcnt(0)
 s_barrier
 v_mfma_f32_16x16x32_bf16 v[48:51], a[32:35], v[136:139], v[48:51]
 ds_read_b64_tr_b16 a[0:1], v207 offset:0
 s_add_u32 m0, s33, 114688
 v_mfma_f32_16x16x32_bf16 v[48:51], a[48:51], v[140:143], v[48:51]
 ds_read_b64_tr_b16 a[2:3], v207 offset:1024
 v_mfma_f32_16x16x32_bf16 v[52:55], a[36:39], v[136:139], v[52:55]
 ds_read_b64_tr_b16 a[4:5], v208 offset:0
 v_mfma_f32_16x16x32_bf16 v[52:55], a[52:55], v[140:143], v[52:55]
 ds_read_b64_tr_b16 a[6:7], v208 offset:1024
 buffer_load_dwordx4 v195, s[8:11], s28 offen lds
 v_mfma_f32_16x16x32_bf16 v[56:59], a[40:43], v[136:139], v[56:59]
 ds_read_b64_tr_b16 a[8:9], v209 offset:0
 v_mfma_f32_16x16x32_bf16 v[56:59], a[56:59], v[140:143], v[56:59]
 ds_read_b64_tr_b16 a[10:11], v209 offset:1024
 v_mfma_f32_16x16x32_bf16 v[60:63], a[44:47], v[136:139], v[60:63]
 buffer_load_dwordx4 v196, s[8:11], s28 offen offset:1024 lds
 v_mfma_f32_16x16x32_bf16 v[60:63], a[60:63], v[140:143], v[60:63]
 ds_read_b64_tr_b16 a[12:13], v210 offset:0
 v_mfma_f32_16x16x32_bf16 v[64:67], a[32:35], v[144:147], v[64:67]
 ds_read_b64_tr_b16 a[14:15], v210 offset:1024
 v_mfma_f32_16x16x32_bf16 v[64:67], a[48:51], v[148:151], v[64:67]
 ds_read_b64_tr_b16 a[16:17], v207 offset:8192
 buffer_load_dwordx4 v197, s[8:11], s28 offen offset:2048 lds
 v_mfma_f32_16x16x32_bf16 v[68:71], a[36:39], v[144:147], v[68:71]
 ds_read_b64_tr_b16 a[18:19], v207 offset:9216
 v_mfma_f32_16x16x32_bf16 v[68:71], a[52:55], v[148:151], v[68:71]
 ds_read_b64_tr_b16 a[20:21], v208 offset:8192
 v_mfma_f32_16x16x32_bf16 v[72:75], a[40:43], v[144:147], v[72:75]
 buffer_load_dwordx4 v198, s[8:11], s28 offen offset:3072 lds
 v_mfma_f32_16x16x32_bf16 v[72:75], a[56:59], v[148:151], v[72:75]
 ds_read_b64_tr_b16 a[22:23], v208 offset:9216
 v_mfma_f32_16x16x32_bf16 v[76:79], a[44:47], v[144:147], v[76:79]
 ds_read_b64_tr_b16 a[24:25], v209 offset:8192
 s_mov_b32 s34, 57344
 v_mfma_f32_16x16x32_bf16 v[76:79], a[60:63], v[148:151], v[76:79]
 ds_read_b64_tr_b16 a[26:27], v209 offset:9216
 v_mfma_f32_16x16x32_bf16 v[80:83], a[32:35], v[152:155], v[80:83]
 ds_read_b64_tr_b16 a[28:29], v210 offset:8192
 buffer_load_dwordx4 a[192:195], v213, s[20:23], s34 offen nt
 v_mfma_f32_16x16x32_bf16 v[80:83], a[48:51], v[156:159], v[80:83]
 ds_read_b64_tr_b16 a[30:31], v210 offset:9216
 v_mfma_f32_16x16x32_bf16 v[84:87], a[36:39], v[152:155], v[84:87]
 ds_read_b128 v[112:115], v203 offset:0
 v_mfma_f32_16x16x32_bf16 v[84:87], a[52:55], v[156:159], v[84:87]
 buffer_load_dwordx4 a[196:199], v213, s[20:23], s34 offen offset:1024 nt
 v_mfma_f32_16x16x32_bf16 v[88:91], a[40:43], v[152:155], v[88:91]
 ds_read_b128 v[116:119], v204 offset:0
 v_mfma_f32_16x16x32_bf16 v[88:91], a[56:59], v[156:159], v[88:91]
 ds_read_b128 v[120:123], v203 offset:2048
 s_mov_b32 s34, 81920
 v_mfma_f32_16x16x32_bf16 v[92:95], a[44:47], v[152:155], v[92:95]
 ds_read_b128 v[124:127], v204 offset:2048
 v_mfma_f32_16x16x32_bf16 v[92:95], a[60:63], v[156:159], v[92:95]
 ds_read_b128 v[128:131], v203 offset:4096
 v_mfma_f32_16x16x32_bf16 v[96:99], a[32:35], v[160:163], v[96:99]
 ds_read_b128 v[132:135], v204 offset:4096
 buffer_load_dwordx4 a[200:203], v211, s[16:19], s34 offen nt
 v_mfma_f32_16x16x32_bf16 v[96:99], a[48:51], v[164:167], v[96:99]
 v_mfma_f32_16x16x32_bf16 v[100:103], a[36:39], v[160:163], v[100:103]
 buffer_load_dwordx4 a[204:207], v212, s[16:19], s34 offen offset:1024 nt
 v_mfma_f32_16x16x32_bf16 v[100:103], a[52:55], v[164:167], v[100:103]
 s_mov_b32 s34, 65536
 v_mfma_f32_16x16x32_bf16 v[104:107], a[40:43], v[160:163], v[104:107]
 buffer_load_dwordx4 a[208:211], v213, s[20:23], s34 offen nt
 v_mfma_f32_16x16x32_bf16 v[104:107], a[56:59], v[164:167], v[104:107]
 v_mfma_f32_16x16x32_bf16 v[108:111], a[44:47], v[160:163], v[108:111]
 buffer_load_dwordx4 a[212:215], v213, s[20:23], s34 offen offset:1024 nt
 v_mfma_f32_16x16x32_bf16 v[108:111], a[60:63], v[164:167], v[108:111]
 s_waitcnt vmcnt(17) lgkmcnt(0)
 s_barrier
 v_mfma_f32_16x16x32_bf16 v[0:3], a[0:3], v[112:115], v[0:3]
 ds_read_b128 v[136:139], v205 offset:0
 v_mfma_f32_16x16x32_bf16 v[0:3], a[16:19], v[116:119], v[0:3]
 s_and_b32 s52, s2, 7
 v_mfma_f32_16x16x32_bf16 v[4:7], a[4:7], v[112:115], v[4:7]
 ds_read_b128 v[140:143], v206 offset:0
 s_lshl_b32 s52, s52, 2
 v_mfma_f32_16x16x32_bf16 v[4:7], a[20:23], v[116:119], v[4:7]
 s_add_u32 s52, s52, s51
 v_mfma_f32_16x16x32_bf16 v[8:11], a[8:11], v[112:115], v[8:11]
 ds_read_b128 v[144:147], v205 offset:2048
 v_mfma_f32_16x16x32_bf16 v[8:11], a[24:27], v[116:119], v[8:11]
 s_mul_i32 s52, s52, 458752
 v_mfma_f32_16x16x32_bf16 v[12:15], a[12:15], v[112:115], v[12:15]
 ds_read_b128 v[148:151], v206 offset:2048
 s_add_u32 s8, s88, s52
 s_addc_u32 s9, s89, 0
 v_mfma_f32_16x16x32_bf16 v[12:15], a[28:31], v[116:119], v[12:15]
 s_mov_b32 s10, 458752
 v_mfma_f32_16x16x32_bf16 v[16:19], a[0:3], v[120:123], v[16:19]
 ds_read_b128 v[152:155], v205 offset:4096
 v_mfma_f32_16x16x32_bf16 v[16:19], a[16:19], v[124:127], v[16:19]
 s_mov_b32 s11, 0x20000
 v_mfma_f32_16x16x32_bf16 v[20:23], a[4:7], v[120:123], v[20:23]
 ds_read_b128 v[156:159], v206 offset:4096
 s_mul_i32 s53, s50, 57344
 v_mfma_f32_16x16x32_bf16 v[20:23], a[20:23], v[124:127], v[20:23]
 s_add_u32 s52, s52, s53
 v_mfma_f32_16x16x32_bf16 v[24:27], a[8:11], v[120:123], v[24:27]
 ds_read_b128 v[160:163], v205 offset:6144
 v_mfma_f32_16x16x32_bf16 v[24:27], a[24:27], v[124:127], v[24:27]
 s_add_u32 s24, s88, s52
 s_addc_u32 s25, s89, 0
 v_mfma_f32_16x16x32_bf16 v[28:31], a[12:15], v[120:123], v[28:31]
 ds_read_b128 v[164:167], v206 offset:6144
 v_mfma_f32_16x16x32_bf16 v[28:31], a[28:31], v[124:127], v[28:31]
 s_mov_b32 s26, 57344
 v_mfma_f32_16x16x32_bf16 v[32:35], a[0:3], v[128:131], v[32:35]
 s_mov_b32 s27, 0x20000
 s_lshl_b32 s52, s49, 21
 v_mfma_f32_16x16x32_bf16 v[32:35], a[16:19], v[132:135], v[32:35]
 s_lshl_b32 s53, s37, 8
 v_mfma_f32_16x16x32_bf16 v[36:39], a[4:7], v[128:131], v[36:39]
 s_add_u32 s52, s52, s53
 v_mfma_f32_16x16x32_bf16 v[36:39], a[20:23], v[132:135], v[36:39]
 s_add_u32 s12, s72, s52
 s_addc_u32 s13, s73, 0
 v_mfma_f32_16x16x32_bf16 v[40:43], a[8:11], v[128:131], v[40:43]
 s_mov_b32 s14, 2095360
 v_mfma_f32_16x16x32_bf16 v[40:43], a[24:27], v[132:135], v[40:43]
 s_mov_b32 s15, 0x20000
 s_lshl_b32 s52, s48, 2
 v_mfma_f32_16x16x32_bf16 v[44:47], a[12:15], v[128:131], v[44:47]
 s_add_u32 s52, s52, s51
 v_mfma_f32_16x16x32_bf16 v[44:47], a[28:31], v[132:135], v[44:47]
 s_waitcnt vmcnt(10) lgkmcnt(0)
 s_barrier
 v_mfma_f32_16x16x32_bf16 v[48:51], a[0:3], v[136:139], v[48:51]
 ds_read_b64_tr_b16 a[32:33], v207 offset:16384
 v_mfma_f32_16x16x32_bf16 v[48:51], a[16:19], v[140:143], v[48:51]
 ds_read_b64_tr_b16 a[34:35], v207 offset:17408
 s_mov_b32 s34, 90112
 v_mfma_f32_16x16x32_bf16 v[52:55], a[4:7], v[136:139], v[52:55]
 ds_read_b64_tr_b16 a[36:37], v208 offset:16384
 v_mfma_f32_16x16x32_bf16 v[52:55], a[20:23], v[140:143], v[52:55]
 ds_read_b64_tr_b16 a[38:39], v208 offset:17408
 s_lshl_b32 s52, s52, 3
 v_mfma_f32_16x16x32_bf16 v[56:59], a[8:11], v[136:139], v[56:59]
 ds_read_b64_tr_b16 a[40:41], v209 offset:16384
 v_mfma_f32_16x16x32_bf16 v[56:59], a[24:27], v[140:143], v[56:59]
 ds_read_b64_tr_b16 a[42:43], v209 offset:17408
 v_mfma_f32_16x16x32_bf16 v[60:63], a[12:15], v[136:139], v[60:63]
 buffer_load_dwordx4 a[216:219], v211, s[16:19], s34 offen nt
 v_mfma_f32_16x16x32_bf16 v[60:63], a[28:31], v[140:143], v[60:63]
 ds_read_b64_tr_b16 a[44:45], v210 offset:16384
 v_mfma_f32_16x16x32_bf16 v[64:67], a[0:3], v[144:147], v[64:67]
 ds_read_b64_tr_b16 a[46:47], v210 offset:17408
 s_add_u32 s52, s52, s37
 v_mfma_f32_16x16x32_bf16 v[64:67], a[16:19], v[148:151], v[64:67]
 ds_read_b64_tr_b16 a[48:49], v207 offset:24576
 v_mfma_f32_16x16x32_bf16 v[68:71], a[4:7], v[144:147], v[68:71]
 ds_read_b64_tr_b16 a[50:51], v207 offset:25600
 v_mfma_f32_16x16x32_bf16 v[68:71], a[20:23], v[148:151], v[68:71]
 ds_read_b64_tr_b16 a[52:53], v208 offset:24576
 buffer_load_dwordx4 a[220:223], v212, s[16:19], s34 offen offset:1024 nt
 v_mfma_f32_16x16x32_bf16 v[72:75], a[8:11], v[144:147], v[72:75]
 s_add_u32 s52, s52, 32
 v_mfma_f32_16x16x32_bf16 v[72:75], a[24:27], v[148:151], v[72:75]
 ds_read_b64_tr_b16 a[54:55], v208 offset:25600
 s_lshl_b32 s52, s52, 7
 v_mfma_f32_16x16x32_bf16 v[76:79], a[12:15], v[144:147], v[76:79]
 ds_read_b64_tr_b16 a[56:57], v209 offset:24576
 s_mov_b32 s34, 73728
 v_mfma_f32_16x16x32_bf16 v[76:79], a[28:31], v[148:151], v[76:79]
 ds_read_b64_tr_b16 a[58:59], v209 offset:25600
 v_mfma_f32_16x16x32_bf16 v[80:83], a[0:3], v[152:155], v[80:83]
 ds_read_b64_tr_b16 a[60:61], v210 offset:24576
 v_mfma_f32_16x16x32_bf16 v[80:83], a[16:19], v[156:159], v[80:83]
 ds_read_b64_tr_b16 a[62:63], v210 offset:25600
 v_mfma_f32_16x16x32_bf16 v[84:87], a[4:7], v[152:155], v[84:87]
 ds_read_b128 v[112:115], v203 offset:12288
 s_add_u32 s52, s52, 67108864
 v_mfma_f32_16x16x32_bf16 v[84:87], a[20:23], v[156:159], v[84:87]
 buffer_load_dwordx4 a[224:227], v213, s[20:23], s34 offen nt
 v_mfma_f32_16x16x32_bf16 v[88:91], a[8:11], v[152:155], v[88:91]
 ds_read_b128 v[116:119], v204 offset:12288
 v_mfma_f32_16x16x32_bf16 v[88:91], a[24:27], v[156:159], v[88:91]
 ds_read_b128 v[120:123], v203 offset:14336
 v_mfma_f32_16x16x32_bf16 v[92:95], a[12:15], v[152:155], v[92:95]
 ds_read_b128 v[124:127], v204 offset:14336
 v_mfma_f32_16x16x32_bf16 v[92:95], a[28:31], v[156:159], v[92:95]
 ds_read_b128 v[128:131], v203 offset:16384
 v_mfma_f32_16x16x32_bf16 v[96:99], a[0:3], v[160:163], v[96:99]
 ds_read_b128 v[132:135], v204 offset:16384
 buffer_load_dwordx4 a[228:231], v213, s[20:23], s34 offen offset:1024 nt
 v_mfma_f32_16x16x32_bf16 v[96:99], a[16:19], v[164:167], v[96:99]
 s_add_u32 s96, s88, s52
 s_addc_u32 s97, s89, 0
 v_mfma_f32_16x16x32_bf16 v[100:103], a[4:7], v[160:163], v[100:103]
 s_mov_b32 s34, 98304
 v_mfma_f32_16x16x32_bf16 v[100:103], a[20:23], v[164:167], v[100:103]
 buffer_load_dwordx4 a[232:235], v211, s[16:19], s34 offen nt
 v_mfma_f32_16x16x32_bf16 v[104:107], a[8:11], v[160:163], v[104:107]
 s_mov_b32 s98, 32
 v_mfma_f32_16x16x32_bf16 v[104:107], a[24:27], v[164:167], v[104:107]
 buffer_load_dwordx4 a[236:239], v212, s[16:19], s34 offen offset:1024 nt
 v_mfma_f32_16x16x32_bf16 v[108:111], a[12:15], v[160:163], v[108:111]
 s_mov_b32 s99, 0x20000
 v_lshrrev_b32 v185, 4, v184
 v_mfma_f32_16x16x32_bf16 v[108:111], a[28:31], v[164:167], v[108:111]
 v_bfe_u32 v186, v184, 1, 3
 s_waitcnt vmcnt(12) lgkmcnt(0)
 s_barrier
 v_mfma_f32_16x16x32_bf16 v[0:3], a[32:35], v[112:115], v[0:3]
 ds_read_b128 v[136:139], v205 offset:16384
 v_mfma_f32_16x16x32_bf16 v[0:3], a[48:51], v[116:119], v[0:3]
 v_and_b32 v187, 1, v184
 v_xor_b32 v186, v186, v185
 v_mfma_f32_16x16x32_bf16 v[4:7], a[36:39], v[112:115], v[4:7]
 ds_read_b128 v[140:143], v206 offset:16384
 v_lshl_add_u32 v186, v186, 1, v187
 v_mfma_f32_16x16x32_bf16 v[4:7], a[52:55], v[116:119], v[4:7]
 v_lshlrev_b32 v186, 4, v186
 v_mfma_f32_16x16x32_bf16 v[8:11], a[40:43], v[112:115], v[8:11]
 ds_read_b128 v[144:147], v205 offset:18432
 v_lshl_add_u32 v186, v185, 11, v186
 v_mfma_f32_16x16x32_bf16 v[8:11], a[56:59], v[116:119], v[8:11]
 v_xor_b32 v187, 128, v186
 s_mul_i32 s54, s30, 32768
 v_mfma_f32_16x16x32_bf16 v[12:15], a[44:47], v[112:115], v[12:15]
 ds_read_b128 v[148:151], v206 offset:18432
 v_add_u32 v199, s54, v186
 v_mfma_f32_16x16x32_bf16 v[12:15], a[60:63], v[116:119], v[12:15]
 s_add_u32 s54, s54, 7168
 v_mfma_f32_16x16x32_bf16 v[16:19], a[32:35], v[120:123], v[16:19]
 ds_read_b128 v[152:155], v205 offset:20480
 v_add_u32 v200, s54, v187
 v_mfma_f32_16x16x32_bf16 v[16:19], a[48:51], v[124:127], v[16:19]
 s_add_u32 s54, s54, 7168
 v_add_u32 v201, s54, v186
 v_mfma_f32_16x16x32_bf16 v[20:23], a[36:39], v[120:123], v[20:23]
 ds_read_b128 v[156:159], v206 offset:20480
 s_add_u32 s54, s54, 7168
 v_mfma_f32_16x16x32_bf16 v[20:23], a[52:55], v[124:127], v[20:23]
 v_add_u32 v202, s54, v187
 s_lshr_b32 s52, s30, 1
 v_mfma_f32_16x16x32_bf16 v[24:27], a[40:43], v[120:123], v[24:27]
 ds_read_b128 v[160:163], v205 offset:22528
 v_mfma_f32_16x16x32_bf16 v[24:27], a[56:59], v[124:127], v[24:27]
 s_and_b32 s53, s30, 1
 v_lshlrev_b32 v194, 4, v184
 v_mfma_f32_16x16x32_bf16 v[28:31], a[44:47], v[120:123], v[28:31]
 ds_read_b128 v[164:167], v206 offset:22528
 v_add_u32 v192, s33, v194
 v_mfma_f32_16x16x32_bf16 v[28:31], a[60:63], v[124:127], v[28:31]
 s_cmp_eq_u32 s30, 3
 s_cselect_b32 s54, 1073741824, 0
 v_mfma_f32_16x16x32_bf16 v[32:35], a[32:35], v[128:131], v[32:35]
 v_add_u32 v193, s54, v192
 v_mfma_f32_16x16x32_bf16 v[32:35], a[48:51], v[132:135], v[32:35]
 v_lshlrev_b32 v197, 2, v184
 v_mov_b32 v198, 1
 v_mfma_f32_16x16x32_bf16 v[36:39], a[36:39], v[128:131], v[36:39]
 v_or_b32 v185, s30, v184
 v_mov_b32 v186, 1073741824
 v_mfma_f32_16x16x32_bf16 v[36:39], a[52:55], v[132:135], v[36:39]
 s_lshl_b32 s52, s50, 2
 s_lshl_b32 s53, s49, 2
 v_mfma_f32_16x16x32_bf16 v[40:43], a[40:43], v[128:131], v[40:43]
 v_mov_b32 v187, s52
 v_mfma_f32_16x16x32_bf16 v[40:43], a[56:59], v[132:135], v[40:43]
 v_mov_b32 v188, s53
 v_cmp_eq_u32 vcc, 0, v185
 v_mfma_f32_16x16x32_bf16 v[44:47], a[44:47], v[128:131], v[44:47]
 s_nop 0
 v_cndmask_b32 v195, v186, v187, vcc
 v_cndmask_b32 v196, v186, v188, vcc
 v_mfma_f32_16x16x32_bf16 v[44:47], a[60:63], v[132:135], v[44:47]
 s_waitcnt lgkmcnt(0)
 s_barrier
 v_mfma_f32_16x16x32_bf16 v[48:51], a[32:35], v[136:139], v[48:51]
 v_mfma_f32_16x16x32_bf16 v[48:51], a[48:51], v[140:143], v[48:51]
 s_mov_b32 s34, 81920
 v_mfma_f32_16x16x32_bf16 v[52:55], a[36:39], v[136:139], v[52:55]
 s_lshr_b32 s52, s30, 1
 s_and_b32 s53, s30, 1
 v_bfe_u32 v186, v184, 2, 2
 v_bfe_u32 v187, v184, 4, 1
 v_mfma_f32_16x16x32_bf16 v[52:55], a[52:55], v[140:143], v[52:55]
 v_lshrrev_b32 v185, 5, v184
 v_lshlrev_b32 v185, 4, v185
 v_lshl_add_u32 v185, v187, 2, v185
 v_mfma_f32_16x16x32_bf16 v[56:59], a[40:43], v[136:139], v[56:59]
 v_add_u32 v185, v185, v186
 v_lshl_add_u32 v186, v187, 2, v186
 v_and_b32 v187, 3, v184
 v_lshlrev_b32 v187, 3, v187
 v_mfma_f32_16x16x32_bf16 v[56:59], a[56:59], v[140:143], v[56:59]
 buffer_load_dwordx4 a[240:243], v213, s[20:23], s34 offen nt
 v_mfma_f32_16x16x32_bf16 v[60:63], a[44:47], v[136:139], v[60:63]
 v_lshl_add_u32 v187, v185, 8, v187
 s_lshl_b32 s54, s52, 1
 s_add_u32 s54, s54, 0
 s_xor_b32 s54, s54, s49
 v_mfma_f32_16x16x32_bf16 v[60:63], a[60:63], v[140:143], v[60:63]
 s_lshl_b32 s54, s54, 1
 s_add_u32 s54, s54, s53
 v_xor_b32 v188, s54, v186
 v_mfma_f32_16x16x32_bf16 v[64:67], a[32:35], v[144:147], v[64:67]
 v_lshl_add_u32 v203, v188, 5, v187
 v_add_u32 v205, 73728, v203
 v_add_u32 v207, 139264, v203
 s_lshl_b32 s54, s52, 1
 v_mfma_f32_16x16x32_bf16 v[64:67], a[48:51], v[148:151], v[64:67]
 s_add_u32 s54, s54, 1
 s_xor_b32 s54, s54, s49
 s_lshl_b32 s54, s54, 1
 v_mfma_f32_16x16x32_bf16 v[68:71], a[36:39], v[144:147], v[68:71]
 s_add_u32 s54, s54, s53
 v_xor_b32 v188, s54, v186
 v_lshl_add_u32 v204, v188, 5, v187
 v_add_u32 v206, 73728, v204
 v_mfma_f32_16x16x32_bf16 v[68:71], a[52:55], v[148:151], v[68:71]
 v_add_u32 v208, 139264, v204
 v_add_u32 v209, 73728, v194
 v_add_u32 v210, 139264, v194
 v_mfma_f32_16x16x32_bf16 v[72:75], a[40:43], v[144:147], v[72:75]
 buffer_load_dwordx4 a[244:247], v213, s[20:23], s34 offen offset:1024 nt
 v_pk_mul_f32 v[0:1], v[0:1], v[248:249]
 v_mfma_f32_16x16x32_bf16 v[72:75], a[56:59], v[148:151], v[72:75]
 v_pk_mul_f32 v[2:3], v[2:3], v[248:249]
 v_cvt_pk_bf16_f32 v0, v0, v1
 v_cvt_pk_bf16_f32 v1, v2, v3
 v_mfma_f32_16x16x32_bf16 v[76:79], a[44:47], v[144:147], v[76:79]
 ds_write_b64 v244, v[0:1] offset:0
 v_pk_mul_f32 v[4:5], v[4:5], v[248:249]
 v_pk_mul_f32 v[6:7], v[6:7], v[248:249]
 v_cvt_pk_bf16_f32 v4, v4, v5
 v_mfma_f32_16x16x32_bf16 v[76:79], a[60:63], v[148:151], v[76:79]
 v_cvt_pk_bf16_f32 v5, v6, v7
 ds_write_b64 v245, v[4:5] offset:0
 v_pk_mul_f32 v[8:9], v[8:9], v[248:249]
 v_mfma_f32_16x16x32_bf16 v[80:83], a[32:35], v[152:155], v[80:83]
 s_mov_b32 s34, 106496
 v_pk_mul_f32 v[10:11], v[10:11], v[248:249]
 v_cvt_pk_bf16_f32 v8, v8, v9
 v_cvt_pk_bf16_f32 v9, v10, v11
 v_mfma_f32_16x16x32_bf16 v[80:83], a[48:51], v[156:159], v[80:83]
 ds_write_b64 v246, v[8:9] offset:0
 v_pk_mul_f32 v[12:13], v[12:13], v[248:249]
 v_pk_mul_f32 v[14:15], v[14:15], v[248:249]
 v_mfma_f32_16x16x32_bf16 v[84:87], a[36:39], v[152:155], v[84:87]
 v_cvt_pk_bf16_f32 v12, v12, v13
 v_cvt_pk_bf16_f32 v13, v14, v15
 ds_write_b64 v247, v[12:13] offset:0
 v_pk_mul_f32 v[16:17], v[16:17], v[248:249]
 v_mfma_f32_16x16x32_bf16 v[84:87], a[52:55], v[156:159], v[84:87]
 v_pk_mul_f32 v[18:19], v[18:19], v[248:249]
 v_cvt_pk_bf16_f32 v16, v16, v17
 v_cvt_pk_bf16_f32 v17, v18, v19
 v_mfma_f32_16x16x32_bf16 v[88:91], a[40:43], v[152:155], v[88:91]
 ds_write_b64 v244, v[16:17] offset:4096
 v_pk_mul_f32 v[20:21], v[20:21], v[248:249]
 v_pk_mul_f32 v[22:23], v[22:23], v[248:249]
 v_cvt_pk_bf16_f32 v20, v20, v21
 v_mfma_f32_16x16x32_bf16 v[88:91], a[56:59], v[156:159], v[88:91]
 buffer_load_dwordx4 a[248:251], v211, s[16:19], s34 offen nt
 v_mfma_f32_16x16x32_bf16 v[92:95], a[44:47], v[152:155], v[92:95]
 v_cvt_pk_bf16_f32 v21, v22, v23
 ds_write_b64 v245, v[20:21] offset:4096
 v_pk_mul_f32 v[24:25], v[24:25], v[248:249]
 v_pk_mul_f32 v[26:27], v[26:27], v[248:249]
 v_mfma_f32_16x16x32_bf16 v[92:95], a[60:63], v[156:159], v[92:95]
 v_cvt_pk_bf16_f32 v24, v24, v25
 v_cvt_pk_bf16_f32 v25, v26, v27
 ds_write_b64 v246, v[24:25] offset:4096
 v_mfma_f32_16x16x32_bf16 v[96:99], a[32:35], v[160:163], v[96:99]
 v_pk_mul_f32 v[28:29], v[28:29], v[248:249]
 v_pk_mul_f32 v[30:31], v[30:31], v[248:249]
 v_cvt_pk_bf16_f32 v28, v28, v29
 v_cvt_pk_bf16_f32 v29, v30, v31
 v_mfma_f32_16x16x32_bf16 v[96:99], a[48:51], v[164:167], v[96:99]
 ds_write_b64 v247, v[28:29] offset:4096
 v_pk_mul_f32 v[32:33], v[32:33], v[248:249]
 v_pk_mul_f32 v[34:35], v[34:35], v[248:249]
 v_mfma_f32_16x16x32_bf16 v[100:103], a[36:39], v[160:163], v[100:103]
 v_cvt_pk_bf16_f32 v32, v32, v33
 v_cvt_pk_bf16_f32 v33, v34, v35
 ds_write_b64 v244, v[32:33] offset:8192
 v_pk_mul_f32 v[36:37], v[36:37], v[248:249]
 v_mfma_f32_16x16x32_bf16 v[100:103], a[52:55], v[164:167], v[100:103]
 buffer_load_dwordx4 a[252:255], v212, s[16:19], s34 offen offset:1024 nt
 v_mfma_f32_16x16x32_bf16 v[104:107], a[40:43], v[160:163], v[104:107]
 v_pk_mul_f32 v[38:39], v[38:39], v[248:249]
 v_cvt_pk_bf16_f32 v36, v36, v37
 v_cvt_pk_bf16_f32 v37, v38, v39
 ds_write_b64 v245, v[36:37] offset:8192
 v_mfma_f32_16x16x32_bf16 v[104:107], a[56:59], v[164:167], v[104:107]
 v_pk_mul_f32 v[40:41], v[40:41], v[248:249]
 v_pk_mul_f32 v[42:43], v[42:43], v[248:249]
 v_cvt_pk_bf16_f32 v40, v40, v41
 v_mfma_f32_16x16x32_bf16 v[108:111], a[44:47], v[160:163], v[108:111]
 v_cvt_pk_bf16_f32 v41, v42, v43
 ds_write_b64 v246, v[40:41] offset:8192
 v_pk_mul_f32 v[44:45], v[44:45], v[248:249]
 v_pk_mul_f32 v[46:47], v[46:47], v[248:249]
 v_mfma_f32_16x16x32_bf16 v[108:111], a[60:63], v[164:167], v[108:111]
 v_cvt_pk_bf16_f32 v44, v44, v45
 v_cvt_pk_bf16_f32 v45, v46, v47
 ds_write_b64 v247, v[44:45] offset:8192
 v_pk_mul_f32 v[48:49], v[48:49], v[248:249]
 v_pk_mul_f32 v[50:51], v[50:51], v[248:249]
 v_cvt_pk_bf16_f32 v48, v48, v49
 v_cvt_pk_bf16_f32 v49, v50, v51
 ds_write_b64 v244, v[48:49] offset:12288
 v_pk_mul_f32 v[52:53], v[52:53], v[248:249]
 v_pk_mul_f32 v[54:55], v[54:55], v[248:249]
 v_cvt_pk_bf16_f32 v52, v52, v53
 v_cvt_pk_bf16_f32 v53, v54, v55
 ds_write_b64 v245, v[52:53] offset:12288
 v_pk_mul_f32 v[56:57], v[56:57], v[248:249]
 v_pk_mul_f32 v[58:59], v[58:59], v[248:249]
 v_cvt_pk_bf16_f32 v56, v56, v57
 v_cvt_pk_bf16_f32 v57, v58, v59
 ds_write_b64 v246, v[56:57] offset:12288
 v_pk_mul_f32 v[60:61], v[60:61], v[248:249]
 v_pk_mul_f32 v[62:63], v[62:63], v[248:249]
 v_cvt_pk_bf16_f32 v60, v60, v61
 v_cvt_pk_bf16_f32 v61, v62, v63
 ds_write_b64 v247, v[60:61] offset:12288
 v_pk_mul_f32 v[64:65], v[64:65], v[248:249]
 v_pk_mul_f32 v[66:67], v[66:67], v[248:249]
 v_cvt_pk_bf16_f32 v64, v64, v65
 v_cvt_pk_bf16_f32 v65, v66, v67
 ds_write_b64 v244, v[64:65] offset:16384
 v_pk_mul_f32 v[68:69], v[68:69], v[248:249]
 v_pk_mul_f32 v[70:71], v[70:71], v[248:249]
 v_cvt_pk_bf16_f32 v68, v68, v69
 v_cvt_pk_bf16_f32 v69, v70, v71
 ds_write_b64 v245, v[68:69] offset:16384
 v_pk_mul_f32 v[72:73], v[72:73], v[248:249]
 v_pk_mul_f32 v[74:75], v[74:75], v[248:249]
 v_cvt_pk_bf16_f32 v72, v72, v73
 v_cvt_pk_bf16_f32 v73, v74, v75
 ds_write_b64 v246, v[72:73] offset:16384
 v_pk_mul_f32 v[76:77], v[76:77], v[248:249]
 v_pk_mul_f32 v[78:79], v[78:79], v[248:249]
 v_cvt_pk_bf16_f32 v76, v76, v77
 v_cvt_pk_bf16_f32 v77, v78, v79
 ds_write_b64 v247, v[76:77] offset:16384
 v_pk_mul_f32 v[80:81], v[80:81], v[248:249]
 v_pk_mul_f32 v[82:83], v[82:83], v[248:249]
 v_cvt_pk_bf16_f32 v80, v80, v81
 v_cvt_pk_bf16_f32 v81, v82, v83
 ds_write_b64 v244, v[80:81] offset:20480
 v_pk_mul_f32 v[84:85], v[84:85], v[248:249]
 v_pk_mul_f32 v[86:87], v[86:87], v[248:249]
 v_cvt_pk_bf16_f32 v84, v84, v85
 v_cvt_pk_bf16_f32 v85, v86, v87
 ds_write_b64 v245, v[84:85] offset:20480
 v_pk_mul_f32 v[88:89], v[88:89], v[248:249]
 v_pk_mul_f32 v[90:91], v[90:91], v[248:249]
 v_cvt_pk_bf16_f32 v88, v88, v89
 v_cvt_pk_bf16_f32 v89, v90, v91
 ds_write_b64 v246, v[88:89] offset:20480
 v_pk_mul_f32 v[92:93], v[92:93], v[248:249]
 v_pk_mul_f32 v[94:95], v[94:95], v[248:249]
 v_cvt_pk_bf16_f32 v92, v92, v93
 v_cvt_pk_bf16_f32 v93, v94, v95
 ds_write_b64 v247, v[92:93] offset:20480
 v_pk_mul_f32 v[96:97], v[96:97], v[248:249]
 v_pk_mul_f32 v[98:99], v[98:99], v[248:249]
 v_cvt_pk_bf16_f32 v96, v96, v97
 v_cvt_pk_bf16_f32 v97, v98, v99
 ds_write_b64 v244, v[96:97] offset:24576
 v_pk_mul_f32 v[100:101], v[100:101], v[248:249]
 v_pk_mul_f32 v[102:103], v[102:103], v[248:249]
 v_cvt_pk_bf16_f32 v100, v100, v101
 v_cvt_pk_bf16_f32 v101, v102, v103
 ds_write_b64 v245, v[100:101] offset:24576
 v_pk_mul_f32 v[104:105], v[104:105], v[248:249]
 v_pk_mul_f32 v[106:107], v[106:107], v[248:249]
 v_cvt_pk_bf16_f32 v104, v104, v105
 v_cvt_pk_bf16_f32 v105, v106, v107
 ds_write_b64 v246, v[104:105] offset:24576
 v_pk_mul_f32 v[108:109], v[108:109], v[248:249]
 v_pk_mul_f32 v[110:111], v[110:111], v[248:249]
 v_cvt_pk_bf16_f32 v108, v108, v109
 v_cvt_pk_bf16_f32 v109, v110, v111
 ds_write_b64 v247, v[108:109] offset:24576
 s_or_b32 s52, s2, s30
 s_cmp_lg_u32 s52, 0
 s_cbranch_scc1 L_noready
 buffer_store_dword v198, off, s[92:95], 0 sc1
L_noready:
 v_add_u32 v112, v250, v220
 v_add_u32 v113, v250, v221
 v_add_u32 v114, v250, v222
 v_add_u32 v115, v250, v223
 v_add_u32 v116, v250, v224
 v_add_u32 v117, v250, v225
 v_add_u32 v118, v250, v226
 v_add_u32 v119, v250, v227
 s_waitcnt lgkmcnt(0)
 s_barrier
 ds_read_b128 a[64:67], v112 offset:0
 ds_read_b128 a[68:71], v113 offset:0
 ds_read_b128 a[72:75], v114 offset:0
 ds_read_b128 a[76:79], v115 offset:0
 ds_read_b128 a[80:83], v116 offset:0
 ds_read_b128 a[84:87], v117 offset:0
 ds_read_b128 a[88:91], v118 offset:0
 ds_read_b128 a[92:95], v119 offset:0
 ds_read_b128 a[96:99], v112 offset:28672
 ds_read_b128 a[100:103], v113 offset:28672
 ds_read_b128 a[104:107], v114 offset:28672
 ds_read_b128 a[108:111], v115 offset:28672
 ds_read_b128 a[112:115], v116 offset:28672
 ds_read_b128 a[116:119], v117 offset:28672
 ds_read_b128 a[120:123], v118 offset:28672
 ds_read_b128 a[124:127], v119 offset:28672
 s_waitcnt lgkmcnt(0)
 s_barrier
 ds_read_b128 a[0:3], v220 offset:0
 ds_read_b128 a[4:7], v221 offset:0
 ds_read_b128 a[8:11], v222 offset:0
 ds_read_b128 a[12:15], v223 offset:0
 ds_read_b128 a[16:19], v224 offset:0
 ds_read_b128 a[20:23], v225 offset:0
 ds_read_b128 a[24:27], v226 offset:0
 ds_read_b128 a[28:31], v227 offset:0
 s_add_u32 m0, s31, 73728
 s_mov_b32 s34, 90112
 buffer_load_dwordx4 v213, s[20:23], s34 offen nt lds
 buffer_load_dwordx4 v213, s[20:23], s34 offen offset:1024 nt lds
 s_add_u32 m0, s31, 81920
 s_mov_b32 s34, 114688
 buffer_load_dwordx4 v211, s[16:19], s34 offen nt lds
 buffer_load_dwordx4 v212, s[16:19], s34 offen offset:1024 nt lds
 s_waitcnt lgkmcnt(7)
 v_mfma_f32_32x32x16_bf16 v[0:15], a[0:3], a[64:67], 0
 s_waitcnt lgkmcnt(6)
 v_mfma_f32_32x32x16_bf16 v[0:15], a[4:7], a[68:71], v[0:15]
 s_waitcnt lgkmcnt(5)
 v_mfma_f32_32x32x16_bf16 v[0:15], a[8:11], a[72:75], v[0:15]
 s_waitcnt lgkmcnt(4)
 v_mfma_f32_32x32x16_bf16 v[0:15], a[12:15], a[76:79], v[0:15]
 s_waitcnt lgkmcnt(3)
 v_mfma_f32_32x32x16_bf16 v[0:15], a[16:19], a[80:83], v[0:15]
 s_waitcnt lgkmcnt(2)
 v_mfma_f32_32x32x16_bf16 v[0:15], a[20:23], a[84:87], v[0:15]
 s_waitcnt lgkmcnt(1)
 v_mfma_f32_32x32x16_bf16 v[0:15], a[24:27], a[88:91], v[0:15]
 s_waitcnt lgkmcnt(0)
 v_mfma_f32_32x32x16_bf16 v[0:15], a[28:31], a[92:95], v[0:15]
 ds_read_b128 a[0:3], v220 offset:8192
 ds_read_b128 a[4:7], v221 offset:8192
 ds_read_b128 a[8:11], v222 offset:8192
 ds_read_b128 a[12:15], v223 offset:8192
 ds_read_b128 a[16:19], v224 offset:8192
 ds_read_b128 a[20:23], v225 offset:8192
 ds_read_b128 a[24:27], v226 offset:8192
 ds_read_b128 a[28:31], v227 offset:8192
 s_nop 3
 v_max3_f32 v185, v0, v1, v2
 v_max3_f32 v185, v185, v3, v4
 v_max3_f32 v185, v185, v5, v6
 v_max3_f32 v185, v185, v7, v8
 v_max3_f32 v185, v185, v9, v10
 v_max3_f32 v185, v185, v11, v12
 v_max3_f32 v185, v185, v13, v14
 v_max_f32 v185, v185, v15
 v_mov_b32 v186, v185
 v_mov_b32 v218, 0
 s_nop 0
 v_permlane32_swap_b32 v185, v186
 v_max_f32 v185, v185, v186
 v_sub_f32 v128, 0, v185
 v_sub_f32 v129, 0, v185
 v_pk_add_f32 v[0:1], v[0:1], v[128:129]
 v_pk_add_f32 v[2:3], v[2:3], v[128:129]
 v_pk_mov_b32 v[130:131], v[128:129], v[128:129]
 v_pk_add_f32 v[4:5], v[4:5], v[128:129]
 v_pk_mov_b32 v[132:133], v[128:129], v[128:129]
 v_pk_add_f32 v[6:7], v[6:7], v[128:129]
 v_pk_mov_b32 v[134:135], v[128:129], v[128:129]
 v_pk_add_f32 v[8:9], v[8:9], v[128:129]
 v_pk_mov_b32 v[136:137], v[128:129], v[128:129]
 v_pk_add_f32 v[10:11], v[10:11], v[128:129]
 v_pk_mov_b32 v[138:139], v[128:129], v[128:129]
 v_pk_add_f32 v[12:13], v[12:13], v[128:129]
 v_pk_mov_b32 v[140:141], v[128:129], v[128:129]
 v_pk_add_f32 v[14:15], v[14:15], v[128:129]
 v_pk_mov_b32 v[142:143], v[128:129], v[128:129]
 s_waitcnt lgkmcnt(0)
 s_barrier
 v_mfma_f32_32x32x16_bf16 v[16:31], a[0:3], a[64:67], v[128:143]
 s_add_u32 m0, s31, 0
 s_mov_b32 s34, 98304
 buffer_load_dwordx4 v213, s[20:23], s34 offen nt lds
 v_exp_f32 v112, v0
 v_exp_f32 v113, v1
 v_exp_f32 v114, v2
 v_exp_f32 v115, v3
 v_mfma_f32_32x32x16_bf16 v[16:31], a[4:7], a[68:71], v[16:31]
 v_add_f32 v215, v112, v113
 v_cvt_pk_bf16_f32 v32, v112, v113
 v_exp_f32 v116, v4
 v_exp_f32 v117, v5
 v_mfma_f32_32x32x16_bf16 v[16:31], a[8:11], a[72:75], v[16:31]
 buffer_load_dwordx4 v213, s[20:23], s34 offen offset:1024 nt lds
 v_add_f32 v215, v215, v114
 v_add_f32 v215, v215, v115
 v_cvt_pk_bf16_f32 v33, v114, v115
 v_exp_f32 v118, v6
 v_exp_f32 v119, v7
 v_mfma_f32_32x32x16_bf16 v[16:31], a[12:15], a[76:79], v[16:31]
 v_add_f32 v215, v215, v116
 v_add_f32 v215, v215, v117
 v_cvt_pk_bf16_f32 v34, v116, v117
 v_exp_f32 v120, v8
 v_exp_f32 v121, v9
 v_mfma_f32_32x32x16_bf16 v[16:31], a[16:19], a[80:83], v[16:31]
 s_add_u32 m0, s31, 8192
 s_mov_b32 s34, 122880
 buffer_load_dwordx4 v211, s[16:19], s34 offen nt lds
 v_add_f32 v215, v215, v118
 v_add_f32 v215, v215, v119
 v_cvt_pk_bf16_f32 v35, v118, v119
 v_exp_f32 v122, v10
 v_exp_f32 v123, v11
 v_mfma_f32_32x32x16_bf16 v[16:31], a[20:23], a[84:87], v[16:31]
 v_add_f32 v215, v215, v120
 v_add_f32 v215, v215, v121
 v_cvt_pk_bf16_f32 v36, v120, v121
 v_exp_f32 v124, v12
 v_exp_f32 v125, v13
 v_mfma_f32_32x32x16_bf16 v[16:31], a[24:27], a[88:91], v[16:31]
 buffer_load_dwordx4 v212, s[16:19], s34 offen offset:1024 nt lds
 v_add_f32 v215, v215, v122
 v_add_f32 v215, v215, v123
 v_cvt_pk_bf16_f32 v37, v122, v123
 v_exp_f32 v126, v14
 v_exp_f32 v127, v15
 v_mfma_f32_32x32x16_bf16 v[16:31], a[28:31], a[92:95], v[16:31]
 v_add_f32 v215, v215, v124
 v_add_f32 v215, v215, v125
 v_cvt_pk_bf16_f32 v38, v124, v125
 v_add_f32 v215, v215, v126
 v_add_f32 v215, v215, v127
 v_cvt_pk_bf16_f32 v39, v126, v127
 ds_read_b128 a[0:3], v220 offset:16384
 ds_read_b128 a[4:7], v221 offset:16384
 ds_read_b128 a[8:11], v222 offset:16384
 ds_read_b128 a[12:15], v223 offset:16384
 ds_read_b128 a[16:19], v224 offset:16384
 ds_read_b128 a[20:23], v225 offset:16384
 ds_read_b128 a[24:27], v226 offset:16384
 ds_read_b128 a[28:31], v227 offset:16384
 v_add_f32 v218, v218, v215
 s_waitcnt lgkmcnt(0)
 s_barrier
 v_mfma_f32_32x32x16_bf16 v[0:15], a[0:3], a[64:67], v[128:143]
 ds_read_b64_tr_b16 a[32:33], v236 offset:24576
 ds_read_b64_tr_b16 a[34:35], v236 offset:26624
 ds_read_b64_tr_b16 a[36:37], v237 offset:24576
 v_exp_f32 v112, v16
 v_mfma_f32_32x32x16_bf16 v[0:15], a[4:7], a[68:71], v[0:15]
 ds_read_b64_tr_b16 a[38:39], v237 offset:26624
 ds_read_b64_tr_b16 a[40:41], v238 offset:24576
 ds_read_b64_tr_b16 a[42:43], v238 offset:26624
 v_exp_f32 v113, v17
 v_mfma_f32_32x32x16_bf16 v[0:15], a[8:11], a[72:75], v[0:15]
 ds_read_b64_tr_b16 a[44:45], v239 offset:24576
 ds_read_b64_tr_b16 a[46:47], v239 offset:26624
 v_exp_f32 v114, v18
 v_mfma_f32_32x32x16_bf16 v[0:15], a[12:15], a[76:79], v[0:15]
 ds_read_b64_tr_b16 a[48:49], v236 offset:28672
 ds_read_b64_tr_b16 a[50:51], v236 offset:30720
 ds_read_b64_tr_b16 a[52:53], v237 offset:28672
 v_exp_f32 v115, v19
 v_add_f32 v215, v112, v113
 v_mfma_f32_32x32x16_bf16 v[0:15], a[16:19], a[80:83], v[0:15]
 ds_read_b64_tr_b16 a[54:55], v237 offset:30720
 ds_read_b64_tr_b16 a[56:57], v238 offset:28672
 ds_read_b64_tr_b16 a[58:59], v238 offset:30720
 v_cvt_pk_bf16_f32 v40, v112, v113
 v_mfma_f32_32x32x16_bf16 v[0:15], a[20:23], a[84:87], v[0:15]
 ds_read_b64_tr_b16 a[60:61], v239 offset:28672
 ds_read_b64_tr_b16 a[62:63], v239 offset:30720
 v_exp_f32 v116, v20
 v_exp_f32 v117, v21
 v_mfma_f32_32x32x16_bf16 v[0:15], a[24:27], a[88:91], v[0:15]
 v_add_f32 v215, v215, v114
 v_add_f32 v215, v215, v115
 v_cvt_pk_bf16_f32 v41, v114, v115
 v_exp_f32 v118, v22
 v_mfma_f32_32x32x16_bf16 v[0:15], a[28:31], a[92:95], v[0:15]
 v_exp_f32 v119, v23
 v_add_f32 v215, v215, v116
 v_add_f32 v215, v215, v117
 v_cvt_pk_bf16_f32 v42, v116, v117
 s_waitcnt lgkmcnt(0)
 v_mfma_f32_32x32x16_bf16 v[48:63], a[32:35], v[32:35], 0
 ds_read_b128 a[0:3], v220 offset:32768
 ds_read_b128 a[4:7], v221 offset:32768
 v_exp_f32 v120, v24
 v_mfma_f32_32x32x16_bf16 v[64:79], a[36:39], v[32:35], 0
 ds_read_b128 a[8:11], v222 offset:32768
 v_exp_f32 v121, v25
 v_add_f32 v215, v215, v118
 v_add_f32 v215, v215, v119
 v_mfma_f32_32x32x16_bf16 v[80:95], a[40:43], v[32:35], 0
 ds_read_b128 a[12:15], v223 offset:32768
 v_cvt_pk_bf16_f32 v43, v118, v119
 v_exp_f32 v122, v26
 v_exp_f32 v123, v27
 v_mfma_f32_32x32x16_bf16 v[96:111], a[44:47], v[32:35], 0
 ds_read_b128 a[16:19], v224 offset:32768
 ds_read_b128 a[20:23], v225 offset:32768
 v_add_f32 v215, v215, v120
 v_add_f32 v215, v215, v121
 v_mfma_f32_32x32x16_bf16 v[48:63], a[48:51], v[36:39], v[48:63]
 ds_read_b128 a[24:27], v226 offset:32768
 v_cvt_pk_bf16_f32 v44, v120, v121
 v_exp_f32 v124, v28
 v_exp_f32 v125, v29
 v_mfma_f32_32x32x16_bf16 v[64:79], a[52:55], v[36:39], v[64:79]
 ds_read_b128 a[28:31], v227 offset:32768
 v_add_f32 v215, v215, v122
 v_add_f32 v215, v215, v123
 v_cvt_pk_bf16_f32 v45, v122, v123
 v_mfma_f32_32x32x16_bf16 v[80:95], a[56:59], v[36:39], v[80:95]
 v_exp_f32 v126, v30
 v_exp_f32 v127, v31
 v_add_f32 v215, v215, v124
 v_mfma_f32_32x32x16_bf16 v[96:111], a[60:63], v[36:39], v[96:111]
 v_add_f32 v215, v215, v125
 v_cvt_pk_bf16_f32 v46, v124, v125
 v_add_f32 v215, v215, v126
 v_add_f32 v215, v215, v127
 v_cvt_pk_bf16_f32 v47, v126, v127
 v_cmp_lt_f32 vcc, 0x45800000, v215
 s_cbranch_vccnz L_stub0
L_back0:
 v_add_f32 v218, v218, v215
 s_waitcnt lgkmcnt(0)
 s_barrier
 v_mfma_f32_32x32x16_bf16 v[16:31], a[0:3], a[64:67], v[128:143]
 ds_read_b64_tr_b16 a[32:33], v236 offset:40960
 ds_read_b64_tr_b16 a[34:35], v236 offset:43008
 ds_read_b64_tr_b16 a[36:37], v237 offset:40960
 v_exp_f32 v112, v0
 v_mfma_f32_32x32x16_bf16 v[16:31], a[4:7], a[68:71], v[16:31]
 ds_read_b64_tr_b16 a[38:39], v237 offset:43008
 ds_read_b64_tr_b16 a[40:41], v238 offset:40960
 ds_read_b64_tr_b16 a[42:43], v238 offset:43008
 v_exp_f32 v113, v1
 v_mfma_f32_32x32x16_bf16 v[16:31], a[8:11], a[72:75], v[16:31]
 ds_read_b64_tr_b16 a[44:45], v239 offset:40960
 ds_read_b64_tr_b16 a[46:47], v239 offset:43008
 v_exp_f32 v114, v2
 v_mfma_f32_32x32x16_bf16 v[16:31], a[12:15], a[76:79], v[16:31]
 ds_read_b64_tr_b16 a[48:49], v236 offset:45056
 ds_read_b64_tr_b16 a[50:51], v236 offset:47104
 ds_read_b64_tr_b16 a[52:53], v237 offset:45056
 v_exp_f32 v115, v3
 v_add_f32 v215, v112, v113
 v_mfma_f32_32x32x16_bf16 v[16:31], a[16:19], a[80:83], v[16:31]
 ds_read_b64_tr_b16 a[54:55], v237 offset:47104
 ds_read_b64_tr_b16 a[56:57], v238 offset:45056
 ds_read_b64_tr_b16 a[58:59], v238 offset:47104
 v_cvt_pk_bf16_f32 v32, v112, v113
 v_mfma_f32_32x32x16_bf16 v[16:31], a[20:23], a[84:87], v[16:31]
 ds_read_b64_tr_b16 a[60:61], v239 offset:45056
 ds_read_b64_tr_b16 a[62:63], v239 offset:47104
 v_exp_f32 v116, v4
 v_exp_f32 v117, v5
 v_mfma_f32_32x32x16_bf16 v[16:31], a[24:27], a[88:91], v[16:31]
 v_add_f32 v215, v215, v114
 v_add_f32 v215, v215, v115
 v_cvt_pk_bf16_f32 v33, v114, v115
 v_exp_f32 v118, v6
 v_mfma_f32_32x32x16_bf16 v[16:31], a[28:31], a[92:95], v[16:31]
 v_exp_f32 v119, v7
 v_add_f32 v215, v215, v116
 v_add_f32 v215, v215, v117
 v_cvt_pk_bf16_f32 v34, v116, v117
 s_waitcnt lgkmcnt(0)
 v_mfma_f32_32x32x16_bf16 v[48:63], a[32:35], v[40:43], v[48:63]
 ds_read_b128 a[0:3], v220 offset:49152
 ds_read_b128 a[4:7], v221 offset:49152
 v_exp_f32 v120, v8
 v_mfma_f32_32x32x16_bf16 v[64:79], a[36:39], v[40:43], v[64:79]
 ds_read_b128 a[8:11], v222 offset:49152
 v_exp_f32 v121, v9
 v_add_f32 v215, v215, v118
 v_add_f32 v215, v215, v119
 v_mfma_f32_32x32x16_bf16 v[80:95], a[40:43], v[40:43], v[80:95]
 ds_read_b128 a[12:15], v223 offset:49152
 v_cvt_pk_bf16_f32 v35, v118, v119
 v_exp_f32 v122, v10
 v_exp_f32 v123, v11
 v_mfma_f32_32x32x16_bf16 v[96:111], a[44:47], v[40:43], v[96:111]
 ds_read_b128 a[16:19], v224 offset:49152
 ds_read_b128 a[20:23], v225 offset:49152
 v_add_f32 v215, v215, v120
 v_add_f32 v215, v215, v121
 v_mfma_f32_32x32x16_bf16 v[48:63], a[48:51], v[44:47], v[48:63]
 ds_read_b128 a[24:27], v226 offset:49152
 v_cvt_pk_bf16_f32 v36, v120, v121
 v_exp_f32 v124, v12
 v_exp_f32 v125, v13
 v_mfma_f32_32x32x16_bf16 v[64:79], a[52:55], v[44:47], v[64:79]
 ds_read_b128 a[28:31], v227 offset:49152
 v_add_f32 v215, v215, v122
 v_add_f32 v215, v215, v123
 v_cvt_pk_bf16_f32 v37, v122, v123
 v_mfma_f32_32x32x16_bf16 v[80:95], a[56:59], v[44:47], v[80:95]
 v_exp_f32 v126, v14
 v_exp_f32 v127, v15
 v_add_f32 v215, v215, v124
 v_mfma_f32_32x32x16_bf16 v[96:111], a[60:63], v[44:47], v[96:111]
 v_add_f32 v215, v215, v125
 v_cvt_pk_bf16_f32 v38, v124, v125
 v_add_f32 v215, v215, v126
 v_add_f32 v215, v215, v127
 v_cvt_pk_bf16_f32 v39, v126, v127
 v_cmp_lt_f32 vcc, 0x45800000, v215
 s_cbranch_vccnz L_stub1
L_back1:
 v_add_f32 v218, v218, v215
 s_waitcnt lgkmcnt(0)
 s_barrier
 v_mfma_f32_32x32x16_bf16 v[0:15], a[0:3], a[64:67], v[128:143]
 ds_read_b64_tr_b16 a[32:33], v236 offset:57344
 ds_read_b64_tr_b16 a[34:35], v236 offset:59392
 ds_read_b64_tr_b16 a[36:37], v237 offset:57344
 v_exp_f32 v112, v16
 v_mfma_f32_32x32x16_bf16 v[0:15], a[4:7], a[68:71], v[0:15]
 ds_read_b64_tr_b16 a[38:39], v237 offset:59392
 ds_read_b64_tr_b16 a[40:41], v238 offset:57344
 ds_read_b64_tr_b16 a[42:43], v238 offset:59392
 s_add_u32 m0, s31, 32768
 s_mov_b32 s34, 106496
 buffer_load_dwordx4 v213, s[20:23], s34 offen nt lds
 v_mfma_f32_32x32x16_bf16 v[0:15], a[8:11], a[72:75], v[0:15]
 ds_read_b64_tr_b16 a[44:45], v239 offset:57344
 ds_read_b64_tr_b16 a[46:47], v239 offset:59392
 v_exp_f32 v113, v17
 v_exp_f32 v114, v18
 v_mfma_f32_32x32x16_bf16 v[0:15], a[12:15], a[76:79], v[0:15]
 ds_read_b64_tr_b16 a[48:49], v236 offset:61440
 ds_read_b64_tr_b16 a[50:51], v236 offset:63488
 ds_read_b64_tr_b16 a[52:53], v237 offset:61440
 v_exp_f32 v115, v19
 v_add_f32 v215, v112, v113
 v_cvt_pk_bf16_f32 v40, v112, v113
 v_mfma_f32_32x32x16_bf16 v[0:15], a[16:19], a[80:83], v[0:15]
 ds_read_b64_tr_b16 a[54:55], v237 offset:63488
 ds_read_b64_tr_b16 a[56:57], v238 offset:61440
 ds_read_b64_tr_b16 a[58:59], v238 offset:63488
 v_exp_f32 v116, v20
 v_mfma_f32_32x32x16_bf16 v[0:15], a[20:23], a[84:87], v[0:15]
 ds_read_b64_tr_b16 a[60:61], v239 offset:61440
 ds_read_b64_tr_b16 a[62:63], v239 offset:63488
 v_exp_f32 v117, v21
 v_add_f32 v215, v215, v114
 v_add_f32 v215, v215, v115
 v_mfma_f32_32x32x16_bf16 v[0:15], a[24:27], a[88:91], v[0:15]
 v_cvt_pk_bf16_f32 v41, v114, v115
 v_exp_f32 v118, v22
 v_exp_f32 v119, v23
 v_add_f32 v215, v215, v116
 v_mfma_f32_32x32x16_bf16 v[0:15], a[28:31], a[92:95], v[0:15]
 v_add_f32 v215, v215, v117
 v_cvt_pk_bf16_f32 v42, v116, v117
 v_exp_f32 v120, v24
 v_exp_f32 v121, v25
 s_waitcnt lgkmcnt(0)
 v_mfma_f32_32x32x16_bf16 v[48:63], a[32:35], v[32:35], v[48:63]
 ds_read_b128 a[0:3], v228 offset:0
 ds_read_b128 a[4:7], v229 offset:0
 ds_write_b128 v180, a[128:131] offset:16384
 v_add_f32 v215, v215, v118
 v_mfma_f32_32x32x16_bf16 v[64:79], a[36:39], v[32:35], v[64:79]
 buffer_load_dwordx4 v213, s[20:23], s34 offen offset:1024 nt lds
 ds_read_b128 a[8:11], v230 offset:0
 ds_write_b128 v180, a[132:135] offset:17408
 v_mfma_f32_32x32x16_bf16 v[80:95], a[40:43], v[32:35], v[80:95]
 ds_read_b128 a[12:15], v231 offset:0
 ds_write_b128 v180, a[136:139] offset:24576
 v_add_f32 v215, v215, v119
 v_cvt_pk_bf16_f32 v43, v118, v119
 v_mfma_f32_32x32x16_bf16 v[96:111], a[44:47], v[32:35], v[96:111]
 ds_read_b128 a[16:19], v232 offset:0
 ds_read_b128 a[20:23], v233 offset:0
 ds_write_b128 v180, a[140:143] offset:25600
 v_exp_f32 v122, v26
 v_mfma_f32_32x32x16_bf16 v[48:63], a[48:51], v[36:39], v[48:63]
 ds_read_b128 a[24:27], v234 offset:0
 v_exp_f32 v123, v27
 v_add_f32 v215, v215, v120
 v_add_f32 v215, v215, v121
 v_cvt_pk_bf16_f32 v44, v120, v121
 v_mfma_f32_32x32x16_bf16 v[64:79], a[52:55], v[36:39], v[64:79]
 ds_read_b128 a[28:31], v235 offset:0
 v_exp_f32 v124, v28
 v_exp_f32 v125, v29
 v_add_f32 v215, v215, v122
 v_mfma_f32_32x32x16_bf16 v[80:95], a[56:59], v[36:39], v[80:95]
 v_add_f32 v215, v215, v123
 v_cvt_pk_bf16_f32 v45, v122, v123
 v_exp_f32 v126, v30
 v_exp_f32 v127, v31
 v_mfma_f32_32x32x16_bf16 v[96:111], a[60:63], v[36:39], v[96:111]
 v_add_f32 v215, v215, v124
 v_add_f32 v215, v215, v125
 v_cvt_pk_bf16_f32 v46, v124, v125
 v_add_f32 v215, v215, v126
 v_add_f32 v215, v215, v127
 v_cvt_pk_bf16_f32 v47, v126, v127
 v_cmp_lt_f32 vcc, 0x45800000, v215
 s_cbranch_vccnz L_stub2
L_back2:
 v_add_f32 v218, v218, v215
 s_waitcnt lgkmcnt(0)
 s_barrier
 v_mfma_f32_32x32x16_bf16 v[16:31], a[0:3], a[64:67], v[128:143]
 ds_read_b64_tr_b16 a[32:33], v236 offset:16384
 ds_read_b64_tr_b16 a[34:35], v236 offset:18432
 ds_read_b64_tr_b16 a[36:37], v237 offset:16384
 v_exp_f32 v112, v0
 v_mfma_f32_32x32x16_bf16 v[16:31], a[4:7], a[68:71], v[16:31]
 ds_read_b64_tr_b16 a[38:39], v237 offset:18432
 ds_read_b64_tr_b16 a[40:41], v238 offset:16384
 ds_read_b64_tr_b16 a[42:43], v238 offset:18432
 s_add_u32 m0, s31, 57344
 s_mov_b32 s34, 4194304
 buffer_load_dwordx4 v211, s[16:19], s34 offen nt lds
 v_mfma_f32_32x32x16_bf16 v[16:31], a[8:11], a[72:75], v[16:31]
 ds_read_b64_tr_b16 a[44:45], v239 offset:16384
 ds_read_b64_tr_b16 a[46:47], v239 offset:18432
 v_exp_f32 v113, v1
 v_exp_f32 v114, v2
 v_mfma_f32_32x32x16_bf16 v[16:31], a[12:15], a[76:79], v[16:31]
 ds_read_b64_tr_b16 a[48:49], v236 offset:20480
 ds_read_b64_tr_b16 a[50:51], v236 offset:22528
 ds_read_b64_tr_b16 a[52:53], v237 offset:20480
 v_exp_f32 v115, v3
 v_add_f32 v215, v112, v113
 v_cvt_pk_bf16_f32 v32, v112, v113
 v_mfma_f32_32x32x16_bf16 v[16:31], a[16:19], a[80:83], v[16:31]
 ds_read_b64_tr_b16 a[54:55], v237 offset:22528
 ds_read_b64_tr_b16 a[56:57], v238 offset:20480
 ds_read_b64_tr_b16 a[58:59], v238 offset:22528
 v_exp_f32 v116, v4
 v_mfma_f32_32x32x16_bf16 v[16:31], a[20:23], a[84:87], v[16:31]
 ds_read_b64_tr_b16 a[60:61], v239 offset:20480
 ds_read_b64_tr_b16 a[62:63], v239 offset:22528
 v_exp_f32 v117, v5
 v_add_f32 v215, v215, v114
 v_add_f32 v215, v215, v115
 v_mfma_f32_32x32x16_bf16 v[16:31], a[24:27], a[88:91], v[16:31]
 v_cvt_pk_bf16_f32 v33, v114, v115
 v_exp_f32 v118, v6
 v_exp_f32 v119, v7
 v_add_f32 v215, v215, v116
 v_mfma_f32_32x32x16_bf16 v[16:31], a[28:31], a[92:95], v[16:31]
 v_add_f32 v215, v215, v117
 v_cvt_pk_bf16_f32 v34, v116, v117
 v_exp_f32 v120, v8
 v_exp_f32 v121, v9
 s_waitcnt lgkmcnt(0)
 v_mfma_f32_32x32x16_bf16 v[48:63], a[32:35], v[40:43], v[48:63]
 ds_read_b128 a[0:3], v220 offset:24576
 ds_read_b128 a[4:7], v221 offset:24576
 ds_write_b128 v180, a[144:147] offset:40960
 v_add_f32 v215, v215, v118
 v_mfma_f32_32x32x16_bf16 v[64:79], a[36:39], v[40:43], v[64:79]
 buffer_load_dwordx4 v212, s[16:19], s34 offen offset:1024 nt lds
 ds_read_b128 a[8:11], v222 offset:24576
 ds_write_b128 v180, a[148:151] offset:41984
 v_mfma_f32_32x32x16_bf16 v[80:95], a[40:43], v[40:43], v[80:95]
 ds_read_b128 a[12:15], v223 offset:24576
 ds_write_b128 v180, a[152:155] offset:49152
 v_add_f32 v215, v215, v119
 v_cvt_pk_bf16_f32 v35, v118, v119
 v_mfma_f32_32x32x16_bf16 v[96:111], a[44:47], v[40:43], v[96:111]
 ds_read_b128 a[16:19], v224 offset:24576
 ds_read_b128 a[20:23], v225 offset:24576
 ds_write_b128 v180, a[156:159] offset:50176
 v_exp_f32 v122, v10
 v_mfma_f32_32x32x16_bf16 v[48:63], a[48:51], v[44:47], v[48:63]
 ds_read_b128 a[24:27], v226 offset:24576
 v_exp_f32 v123, v11
 v_add_f32 v215, v215, v120
 v_add_f32 v215, v215, v121
 v_cvt_pk_bf16_f32 v36, v120, v121
 v_mfma_f32_32x32x16_bf16 v[64:79], a[52:55], v[44:47], v[64:79]
 ds_read_b128 a[28:31], v227 offset:24576
 v_exp_f32 v124, v12
 v_exp_f32 v125, v13
 v_add_f32 v215, v215, v122
 v_mfma_f32_32x32x16_bf16 v[80:95], a[56:59], v[44:47], v[80:95]
 v_add_f32 v215, v215, v123
 v_cvt_pk_bf16_f32 v37, v122, v123
 v_exp_f32 v126, v14
 v_exp_f32 v127, v15
 v_mfma_f32_32x32x16_bf16 v[96:111], a[60:63], v[44:47], v[96:111]
 v_add_f32 v215, v215, v124
 v_add_f32 v215, v215, v125
 v_cvt_pk_bf16_f32 v38, v124, v125
 v_add_f32 v215, v215, v126
 v_add_f32 v215, v215, v127
 v_cvt_pk_bf16_f32 v39, v126, v127
 v_cmp_lt_f32 vcc, 0x45800000, v215
 s_cbranch_vccnz L_stub3
L_back3:
 v_add_f32 v218, v218, v215
 s_waitcnt lgkmcnt(0)
 s_barrier
 v_mfma_f32_32x32x16_bf16 v[0:15], a[0:3], a[64:67], v[128:143]
 ds_read_b64_tr_b16 a[32:33], v236 offset:40960
 ds_read_b64_tr_b16 a[34:35], v236 offset:43008
 ds_read_b64_tr_b16 a[36:37], v237 offset:40960
 v_exp_f32 v112, v16
 v_mfma_f32_32x32x16_bf16 v[0:15], a[4:7], a[68:71], v[0:15]
 ds_read_b64_tr_b16 a[38:39], v237 offset:43008
 ds_read_b64_tr_b16 a[40:41], v238 offset:40960
 ds_read_b64_tr_b16 a[42:43], v238 offset:43008
 s_add_u32 m0, s31, 65536
 s_mov_b32 s34, 114688
 buffer_load_dwordx4 v213, s[20:23], s34 offen nt lds
 v_mfma_f32_32x32x16_bf16 v[0:15], a[8:11], a[72:75], v[0:15]
 ds_read_b64_tr_b16 a[44:45], v239 offset:40960
 ds_read_b64_tr_b16 a[46:47], v239 offset:43008
 v_exp_f32 v113, v17
 v_exp_f32 v114, v18
 v_mfma_f32_32x32x16_bf16 v[0:15], a[12:15], a[76:79], v[0:15]
 ds_read_b64_tr_b16 a[48:49], v236 offset:45056
 ds_read_b64_tr_b16 a[50:51], v236 offset:47104
 ds_read_b64_tr_b16 a[52:53], v237 offset:45056
 v_exp_f32 v115, v19
 v_add_f32 v215, v112, v113
 v_cvt_pk_bf16_f32 v40, v112, v113
 v_mfma_f32_32x32x16_bf16 v[0:15], a[16:19], a[80:83], v[0:15]
 ds_read_b64_tr_b16 a[54:55], v237 offset:47104
 ds_read_b64_tr_b16 a[56:57], v238 offset:45056
 ds_read_b64_tr_b16 a[58:59], v238 offset:47104
 v_exp_f32 v116, v20
 v_mfma_f32_32x32x16_bf16 v[0:15], a[20:23], a[84:87], v[0:15]
 ds_read_b64_tr_b16 a[60:61], v239 offset:45056
 ds_read_b64_tr_b16 a[62:63], v239 offset:47104
 v_exp_f32 v117, v21
 v_add_f32 v215, v215, v114
 v_add_f32 v215, v215, v115
 v_mfma_f32_32x32x16_bf16 v[0:15], a[24:27], a[88:91], v[0:15]
 v_cvt_pk_bf16_f32 v41, v114, v115
 v_exp_f32 v118, v22
 v_exp_f32 v119, v23
 v_add_f32 v215, v215, v116
 v_mfma_f32_32x32x16_bf16 v[0:15], a[28:31], a[92:95], v[0:15]
 v_add_f32 v215, v215, v117
 v_cvt_pk_bf16_f32 v42, v116, v117
 v_exp_f32 v120, v24
 v_exp_f32 v121, v25
 s_waitcnt lgkmcnt(0)
 v_mfma_f32_32x32x16_bf16 v[48:63], a[32:35], v[32:35], v[48:63]
 ds_read_b128 a[0:3], v220 offset:49152
 ds_read_b128 a[4:7], v221 offset:49152
 ds_write_b128 v180, a[160:163] offset:16384
 v_add_f32 v215, v215, v118
 v_mfma_f32_32x32x16_bf16 v[64:79], a[36:39], v[32:35], v[64:79]
 buffer_load_dwordx4 v213, s[20:23], s34 offen offset:1024 nt lds
 ds_read_b128 a[8:11], v222 offset:49152
 ds_write_b128 v180, a[164:167] offset:17408
 v_mfma_f32_32x32x16_bf16 v[80:95], a[40:43], v[32:35], v[80:95]
 ds_read_b128 a[12:15], v223 offset:49152
 ds_write_b128 v180, a[168:171] offset:24576
 v_add_f32 v215, v215, v119
 v_cvt_pk_bf16_f32 v43, v118, v119
 v_mfma_f32_32x32x16_bf16 v[96:111], a[44:47], v[32:35], v[96:111]
 ds_read_b128 a[16:19], v224 offset:49152
 ds_read_b128 a[20:23], v225 offset:49152
 ds_write_b128 v180, a[172:175] offset:25600
 v_exp_f32 v122, v26
 v_mfma_f32_32x32x16_bf16 v[48:63], a[48:51], v[36:39], v[48:63]
 ds_read_b128 a[24:27], v226 offset:49152
 v_exp_f32 v123, v27
 v_add_f32 v215, v215, v120
 v_add_f32 v215, v215, v121
 v_cvt_pk_bf16_f32 v44, v120, v121
 v_mfma_f32_32x32x16_bf16 v[64:79], a[52:55], v[36:39], v[64:79]
 ds_read_b128 a[28:31], v227 offset:49152
 v_exp_f32 v124, v28
 v_exp_f32 v125, v29
 v_add_f32 v215, v215, v122
 v_mfma_f32_32x32x16_bf16 v[80:95], a[56:59], v[36:39], v[80:95]
 v_add_f32 v215, v215, v123
 v_cvt_pk_bf16_f32 v45, v122, v123
 v_exp_f32 v126, v30
 v_exp_f32 v127, v31
 v_mfma_f32_32x32x16_bf16 v[96:111], a[60:63], v[36:39], v[96:111]
 v_add_f32 v215, v215, v124
 v_add_f32 v215, v215, v125
 v_cvt_pk_bf16_f32 v46, v124, v125
 v_add_f32 v215, v215, v126
 v_add_f32 v215, v215, v127
 v_cvt_pk_bf16_f32 v47, v126, v127
 v_cmp_lt_f32 vcc, 0x45800000, v215
 s_cbranch_vccnz L_stub4
L_back4:
 v_add_f32 v218, v218, v215
 s_waitcnt lgkmcnt(0)
 s_barrier
 v_mfma_f32_32x32x16_bf16 v[16:31], a[0:3], a[64:67], v[128:143]
 ds_read_b64_tr_b16 a[32:33], v236 offset:16384
 ds_read_b64_tr_b16 a[34:35], v236 offset:18432
 ds_read_b64_tr_b16 a[36:37], v237 offset:16384
 v_exp_f32 v112, v0
 v_mfma_f32_32x32x16_bf16 v[16:31], a[4:7], a[68:71], v[16:31]
 ds_read_b64_tr_b16 a[38:39], v237 offset:18432
 ds_read_b64_tr_b16 a[40:41], v238 offset:16384
 ds_read_b64_tr_b16 a[42:43], v238 offset:18432
 s_add_u32 m0, s31, 90112
 s_mov_b32 s34, 4202496
 buffer_load_dwordx4 v211, s[16:19], s34 offen nt lds
 v_mfma_f32_32x32x16_bf16 v[16:31], a[8:11], a[72:75], v[16:31]
 ds_read_b64_tr_b16 a[44:45], v239 offset:16384
 ds_read_b64_tr_b16 a[46:47], v239 offset:18432
 v_exp_f32 v113, v1
 v_exp_f32 v114, v2
 v_mfma_f32_32x32x16_bf16 v[16:31], a[12:15], a[76:79], v[16:31]
 ds_read_b64_tr_b16 a[48:49], v236 offset:20480
 ds_read_b64_tr_b16 a[50:51], v236 offset:22528
 ds_read_b64_tr_b16 a[52:53], v237 offset:20480
 v_exp_f32 v115, v3
 v_add_f32 v215, v112, v113
 v_cvt_pk_bf16_f32 v32, v112, v113
 v_mfma_f32_32x32x16_bf16 v[16:31], a[16:19], a[80:83], v[16:31]
 ds_read_b64_tr_b16 a[54:55], v237 offset:22528
 ds_read_b64_tr_b16 a[56:57], v238 offset:20480
 ds_read_b64_tr_b16 a[58:59], v238 offset:22528
 v_exp_f32 v116, v4
 v_mfma_f32_32x32x16_bf16 v[16:31], a[20:23], a[84:87], v[16:31]
 ds_read_b64_tr_b16 a[60:61], v239 offset:20480
 ds_read_b64_tr_b16 a[62:63], v239 offset:22528
 v_exp_f32 v117, v5
 v_add_f32 v215, v215, v114
 v_add_f32 v215, v215, v115
 v_mfma_f32_32x32x16_bf16 v[16:31], a[24:27], a[88:91], v[16:31]
 v_cvt_pk_bf16_f32 v33, v114, v115
 v_exp_f32 v118, v6
 v_exp_f32 v119, v7
 v_add_f32 v215, v215, v116
 v_mfma_f32_32x32x16_bf16 v[16:31], a[28:31], a[92:95], v[16:31]
 v_add_f32 v215, v215, v117
 v_cvt_pk_bf16_f32 v34, v116, v117
 v_exp_f32 v120, v8
 v_exp_f32 v121, v9
 s_waitcnt lgkmcnt(0)
 v_mfma_f32_32x32x16_bf16 v[48:63], a[32:35], v[40:43], v[48:63]
 ds_read_b128 a[0:3], v220 offset:24576
 ds_read_b128 a[4:7], v221 offset:24576
 ds_write_b128 v180, a[176:179] offset:40960
 v_add_f32 v215, v215, v118
 v_mfma_f32_32x32x16_bf16 v[64:79], a[36:39], v[40:43], v[64:79]
 buffer_load_dwordx4 v212, s[16:19], s34 offen offset:1024 nt lds
 ds_read_b128 a[8:11], v222 offset:24576
 ds_write_b128 v180, a[180:183] offset:41984
 v_mfma_f32_32x32x16_bf16 v[80:95], a[40:43], v[40:43], v[80:95]
 ds_read_b128 a[12:15], v223 offset:24576
 ds_write_b128 v180, a[184:187] offset:49152
 v_add_f32 v215, v215, v119
 v_cvt_pk_bf16_f32 v35, v118, v119
 v_mfma_f32_32x32x16_bf16 v[96:111], a[44:47], v[40:43], v[96:111]
 ds_read_b128 a[16:19], v224 offset:24576
 ds_read_b128 a[20:23], v225 offset:24576
 ds_write_b128 v180, a[188:191] offset:50176
 v_exp_f32 v122, v10
 v_mfma_f32_32x32x16_bf16 v[48:63], a[48:51], v[44:47], v[48:63]
 ds_read_b128 a[24:27], v226 offset:24576
 v_exp_f32 v123, v11
 v_add_f32 v215, v215, v120
 v_add_f32 v215, v215, v121
 v_cvt_pk_bf16_f32 v36, v120, v121
 v_mfma_f32_32x32x16_bf16 v[64:79], a[52:55], v[44:47], v[64:79]
 ds_read_b128 a[28:31], v227 offset:24576
 v_exp_f32 v124, v12
 v_exp_f32 v125, v13
 v_add_f32 v215, v215, v122
 v_mfma_f32_32x32x16_bf16 v[80:95], a[56:59], v[44:47], v[80:95]
 v_add_f32 v215, v215, v123
 v_cvt_pk_bf16_f32 v37, v122, v123
 v_exp_f32 v126, v14
 v_exp_f32 v127, v15
 v_mfma_f32_32x32x16_bf16 v[96:111], a[60:63], v[44:47], v[96:111]
 v_add_f32 v215, v215, v124
 v_add_f32 v215, v215, v125
 v_cvt_pk_bf16_f32 v38, v124, v125
 v_add_f32 v215, v215, v126
 v_add_f32 v215, v215, v127
 v_cvt_pk_bf16_f32 v39, v126, v127
 v_cmp_lt_f32 vcc, 0x45800000, v215
 s_cbranch_vccnz L_stub5
L_back5:
 v_add_f32 v218, v218, v215
 s_waitcnt lgkmcnt(0)
 s_barrier
 v_mfma_f32_32x32x16_bf16 v[0:15], a[0:3], a[64:67], v[128:143]
 ds_read_b64_tr_b16 a[32:33], v236 offset:40960
 ds_read_b64_tr_b16 a[34:35], v236 offset:43008
 ds_read_b64_tr_b16 a[36:37], v237 offset:40960
 v_exp_f32 v112, v16
 v_mfma_f32_32x32x16_bf16 v[0:15], a[4:7], a[68:71], v[0:15]
 ds_read_b64_tr_b16 a[38:39], v237 offset:43008
 ds_read_b64_tr_b16 a[40:41], v238 offset:40960
 ds_read_b64_tr_b16 a[42:43], v238 offset:43008
 s_add_u32 m0, s31, 98304
 s_mov_b32 s34, 122880
 buffer_load_dwordx4 v213, s[20:23], s34 offen nt lds
 v_mfma_f32_32x32x16_bf16 v[0:15], a[8:11], a[72:75], v[0:15]
 ds_read_b64_tr_b16 a[44:45], v239 offset:40960
 ds_read_b64_tr_b16 a[46:47], v239 offset:43008
 v_exp_f32 v113, v17
 v_exp_f32 v114, v18
 v_mfma_f32_32x32x16_bf16 v[0:15], a[12:15], a[76:79], v[0:15]
 ds_read_b64_tr_b16 a[48:49], v236 offset:45056
 ds_read_b64_tr_b16 a[50:51], v236 offset:47104
 ds_read_b64_tr_b16 a[52:53], v237 offset:45056
 v_exp_f32 v115, v19
 v_add_f32 v215, v112, v113
 v_cvt_pk_bf16_f32 v40, v112, v113
 v_mfma_f32_32x32x16_bf16 v[0:15], a[16:19], a[80:83], v[0:15]
 ds_read_b64_tr_b16 a[54:55], v237 offset:47104
 ds_read_b64_tr_b16 a[56:57], v238 offset:45056
 ds_read_b64_tr_b16 a[58:59], v238 offset:47104
 v_exp_f32 v116, v20
 v_mfma_f32_32x32x16_bf16 v[0:15], a[20:23], a[84:87], v[0:15]
 ds_read_b64_tr_b16 a[60:61], v239 offset:45056
 ds_read_b64_tr_b16 a[62:63], v239 offset:47104
 v_exp_f32 v117, v21
 v_add_f32 v215, v215, v114
 v_add_f32 v215, v215, v115
 v_mfma_f32_32x32x16_bf16 v[0:15], a[24:27], a[88:91], v[0:15]
 v_cvt_pk_bf16_f32 v41, v114, v115
 v_exp_f32 v118, v22
 v_exp_f32 v119, v23
 v_add_f32 v215, v215, v116
 v_mfma_f32_32x32x16_bf16 v[0:15], a[28:31], a[92:95], v[0:15]
 v_add_f32 v215, v215, v117
 v_cvt_pk_bf16_f32 v42, v116, v117
 v_exp_f32 v120, v24
 v_exp_f32 v121, v25
 s_waitcnt lgkmcnt(0)
 v_mfma_f32_32x32x16_bf16 v[48:63], a[32:35], v[32:35], v[48:63]
 ds_read_b128 a[0:3], v220 offset:49152
 ds_read_b128 a[4:7], v221 offset:49152
 s_waitcnt vmcnt(29)
 ds_write_b128 v180, a[192:195] offset:16384
 v_add_f32 v215, v215, v118
 v_mfma_f32_32x32x16_bf16 v[64:79], a[36:39], v[32:35], v[64:79]
 buffer_load_dwordx4 v213, s[20:23], s34 offen offset:1024 nt lds
 ds_read_b128 a[8:11], v222 offset:49152
 ds_write_b128 v180, a[196:199] offset:17408
 v_mfma_f32_32x32x16_bf16 v[80:95], a[40:43], v[32:35], v[80:95]
 ds_read_b128 a[12:15], v223 offset:49152
 ds_write_b128 v180, a[200:203] offset:24576
 v_add_f32 v215, v215, v119
 v_cvt_pk_bf16_f32 v43, v118, v119
 v_mfma_f32_32x32x16_bf16 v[96:111], a[44:47], v[32:35], v[96:111]
 ds_read_b128 a[16:19], v224 offset:49152
 ds_read_b128 a[20:23], v225 offset:49152
 ds_write_b128 v180, a[204:207] offset:25600
 v_exp_f32 v122, v26
 v_mfma_f32_32x32x16_bf16 v[48:63], a[48:51], v[36:39], v[48:63]
 ds_read_b128 a[24:27], v226 offset:49152
 v_exp_f32 v123, v27
 v_add_f32 v215, v215, v120
 v_add_f32 v215, v215, v121
 v_cvt_pk_bf16_f32 v44, v120, v121
 v_mfma_f32_32x32x16_bf16 v[64:79], a[52:55], v[36:39], v[64:79]
 ds_read_b128 a[28:31], v227 offset:49152
 v_exp_f32 v124, v28
 v_exp_f32 v125, v29
 v_add_f32 v215, v215, v122
 v_mfma_f32_32x32x16_bf16 v[80:95], a[56:59], v[36:39], v[80:95]
 v_add_f32 v215, v215, v123
 v_cvt_pk_bf16_f32 v45, v122, v123
 v_exp_f32 v126, v30
 v_exp_f32 v127, v31
 v_mfma_f32_32x32x16_bf16 v[96:111], a[60:63], v[36:39], v[96:111]
 v_add_f32 v215, v215, v124
 v_add_f32 v215, v215, v125
 v_cvt_pk_bf16_f32 v46, v124, v125
 v_add_f32 v215, v215, v126
 v_add_f32 v215, v215, v127
 v_cvt_pk_bf16_f32 v47, v126, v127
 v_cmp_lt_f32 vcc, 0x45800000, v215
 s_cbranch_vccnz L_stub6
L_back6:
 v_add_f32 v218, v218, v215
 s_waitcnt lgkmcnt(0)
 s_barrier
 v_mfma_f32_32x32x16_bf16 v[16:31], a[0:3], a[64:67], v[128:143]
 ds_read_b64_tr_b16 a[32:33], v236 offset:16384
 ds_read_b64_tr_b16 a[34:35], v236 offset:18432
 ds_read_b64_tr_b16 a[36:37], v237 offset:16384
 v_exp_f32 v112, v0
 v_exp_f32 v113, v1
 v_mfma_f32_32x32x16_bf16 v[16:31], a[4:7], a[68:71], v[16:31]
 ds_read_b64_tr_b16 a[38:39], v237 offset:18432
 ds_read_b64_tr_b16 a[40:41], v238 offset:16384
 ds_read_b64_tr_b16 a[42:43], v238 offset:18432
 s_add_u32 m0, s31, 106496
 s_mov_b32 s34, 4210688
 buffer_load_dwordx4 v211, s[16:19], s34 offen nt lds
 v_mfma_f32_32x32x16_bf16 v[16:31], a[8:11], a[72:75], v[16:31]
 ds_read_b64_tr_b16 a[44:45], v239 offset:16384
 ds_read_b64_tr_b16 a[46:47], v239 offset:18432
 v_exp_f32 v114, v2
 v_exp_f32 v115, v3
 v_mfma_f32_32x32x16_bf16 v[16:31], a[12:15], a[76:79], v[16:31]
 ds_read_b64_tr_b16 a[48:49], v236 offset:20480
 ds_read_b64_tr_b16 a[50:51], v236 offset:22528
 ds_read_b64_tr_b16 a[52:53], v237 offset:20480
 v_add_f32 v215, v112, v113
 v_cvt_pk_bf16_f32 v32, v112, v113
 v_mfma_f32_32x32x16_bf16 v[16:31], a[16:19], a[80:83], v[16:31]
 ds_read_b64_tr_b16 a[54:55], v237 offset:22528
 ds_read_b64_tr_b16 a[56:57], v238 offset:20480
 ds_read_b64_tr_b16 a[58:59], v238 offset:22528
 v_exp_f32 v116, v4
 v_exp_f32 v117, v5
 v_mfma_f32_32x32x16_bf16 v[16:31], a[20:23], a[84:87], v[16:31]
 ds_read_b64_tr_b16 a[60:61], v239 offset:20480
 ds_read_b64_tr_b16 a[62:63], v239 offset:22528
 v_add_f32 v215, v215, v114
 v_add_f32 v215, v215, v115
 v_cvt_pk_bf16_f32 v33, v114, v115
 v_mfma_f32_32x32x16_bf16 v[16:31], a[24:27], a[88:91], v[16:31]
 buffer_load_dwordx4 v212, s[16:19], s34 offen offset:1024 nt lds
 v_exp_f32 v118, v6
 v_exp_f32 v119, v7
 v_mfma_f32_32x32x16_bf16 v[16:31], a[28:31], a[92:95], v[16:31]
 v_add_f32 v215, v215, v116
 v_add_f32 v215, v215, v117
 v_cvt_pk_bf16_f32 v34, v116, v117
 v_exp_f32 v120, v8
 s_waitcnt lgkmcnt(0)
 v_mfma_f32_32x32x16_bf16 v[48:63], a[32:35], v[40:43], v[48:63]
 ds_read_b128 a[0:3], v220 offset:24576
 ds_read_b128 a[4:7], v221 offset:24576
 s_waitcnt vmcnt(28)
 ds_write_b128 v180, a[208:211] offset:40960
 v_exp_f32 v121, v9
 v_mfma_f32_32x32x16_bf16 v[64:79], a[36:39], v[40:43], v[64:79]
 ds_read_b128 a[8:11], v222 offset:24576
 ds_write_b128 v180, a[212:215] offset:41984
 v_add_f32 v215, v215, v118
 v_add_f32 v215, v215, v119
 v_cvt_pk_bf16_f32 v35, v118, v119
 v_mfma_f32_32x32x16_bf16 v[80:95], a[40:43], v[40:43], v[80:95]
 buffer_load_dword v216, v197, s[92:95], 0 offen offset:0 sc1
 ds_read_b128 a[12:15], v223 offset:24576
 ds_write_b128 v180, a[216:219] offset:49152
 v_mfma_f32_32x32x16_bf16 v[96:111], a[44:47], v[40:43], v[96:111]
 ds_read_b128 a[16:19], v224 offset:24576
 ds_read_b128 a[20:23], v225 offset:24576
 ds_write_b128 v180, a[220:223] offset:50176
 v_exp_f32 v122, v10
 v_mfma_f32_32x32x16_bf16 v[48:63], a[48:51], v[44:47], v[48:63]
 ds_read_b128 a[24:27], v226 offset:24576
 v_exp_f32 v123, v11
 v_add_f32 v215, v215, v120
 v_add_f32 v215, v215, v121
 v_cvt_pk_bf16_f32 v36, v120, v121
 v_mfma_f32_32x32x16_bf16 v[64:79], a[52:55], v[44:47], v[64:79]
 ds_read_b128 a[28:31], v227 offset:24576
 v_exp_f32 v124, v12
 v_exp_f32 v125, v13
 v_add_f32 v215, v215, v122
 v_mfma_f32_32x32x16_bf16 v[80:95], a[56:59], v[44:47], v[80:95]
 v_add_f32 v215, v215, v123
 v_cvt_pk_bf16_f32 v37, v122, v123
 v_exp_f32 v126, v14
 v_exp_f32 v127, v15
 v_mfma_f32_32x32x16_bf16 v[96:111], a[60:63], v[44:47], v[96:111]
 v_add_f32 v215, v215, v124
 v_add_f32 v215, v215, v125
 v_cvt_pk_bf16_f32 v38, v124, v125
 v_add_f32 v215, v215, v126
 v_add_f32 v215, v215, v127
 v_cvt_pk_bf16_f32 v39, v126, v127
 v_cmp_lt_f32 vcc, 0x45800000, v215
 s_cbranch_vccnz L_stub7
L_back7:
 v_add_f32 v218, v218, v215
 s_waitcnt lgkmcnt(0)
 s_barrier
 v_mfma_f32_32x32x16_bf16 v[0:15], a[0:3], a[64:67], v[128:143]
 ds_read_b64_tr_b16 a[32:33], v236 offset:40960
 ds_read_b64_tr_b16 a[34:35], v236 offset:43008
 ds_read_b64_tr_b16 a[36:37], v237 offset:40960
 v_exp_f32 v112, v16
 v_mfma_f32_32x32x16_bf16 v[0:15], a[4:7], a[68:71], v[0:15]
 ds_read_b64_tr_b16 a[38:39], v237 offset:43008
 ds_read_b64_tr_b16 a[40:41], v238 offset:40960
 ds_read_b64_tr_b16 a[42:43], v238 offset:43008
 s_add_u32 m0, s31, 114688
 s_mov_b32 s34, 4194304
 buffer_load_dwordx4 v213, s[20:23], s34 offen nt lds
 v_mfma_f32_32x32x16_bf16 v[0:15], a[8:11], a[72:75], v[0:15]
 ds_read_b64_tr_b16 a[44:45], v239 offset:40960
 ds_read_b64_tr_b16 a[46:47], v239 offset:43008
 v_exp_f32 v113, v17
 v_exp_f32 v114, v18
 v_mfma_f32_32x32x16_bf16 v[0:15], a[12:15], a[76:79], v[0:15]
 ds_read_b64_tr_b16 a[48:49], v236 offset:45056
 ds_read_b64_tr_b16 a[50:51], v236 offset:47104
 ds_read_b64_tr_b16 a[52:53], v237 offset:45056
 v_exp_f32 v115, v19
 v_add_f32 v215, v112, v113
 v_cvt_pk_bf16_f32 v40, v112, v113
 v_mfma_f32_32x32x16_bf16 v[0:15], a[16:19], a[80:83], v[0:15]
 ds_read_b64_tr_b16 a[54:55], v237 offset:47104
 ds_read_b64_tr_b16 a[56:57], v238 offset:45056
 ds_read_b64_tr_b16 a[58:59], v238 offset:47104
 v_exp_f32 v116, v20
 v_mfma_f32_32x32x16_bf16 v[0:15], a[20:23], a[84:87], v[0:15]
 ds_read_b64_tr_b16 a[60:61], v239 offset:45056
 ds_read_b64_tr_b16 a[62:63], v239 offset:47104
 v_exp_f32 v117, v21
 v_add_f32 v215, v215, v114
 v_add_f32 v215, v215, v115
 v_mfma_f32_32x32x16_bf16 v[0:15], a[24:27], a[88:91], v[0:15]
 v_cvt_pk_bf16_f32 v41, v114, v115
 v_exp_f32 v118, v22
 v_exp_f32 v119, v23
 v_add_f32 v215, v215, v116
 v_mfma_f32_32x32x16_bf16 v[0:15], a[28:31], a[92:95], v[0:15]
 v_add_f32 v215, v215, v117
 v_cvt_pk_bf16_f32 v42, v116, v117
 v_exp_f32 v120, v24
 v_exp_f32 v121, v25
 s_waitcnt lgkmcnt(0)
 v_mfma_f32_32x32x16_bf16 v[48:63], a[32:35], v[32:35], v[48:63]
 ds_read_b128 a[0:3], v220 offset:49152
 ds_read_b128 a[4:7], v221 offset:49152
 s_waitcnt vmcnt(26)
 ds_write_b128 v180, a[224:227] offset:16384
 v_add_f32 v215, v215, v118
 v_mfma_f32_32x32x16_bf16 v[64:79], a[36:39], v[32:35], v[64:79]
 buffer_load_dwordx4 v213, s[20:23], s34 offen offset:1024 nt lds
 ds_read_b128 a[8:11], v222 offset:49152
 ds_write_b128 v180, a[228:231] offset:17408
 v_mfma_f32_32x32x16_bf16 v[80:95], a[40:43], v[32:35], v[80:95]
 ds_read_b128 a[12:15], v223 offset:49152
 ds_write_b128 v180, a[232:235] offset:24576
 v_add_f32 v215, v215, v119
 v_cvt_pk_bf16_f32 v43, v118, v119
 v_mfma_f32_32x32x16_bf16 v[96:111], a[44:47], v[32:35], v[96:111]
 ds_read_b128 a[16:19], v224 offset:49152
 ds_read_b128 a[20:23], v225 offset:49152
 ds_write_b128 v180, a[236:239] offset:25600
 v_exp_f32 v122, v26
 v_mfma_f32_32x32x16_bf16 v[48:63], a[48:51], v[36:39], v[48:63]
 ds_read_b128 a[24:27], v226 offset:49152
 v_exp_f32 v123, v27
 v_add_f32 v215, v215, v120
 v_add_f32 v215, v215, v121
 v_cvt_pk_bf16_f32 v44, v120, v121
 v_mfma_f32_32x32x16_bf16 v[64:79], a[52:55], v[36:39], v[64:79]
 ds_read_b128 a[28:31], v227 offset:49152
 v_exp_f32 v124, v28
 v_exp_f32 v125, v29
 v_add_f32 v215, v215, v122
 v_mfma_f32_32x32x16_bf16 v[80:95], a[56:59], v[36:39], v[80:95]
 v_add_f32 v215, v215, v123
 v_cvt_pk_bf16_f32 v45, v122, v123
 v_exp_f32 v126, v30
 v_exp_f32 v127, v31
 v_mfma_f32_32x32x16_bf16 v[96:111], a[60:63], v[36:39], v[96:111]
 v_add_f32 v215, v215, v124
 v_add_f32 v215, v215, v125
 v_cvt_pk_bf16_f32 v46, v124, v125
 v_add_f32 v215, v215, v126
 v_add_f32 v215, v215, v127
 v_cvt_pk_bf16_f32 v47, v126, v127
 v_cmp_lt_f32 vcc, 0x45800000, v215
 s_cbranch_vccnz L_stub8
L_back8:
 v_add_f32 v218, v218, v215
 s_waitcnt lgkmcnt(0)
 s_barrier
 v_mfma_f32_32x32x16_bf16 v[16:31], a[0:3], a[64:67], v[128:143]
 ds_read_b64_tr_b16 a[32:33], v236 offset:16384
 ds_read_b64_tr_b16 a[34:35], v236 offset:18432
 ds_read_b64_tr_b16 a[36:37], v237 offset:16384
 v_exp_f32 v112, v0
 v_mfma_f32_32x32x16_bf16 v[16:31], a[4:7], a[68:71], v[16:31]
 ds_read_b64_tr_b16 a[38:39], v237 offset:18432
 ds_read_b64_tr_b16 a[40:41], v238 offset:16384
 ds_read_b64_tr_b16 a[42:43], v238 offset:18432
 s_add_u32 m0, s31, 122880
 s_mov_b32 s34, 4218880
 buffer_load_dwordx4 v211, s[16:19], s34 offen nt lds
 v_mfma_f32_32x32x16_bf16 v[16:31], a[8:11], a[72:75], v[16:31]
 ds_read_b64_tr_b16 a[44:45], v239 offset:16384
 ds_read_b64_tr_b16 a[46:47], v239 offset:18432
 v_exp_f32 v113, v1
 v_exp_f32 v114, v2
 v_mfma_f32_32x32x16_bf16 v[16:31], a[12:15], a[76:79], v[16:31]
 ds_read_b64_tr_b16 a[48:49], v236 offset:20480
 ds_read_b64_tr_b16 a[50:51], v236 offset:22528
 ds_read_b64_tr_b16 a[52:53], v237 offset:20480
 v_exp_f32 v115, v3
 v_add_f32 v215, v112, v113
 v_cvt_pk_bf16_f32 v32, v112, v113
 v_mfma_f32_32x32x16_bf16 v[16:31], a[16:19], a[80:83], v[16:31]
 ds_read_b64_tr_b16 a[54:55], v237 offset:22528
 ds_read_b64_tr_b16 a[56:57], v238 offset:20480
 ds_read_b64_tr_b16 a[58:59], v238 offset:22528
 v_exp_f32 v116, v4
 v_mfma_f32_32x32x16_bf16 v[16:31], a[20:23], a[84:87], v[16:31]
 ds_read_b64_tr_b16 a[60:61], v239 offset:20480
 ds_read_b64_tr_b16 a[62:63], v239 offset:22528
 v_exp_f32 v117, v5
 v_add_f32 v215, v215, v114
 v_add_f32 v215, v215, v115
 v_mfma_f32_32x32x16_bf16 v[16:31], a[24:27], a[88:91], v[16:31]
 v_cvt_pk_bf16_f32 v33, v114, v115
 v_exp_f32 v118, v6
 v_exp_f32 v119, v7
 v_add_f32 v215, v215, v116
 v_mfma_f32_32x32x16_bf16 v[16:31], a[28:31], a[92:95], v[16:31]
 v_add_f32 v215, v215, v117
 v_cvt_pk_bf16_f32 v34, v116, v117
 v_exp_f32 v120, v8
 v_exp_f32 v121, v9
 s_waitcnt lgkmcnt(0)
 v_mfma_f32_32x32x16_bf16 v[48:63], a[32:35], v[40:43], v[48:63]
 ds_read_b128 a[0:3], v220 offset:24576
 ds_read_b128 a[4:7], v221 offset:24576
 s_waitcnt vmcnt(24)
 ds_write_b128 v180, a[240:243] offset:40960
 v_add_f32 v215, v215, v118
 v_mfma_f32_32x32x16_bf16 v[64:79], a[36:39], v[40:43], v[64:79]
 buffer_load_dwordx4 v212, s[16:19], s34 offen offset:1024 nt lds
 ds_read_b128 a[8:11], v222 offset:24576
 ds_write_b128 v180, a[244:247] offset:41984
 v_mfma_f32_32x32x16_bf16 v[80:95], a[40:43], v[40:43], v[80:95]
 ds_read_b128 a[12:15], v223 offset:24576
 ds_write_b128 v180, a[248:251] offset:49152
 v_add_f32 v215, v215, v119
 v_cvt_pk_bf16_f32 v35, v118, v119
 v_mfma_f32_32x32x16_bf16 v[96:111], a[44:47], v[40:43], v[96:111]
 ds_read_b128 a[16:19], v224 offset:24576
 ds_read_b128 a[20:23], v225 offset:24576
 ds_write_b128 v180, a[252:255] offset:50176
 v_exp_f32 v122, v10
 v_mfma_f32_32x32x16_bf16 v[48:63], a[48:51], v[44:47], v[48:63]
 ds_read_b128 a[24:27], v226 offset:24576
 v_exp_f32 v123, v11
 v_add_f32 v215, v215, v120
 v_add_f32 v215, v215, v121
 v_cvt_pk_bf16_f32 v36, v120, v121
 v_mfma_f32_32x32x16_bf16 v[64:79], a[52:55], v[44:47], v[64:79]
 ds_read_b128 a[28:31], v227 offset:24576
 v_exp_f32 v124, v12
 v_exp_f32 v125, v13
 v_add_f32 v215, v215, v122
 v_mfma_f32_32x32x16_bf16 v[80:95], a[56:59], v[44:47], v[80:95]
 v_add_f32 v215, v215, v123
 v_cvt_pk_bf16_f32 v37, v122, v123
 v_exp_f32 v126, v14
 v_exp_f32 v127, v15
 v_mfma_f32_32x32x16_bf16 v[96:111], a[60:63], v[44:47], v[96:111]
 v_add_f32 v215, v215, v124
 v_add_f32 v215, v215, v125
 v_cvt_pk_bf16_f32 v38, v124, v125
 v_add_f32 v215, v215, v126
 v_add_f32 v215, v215, v127
 v_cvt_pk_bf16_f32 v39, v126, v127
 v_cmp_lt_f32 vcc, 0x45800000, v215
 s_cbranch_vccnz L_stub9
L_back9:
 v_add_f32 v218, v218, v215
 s_waitcnt lgkmcnt(0)
 s_barrier
 v_mfma_f32_32x32x16_bf16 v[0:15], a[0:3], a[64:67], v[128:143]
 ds_read_b64_tr_b16 a[32:33], v236 offset:40960
 ds_read_b64_tr_b16 a[34:35], v236 offset:43008
 ds_read_b64_tr_b16 a[36:37], v237 offset:40960
 v_exp_f32 v112, v16
 v_mfma_f32_32x32x16_bf16 v[0:15], a[4:7], a[68:71], v[0:15]
 ds_read_b64_tr_b16 a[38:39], v237 offset:43008
 ds_read_b64_tr_b16 a[40:41], v238 offset:40960
 ds_read_b64_tr_b16 a[42:43], v238 offset:43008
 v_exp_f32 v113, v17
 v_mfma_f32_32x32x16_bf16 v[0:15], a[8:11], a[72:75], v[0:15]
 ds_read_b64_tr_b16 a[44:45], v239 offset:40960
 ds_read_b64_tr_b16 a[46:47], v239 offset:43008
 v_exp_f32 v114, v18
 v_mfma_f32_32x32x16_bf16 v[0:15], a[12:15], a[76:79], v[0:15]
 ds_read_b64_tr_b16 a[48:49], v236 offset:45056
 ds_read_b64_tr_b16 a[50:51], v236 offset:47104
 ds_read_b64_tr_b16 a[52:53], v237 offset:45056
 v_exp_f32 v115, v19
 v_add_f32 v215, v112, v113
 v_mfma_f32_32x32x16_bf16 v[0:15], a[16:19], a[80:83], v[0:15]
 ds_read_b64_tr_b16 a[54:55], v237 offset:47104
 ds_read_b64_tr_b16 a[56:57], v238 offset:45056
 ds_read_b64_tr_b16 a[58:59], v238 offset:47104
 v_cvt_pk_bf16_f32 v40, v112, v113
 v_mfma_f32_32x32x16_bf16 v[0:15], a[20:23], a[84:87], v[0:15]
 ds_read_b64_tr_b16 a[60:61], v239 offset:45056
 ds_read_b64_tr_b16 a[62:63], v239 offset:47104
 v_exp_f32 v116, v20
 v_exp_f32 v117, v21
 v_mfma_f32_32x32x16_bf16 v[0:15], a[24:27], a[88:91], v[0:15]
 v_add_f32 v215, v215, v114
 v_add_f32 v215, v215, v115
 v_cvt_pk_bf16_f32 v41, v114, v115
 v_exp_f32 v118, v22
 v_mfma_f32_32x32x16_bf16 v[0:15], a[28:31], a[92:95], v[0:15]
 v_exp_f32 v119, v23
 v_add_f32 v215, v215, v116
 v_add_f32 v215, v215, v117
 v_cvt_pk_bf16_f32 v42, v116, v117
 s_waitcnt lgkmcnt(0)
 v_mfma_f32_32x32x16_bf16 v[48:63], a[32:35], v[32:35], v[48:63]
 ds_read_b128 a[0:3], v220 offset:49152
 ds_read_b128 a[4:7], v221 offset:49152
 v_exp_f32 v120, v24
 v_mfma_f32_32x32x16_bf16 v[64:79], a[36:39], v[32:35], v[64:79]
 ds_read_b128 a[8:11], v222 offset:49152
 v_exp_f32 v121, v25
 v_add_f32 v215, v215, v118
 v_add_f32 v215, v215, v119
 v_mfma_f32_32x32x16_bf16 v[80:95], a[40:43], v[32:35], v[80:95]
 ds_read_b128 a[12:15], v223 offset:49152
 v_cvt_pk_bf16_f32 v43, v118, v119
 v_exp_f32 v122, v26
 v_exp_f32 v123, v27
 v_mfma_f32_32x32x16_bf16 v[96:111], a[44:47], v[32:35], v[96:111]
 ds_read_b128 a[16:19], v224 offset:49152
 ds_read_b128 a[20:23], v225 offset:49152
 v_add_f32 v215, v215, v120
 v_add_f32 v215, v215, v121
 v_mfma_f32_32x32x16_bf16 v[48:63], a[48:51], v[36:39], v[48:63]
 ds_read_b128 a[24:27], v226 offset:49152
 v_cvt_pk_bf16_f32 v44, v120, v121
 v_exp_f32 v124, v28
 v_exp_f32 v125, v29
 v_mfma_f32_32x32x16_bf16 v[64:79], a[52:55], v[36:39], v[64:79]
 ds_read_b128 a[28:31], v227 offset:49152
 v_add_f32 v215, v215, v122
 v_add_f32 v215, v215, v123
 v_cvt_pk_bf16_f32 v45, v122, v123
 v_mfma_f32_32x32x16_bf16 v[80:95], a[56:59], v[36:39], v[80:95]
 v_exp_f32 v126, v30
 v_exp_f32 v127, v31
 v_add_f32 v215, v215, v124
 v_mfma_f32_32x32x16_bf16 v[96:111], a[60:63], v[36:39], v[96:111]
 v_add_f32 v215, v215, v125
 v_cvt_pk_bf16_f32 v46, v124, v125
 v_add_f32 v215, v215, v126
 v_add_f32 v215, v215, v127
 v_cvt_pk_bf16_f32 v47, v126, v127
 v_cmp_lt_f32 vcc, 0x45800000, v215
 s_cbranch_vccnz L_stub10
L_back10:
 v_add_f32 v218, v218, v215
 s_waitcnt vmcnt(21) lgkmcnt(0)
 s_barrier
 v_mfma_f32_32x32x16_bf16 v[16:31], a[0:3], a[64:67], v[128:143]
 ds_read_b64_tr_b16 a[32:33], v240 offset:8192
 ds_read_b64_tr_b16 a[34:35], v240 offset:10240
 ds_read_b64_tr_b16 a[36:37], v241 offset:8192
 v_exp_f32 v112, v0
 v_mfma_f32_32x32x16_bf16 v[16:31], a[4:7], a[68:71], v[16:31]
 ds_read_b64_tr_b16 a[38:39], v241 offset:10240
 ds_read_b64_tr_b16 a[40:41], v242 offset:8192
 ds_read_b64_tr_b16 a[42:43], v242 offset:10240
 s_add_u32 m0, s31, 16384
 s_mov_b32 s34, 4202496
 buffer_load_dwordx4 v213, s[20:23], s34 offen nt lds
 v_mfma_f32_32x32x16_bf16 v[16:31], a[8:11], a[72:75], v[16:31]
 ds_read_b64_tr_b16 a[44:45], v243 offset:8192
 ds_read_b64_tr_b16 a[46:47], v243 offset:10240
 v_exp_f32 v113, v1
 v_exp_f32 v114, v2
 v_mfma_f32_32x32x16_bf16 v[16:31], a[12:15], a[76:79], v[16:31]
 ds_read_b64_tr_b16 a[48:49], v240 offset:12288
 ds_read_b64_tr_b16 a[50:51], v240 offset:14336
 ds_read_b64_tr_b16 a[52:53], v241 offset:12288
 v_exp_f32 v115, v3
 v_add_f32 v215, v112, v113
 v_mfma_f32_32x32x16_bf16 v[16:31], a[16:19], a[80:83], v[16:31]
 ds_read_b64_tr_b16 a[54:55], v241 offset:14336
 ds_read_b64_tr_b16 a[56:57], v242 offset:12288
 ds_read_b64_tr_b16 a[58:59], v242 offset:14336
 buffer_load_dwordx4 v213, s[20:23], s34 offen offset:1024 nt lds
 v_mfma_f32_32x32x16_bf16 v[16:31], a[20:23], a[84:87], v[16:31]
 ds_read_b64_tr_b16 a[60:61], v243 offset:12288
 ds_read_b64_tr_b16 a[62:63], v243 offset:14336
 v_cvt_pk_bf16_f32 v32, v112, v113
 v_exp_f32 v116, v4
 v_exp_f32 v117, v5
 v_mfma_f32_32x32x16_bf16 v[16:31], a[24:27], a[88:91], v[16:31]
 s_waitcnt vmcnt(6)
 v_cmp_eq_u32 vcc, 1, v216
 s_and_b32 s42, vcc_lo, 1
 s_cmp_eq_u32 s42, 1
 s_cbranch_scc0 L_spin0
L_spun0:
 v_add_f32 v215, v215, v114
 v_mfma_f32_32x32x16_bf16 v[16:31], a[28:31], a[92:95], v[16:31]
 v_add_f32 v215, v215, v115
 v_cvt_pk_bf16_f32 v33, v114, v115
 v_exp_f32 v118, v6
 v_exp_f32 v119, v7
 s_waitcnt lgkmcnt(0)
 v_mfma_f32_32x32x16_bf16 v[48:63], a[32:35], v[40:43], v[48:63]
 s_and_b32 s52, s2, 7
 s_lshl_b32 s52, s52, 2
 s_add_u32 s52, s52, s51
 s_lshl_b32 s52, s52, 7
 s_add_u32 s52, s52, 67108864
 s_add_u32 s92, s88, s52
 s_addc_u32 s93, s89, 0
 s_mov_b32 s94, 64
 ds_read_b128 a[0:3], v228 offset:16384
 ds_read_b128 a[4:7], v229 offset:16384
 v_mfma_f32_32x32x16_bf16 v[64:79], a[36:39], v[40:43], v[64:79]
 ds_read_b128 a[8:11], v230 offset:16384
 v_add_f32 v215, v215, v116
 v_add_f32 v215, v215, v117
 v_cvt_pk_bf16_f32 v34, v116, v117
 v_exp_f32 v120, v8
 v_mfma_f32_32x32x16_bf16 v[80:95], a[40:43], v[40:43], v[80:95]
 ds_read_b128 a[12:15], v231 offset:16384
 v_exp_f32 v121, v9
 v_add_f32 v215, v215, v118
 v_add_f32 v215, v215, v119
 v_mfma_f32_32x32x16_bf16 v[96:111], a[44:47], v[40:43], v[96:111]
 ds_read_b128 a[16:19], v232 offset:16384
 ds_read_b128 a[20:23], v233 offset:16384
 v_cvt_pk_bf16_f32 v35, v118, v119
 v_exp_f32 v122, v10
 v_mfma_f32_32x32x16_bf16 v[48:63], a[48:51], v[44:47], v[48:63]
 ds_read_b128 a[24:27], v234 offset:16384
 v_exp_f32 v123, v11
 v_add_f32 v215, v215, v120
 v_add_f32 v215, v215, v121
 v_cvt_pk_bf16_f32 v36, v120, v121
 v_mfma_f32_32x32x16_bf16 v[64:79], a[52:55], v[44:47], v[64:79]
 ds_read_b128 a[28:31], v235 offset:16384
 v_exp_f32 v124, v12
 v_exp_f32 v125, v13
 v_add_f32 v215, v215, v122
 v_mfma_f32_32x32x16_bf16 v[80:95], a[56:59], v[44:47], v[80:95]
 v_add_f32 v215, v215, v123
 v_cvt_pk_bf16_f32 v37, v122, v123
 v_exp_f32 v126, v14
 v_exp_f32 v127, v15
 v_mfma_f32_32x32x16_bf16 v[96:111], a[60:63], v[44:47], v[96:111]
 v_add_f32 v215, v215, v124
 v_add_f32 v215, v215, v125
 v_cvt_pk_bf16_f32 v38, v124, v125
 v_add_f32 v215, v215, v126
 v_add_f32 v215, v215, v127
 v_cvt_pk_bf16_f32 v39, v126, v127
 v_cmp_lt_f32 vcc, 0x45800000, v215
 s_cbranch_vccnz L_stub11
L_back11:
 v_add_f32 v218, v218, v215
 s_waitcnt lgkmcnt(0)
 s_barrier
 v_mfma_f32_32x32x16_bf16 v[0:15], a[0:3], a[64:67], v[128:143]
 ds_read_b64_tr_b16 a[32:33], v236 offset:0
 ds_read_b64_tr_b16 a[34:35], v236 offset:2048
 ds_read_b64_tr_b16 a[36:37], v237 offset:0
 v_exp_f32 v112, v16
 v_mfma_f32_32x32x16_bf16 v[0:15], a[4:7], a[68:71], v[0:15]
 ds_read_b64_tr_b16 a[38:39], v237 offset:2048
 ds_read_b64_tr_b16 a[40:41], v238 offset:0
 ds_read_b64_tr_b16 a[42:43], v238 offset:2048
 s_add_u32 m0, s31, 24576
 s_mov_b32 s34, 4227072
 buffer_load_dwordx4 v211, s[16:19], s34 offen nt lds
 v_mfma_f32_32x32x16_bf16 v[0:15], a[8:11], a[72:75], v[0:15]
 ds_read_b64_tr_b16 a[44:45], v239 offset:0
 ds_read_b64_tr_b16 a[46:47], v239 offset:2048
 v_exp_f32 v113, v17
 v_exp_f32 v114, v18
 v_mfma_f32_32x32x16_bf16 v[0:15], a[12:15], a[76:79], v[0:15]
 ds_read_b64_tr_b16 a[48:49], v236 offset:4096
 ds_read_b64_tr_b16 a[50:51], v236 offset:6144
 ds_read_b64_tr_b16 a[52:53], v237 offset:4096
 v_exp_f32 v115, v19
 v_mfma_f32_32x32x16_bf16 v[0:15], a[16:19], a[80:83], v[0:15]
 ds_read_b64_tr_b16 a[54:55], v237 offset:6144
 ds_read_b64_tr_b16 a[56:57], v238 offset:4096
 ds_read_b64_tr_b16 a[58:59], v238 offset:6144
 v_add_f32 v215, v112, v113
 v_cvt_pk_bf16_f32 v40, v112, v113
 v_mfma_f32_32x32x16_bf16 v[0:15], a[20:23], a[84:87], v[0:15]
 ds_read_b64_tr_b16 a[60:61], v239 offset:4096
 ds_read_b64_tr_b16 a[62:63], v239 offset:6144
 v_exp_f32 v116, v20
 v_exp_f32 v117, v21
 v_mfma_f32_32x32x16_bf16 v[0:15], a[24:27], a[88:91], v[0:15]
 v_add_f32 v215, v215, v114
 v_add_f32 v215, v215, v115
 v_cvt_pk_bf16_f32 v41, v114, v115
 v_exp_f32 v118, v22
 v_mfma_f32_32x32x16_bf16 v[0:15], a[28:31], a[92:95], v[0:15]
 v_exp_f32 v119, v23
 v_add_f32 v215, v215, v116
 v_add_f32 v215, v215, v117
 v_cvt_pk_bf16_f32 v42, v116, v117
 s_waitcnt lgkmcnt(0)
 v_mfma_f32_32x32x16_bf16 v[48:63], a[32:35], v[32:35], v[48:63]
 ds_read_b128 a[0:3], v220 offset:8192
 ds_read_b128 a[4:7], v221 offset:8192
 v_exp_f32 v120, v24
 v_exp_f32 v121, v25
 v_mfma_f32_32x32x16_bf16 v[64:79], a[36:39], v[32:35], v[64:79]
 buffer_load_dwordx4 v212, s[16:19], s34 offen offset:1024 nt lds
 ds_read_b128 a[8:11], v222 offset:8192
 v_mfma_f32_32x32x16_bf16 v[80:95], a[40:43], v[32:35], v[80:95]
 ds_read_b128 a[12:15], v223 offset:8192
 v_add_f32 v215, v215, v118
 v_add_f32 v215, v215, v119
 v_cvt_pk_bf16_f32 v43, v118, v119
 v_exp_f32 v122, v26
 v_mfma_f32_32x32x16_bf16 v[96:111], a[44:47], v[32:35], v[96:111]
 ds_read_b128 a[16:19], v224 offset:8192
 ds_read_b128 a[20:23], v225 offset:8192
 v_exp_f32 v123, v27
 v_add_f32 v215, v215, v120
 v_mfma_f32_32x32x16_bf16 v[48:63], a[48:51], v[36:39], v[48:63]
 ds_read_b128 a[24:27], v226 offset:8192
 v_add_f32 v215, v215, v121
 v_cvt_pk_bf16_f32 v44, v120, v121
 v_exp_f32 v124, v28
 v_mfma_f32_32x32x16_bf16 v[64:79], a[52:55], v[36:39], v[64:79]
 ds_read_b128 a[28:31], v227 offset:8192
 v_exp_f32 v125, v29
 v_add_f32 v215, v215, v122
 v_add_f32 v215, v215, v123
 v_mfma_f32_32x32x16_bf16 v[80:95], a[56:59], v[36:39], v[80:95]
 v_cvt_pk_bf16_f32 v45, v122, v123
 v_exp_f32 v126, v30
 v_exp_f32 v127, v31
 v_add_f32 v215, v215, v124
 v_mfma_f32_32x32x16_bf16 v[96:111], a[60:63], v[36:39], v[96:111]
 v_add_f32 v215, v215, v125
 v_cvt_pk_bf16_f32 v46, v124, v125
 v_add_f32 v215, v215, v126
 v_add_f32 v215, v215, v127
 v_cvt_pk_bf16_f32 v47, v126, v127
 v_cmp_lt_f32 vcc, 0x45800000, v215
 s_cbranch_vccnz L_stub12
L_back12:
 v_add_f32 v218, v218, v215
 s_waitcnt lgkmcnt(0)
 s_barrier
 v_mfma_f32_32x32x16_bf16 v[16:31], a[0:3], a[64:67], v[128:143]
 ds_read_b64_tr_b16 a[32:33], v236 offset:32768
 ds_read_b64_tr_b16 a[34:35], v236 offset:34816
 ds_read_b64_tr_b16 a[36:37], v237 offset:32768
 v_exp_f32 v112, v0
 v_mfma_f32_32x32x16_bf16 v[16:31], a[4:7], a[68:71], v[16:31]
 ds_read_b64_tr_b16 a[38:39], v237 offset:34816
 ds_read_b64_tr_b16 a[40:41], v238 offset:32768
 ds_read_b64_tr_b16 a[42:43], v238 offset:34816
 s_add_u32 m0, s31, 0
 s_mov_b32 s34, 4210688
 buffer_load_dwordx4 v213, s[20:23], s34 offen nt lds
 v_mfma_f32_32x32x16_bf16 v[16:31], a[8:11], a[72:75], v[16:31]
 ds_read_b64_tr_b16 a[44:45], v239 offset:32768
 ds_read_b64_tr_b16 a[46:47], v239 offset:34816
 v_exp_f32 v113, v1
 v_exp_f32 v114, v2
 v_mfma_f32_32x32x16_bf16 v[16:31], a[12:15], a[76:79], v[16:31]
 ds_read_b64_tr_b16 a[48:49], v236 offset:36864
 ds_read_b64_tr_b16 a[50:51], v236 offset:38912
 ds_read_b64_tr_b16 a[52:53], v237 offset:36864
 v_exp_f32 v115, v3
 v_mfma_f32_32x32x16_bf16 v[16:31], a[16:19], a[80:83], v[16:31]
 ds_read_b64_tr_b16 a[54:55], v237 offset:38912
 ds_read_b64_tr_b16 a[56:57], v238 offset:36864
 ds_read_b64_tr_b16 a[58:59], v238 offset:38912
 v_add_f32 v215, v112, v113
 v_cvt_pk_bf16_f32 v32, v112, v113
 v_mfma_f32_32x32x16_bf16 v[16:31], a[20:23], a[84:87], v[16:31]
 ds_read_b64_tr_b16 a[60:61], v239 offset:36864
 ds_read_b64_tr_b16 a[62:63], v239 offset:38912
 v_exp_f32 v116, v4
 v_exp_f32 v117, v5
 v_mfma_f32_32x32x16_bf16 v[16:31], a[24:27], a[88:91], v[16:31]
 v_add_f32 v215, v215, v114
 v_add_f32 v215, v215, v115
 v_cvt_pk_bf16_f32 v33, v114, v115
 v_exp_f32 v118, v6
 v_mfma_f32_32x32x16_bf16 v[16:31], a[28:31], a[92:95], v[16:31]
 v_exp_f32 v119, v7
 v_add_f32 v215, v215, v116
 v_add_f32 v215, v215, v117
 v_cvt_pk_bf16_f32 v34, v116, v117
 s_waitcnt lgkmcnt(0)
 v_mfma_f32_32x32x16_bf16 v[48:63], a[32:35], v[40:43], v[48:63]
 ds_read_b128 a[0:3], v220 offset:57344
 ds_read_b128 a[4:7], v221 offset:57344
 v_exp_f32 v120, v8
 v_exp_f32 v121, v9
 v_mfma_f32_32x32x16_bf16 v[64:79], a[36:39], v[40:43], v[64:79]
 buffer_load_dwordx4 v213, s[20:23], s34 offen offset:1024 nt lds
 ds_read_b128 a[8:11], v222 offset:57344
 v_mfma_f32_32x32x16_bf16 v[80:95], a[40:43], v[40:43], v[80:95]
 ds_read_b128 a[12:15], v223 offset:57344
 v_add_f32 v215, v215, v118
 v_add_f32 v215, v215, v119
 v_cvt_pk_bf16_f32 v35, v118, v119
 v_exp_f32 v122, v10
 v_mfma_f32_32x32x16_bf16 v[96:111], a[44:47], v[40:43], v[96:111]
 ds_read_b128 a[16:19], v224 offset:57344
 ds_read_b128 a[20:23], v225 offset:57344
 v_exp_f32 v123, v11
 v_add_f32 v215, v215, v120
 v_mfma_f32_32x32x16_bf16 v[48:63], a[48:51], v[44:47], v[48:63]
 ds_read_b128 a[24:27], v226 offset:57344
 v_add_f32 v215, v215, v121
 v_cvt_pk_bf16_f32 v36, v120, v121
 v_exp_f32 v124, v12
 v_mfma_f32_32x32x16_bf16 v[64:79], a[52:55], v[44:47], v[64:79]
 ds_read_b128 a[28:31], v227 offset:57344
 v_exp_f32 v125, v13
 v_add_f32 v215, v215, v122
 v_add_f32 v215, v215, v123
 v_mfma_f32_32x32x16_bf16 v[80:95], a[56:59], v[44:47], v[80:95]
 v_cvt_pk_bf16_f32 v37, v122, v123
 v_exp_f32 v126, v14
 v_exp_f32 v127, v15
 v_add_f32 v215, v215, v124
 v_mfma_f32_32x32x16_bf16 v[96:111], a[60:63], v[44:47], v[96:111]
 v_add_f32 v215, v215, v125
 v_cvt_pk_bf16_f32 v38, v124, v125
 v_add_f32 v215, v215, v126
 v_add_f32 v215, v215, v127
 v_cvt_pk_bf16_f32 v39, v126, v127
 v_cmp_lt_f32 vcc, 0x45800000, v215
 s_cbranch_vccnz L_stub13
L_back13:
 v_add_f32 v218, v218, v215
 s_waitcnt lgkmcnt(0)
 s_barrier
 v_mfma_f32_32x32x16_bf16 v[0:15], a[0:3], a[96:99], 0
 ds_read_b64_tr_b16 a[32:33], v240 offset:0
 ds_read_b64_tr_b16 a[34:35], v240 offset:2048
 ds_read_b64_tr_b16 a[36:37], v241 offset:0
 v_exp_f32 v112, v16
 v_mfma_f32_32x32x16_bf16 v[0:15], a[4:7], a[100:103], v[0:15]
 ds_read_b64_tr_b16 a[38:39], v241 offset:2048
 ds_read_b64_tr_b16 a[40:41], v242 offset:0
 ds_read_b64_tr_b16 a[42:43], v242 offset:2048
 s_add_u32 m0, s31, 8192
 s_mov_b32 s34, 4235264
 buffer_load_dwordx4 v211, s[16:19], s34 offen nt lds
 v_mfma_f32_32x32x16_bf16 v[0:15], a[8:11], a[104:107], v[0:15]
 ds_read_b64_tr_b16 a[44:45], v243 offset:0
 ds_read_b64_tr_b16 a[46:47], v243 offset:2048
 v_exp_f32 v113, v17
 v_exp_f32 v114, v18
 v_mfma_f32_32x32x16_bf16 v[0:15], a[12:15], a[108:111], v[0:15]
 ds_read_b64_tr_b16 a[48:49], v240 offset:4096
 ds_read_b64_tr_b16 a[50:51], v240 offset:6144
 ds_read_b64_tr_b16 a[52:53], v241 offset:4096
 v_exp_f32 v115, v19
 v_mfma_f32_32x32x16_bf16 v[0:15], a[16:19], a[112:115], v[0:15]
 ds_read_b64_tr_b16 a[54:55], v241 offset:6144
 ds_read_b64_tr_b16 a[56:57], v242 offset:4096
 ds_read_b64_tr_b16 a[58:59], v242 offset:6144
 v_add_f32 v215, v112, v113
 v_cvt_pk_bf16_f32 v40, v112, v113
 v_mfma_f32_32x32x16_bf16 v[0:15], a[20:23], a[116:119], v[0:15]
 ds_read_b64_tr_b16 a[60:61], v243 offset:4096
 ds_read_b64_tr_b16 a[62:63], v243 offset:6144
 v_exp_f32 v116, v20
 v_exp_f32 v117, v21
 v_mfma_f32_32x32x16_bf16 v[0:15], a[24:27], a[120:123], v[0:15]
 v_add_f32 v215, v215, v114
 v_add_f32 v215, v215, v115
 v_cvt_pk_bf16_f32 v41, v114, v115
 v_exp_f32 v118, v22
 v_mfma_f32_32x32x16_bf16 v[0:15], a[28:31], a[124:127], v[0:15]
 v_exp_f32 v119, v23
 v_add_f32 v215, v215, v116
 v_add_f32 v215, v215, v117
 v_cvt_pk_bf16_f32 v42, v116, v117
 s_waitcnt lgkmcnt(0)
 v_mfma_f32_32x32x16_bf16 v[48:63], a[32:35], v[32:35], v[48:63]
 ds_read_b128 a[0:3], v228 offset:24576
 ds_read_b128 a[4:7], v229 offset:24576
 v_exp_f32 v120, v24
 v_exp_f32 v121, v25
 v_mfma_f32_32x32x16_bf16 v[64:79], a[36:39], v[32:35], v[64:79]
 buffer_load_dwordx4 v212, s[16:19], s34 offen offset:1024 nt lds
 ds_read_b128 a[8:11], v230 offset:24576
 v_mfma_f32_32x32x16_bf16 v[80:95], a[40:43], v[32:35], v[80:95]
 ds_read_b128 a[12:15], v231 offset:24576
 v_add_f32 v215, v215, v118
 v_add_f32 v215, v215, v119
 v_cvt_pk_bf16_f32 v43, v118, v119
 v_exp_f32 v122, v26
 v_mfma_f32_32x32x16_bf16 v[96:111], a[44:47], v[32:35], v[96:111]
 ds_read_b128 a[16:19], v232 offset:24576
 ds_read_b128 a[20:23], v233 offset:24576
 v_exp_f32 v123, v27
 v_add_f32 v215, v215, v120
 v_mfma_f32_32x32x16_bf16 v[48:63], a[48:51], v[36:39], v[48:63]
 ds_read_b128 a[24:27], v234 offset:24576
 v_add_f32 v215, v215, v121
 v_cvt_pk_bf16_f32 v44, v120, v121
 v_exp_f32 v124, v28
 v_mfma_f32_32x32x16_bf16 v[64:79], a[52:55], v[36:39], v[64:79]
 ds_read_b128 a[28:31], v235 offset:24576
 v_exp_f32 v125, v29
 v_add_f32 v215, v215, v122
 v_add_f32 v215, v215, v123
 v_mfma_f32_32x32x16_bf16 v[80:95], a[56:59], v[36:39], v[80:95]
 v_cvt_pk_bf16_f32 v45, v122, v123
 v_exp_f32 v126, v30
 v_exp_f32 v127, v31
 v_add_f32 v215, v215, v124
 v_mfma_f32_32x32x16_bf16 v[96:111], a[60:63], v[36:39], v[96:111]
 v_add_f32 v215, v215, v125
 v_cvt_pk_bf16_f32 v46, v124, v125
 v_add_f32 v215, v215, v126
 v_add_f32 v215, v215, v127
 v_cvt_pk_bf16_f32 v47, v126, v127
 v_cmp_lt_f32 vcc, 0x45800000, v215
 s_cbranch_vccnz L_stub14
L_back14:
 v_add_f32 v218, v218, v215
 v_max3_f32 v185, v0, v1, v2
 v_max3_f32 v185, v185, v3, v4
 v_max3_f32 v185, v185, v5, v6
 v_max3_f32 v185, v185, v7, v8
 v_max3_f32 v185, v185, v9, v10
 v_max3_f32 v185, v185, v11, v12
 v_max3_f32 v185, v185, v13, v14
 v_max_f32 v185, v185, v15
 v_mov_b32 v186, v185
 v_mov_b32 v219, 0
 s_nop 0
 v_permlane32_swap_b32 v185, v186
 v_max_f32 v185, v185, v186
 v_sub_f32 v128, 0, v185
 v_sub_f32 v129, 0, v185
 v_pk_add_f32 v[0:1], v[0:1], v[128:129]
 v_pk_add_f32 v[2:3], v[2:3], v[128:129]
 v_pk_mov_b32 v[130:131], v[128:129], v[128:129]
 v_pk_add_f32 v[4:5], v[4:5], v[128:129]
 v_pk_mov_b32 v[132:133], v[128:129], v[128:129]
 v_pk_add_f32 v[6:7], v[6:7], v[128:129]
 v_pk_mov_b32 v[134:135], v[128:129], v[128:129]
 v_pk_add_f32 v[8:9], v[8:9], v[128:129]
 v_pk_mov_b32 v[136:137], v[128:129], v[128:129]
 v_pk_add_f32 v[10:11], v[10:11], v[128:129]
 v_pk_mov_b32 v[138:139], v[128:129], v[128:129]
 v_pk_add_f32 v[12:13], v[12:13], v[128:129]
 v_pk_mov_b32 v[140:141], v[128:129], v[128:129]
 v_pk_add_f32 v[14:15], v[14:15], v[128:129]
 v_pk_mov_b32 v[142:143], v[128:129], v[128:129]
 s_waitcnt lgkmcnt(0)
 s_barrier
 v_mfma_f32_32x32x16_bf16 v[16:31], a[0:3], a[96:99], v[128:143]
 ds_read_b64_tr_b16 a[32:33], v240 offset:32768
 ds_read_b64_tr_b16 a[34:35], v240 offset:34816
 ds_read_b64_tr_b16 a[36:37], v241 offset:32768
 v_exp_f32 v112, v0
 v_mfma_f32_32x32x16_bf16 v[16:31], a[4:7], a[100:103], v[16:31]
 ds_read_b64_tr_b16 a[38:39], v241 offset:34816
 ds_read_b64_tr_b16 a[40:41], v242 offset:32768
 ds_read_b64_tr_b16 a[42:43], v242 offset:34816
 s_add_u32 m0, s31, 32768
 s_mov_b32 s34, 4218880
 buffer_load_dwordx4 v213, s[20:23], s34 offen nt lds
 v_mfma_f32_32x32x16_bf16 v[16:31], a[8:11], a[104:107], v[16:31]
 ds_read_b64_tr_b16 a[44:45], v243 offset:32768
 ds_read_b64_tr_b16 a[46:47], v243 offset:34816
 v_exp_f32 v113, v1
 v_exp_f32 v114, v2
 v_mfma_f32_32x32x16_bf16 v[16:31], a[12:15], a[108:111], v[16:31]
 ds_read_b64_tr_b16 a[48:49], v240 offset:36864
 ds_read_b64_tr_b16 a[50:51], v240 offset:38912
 ds_read_b64_tr_b16 a[52:53], v241 offset:36864
 v_exp_f32 v115, v3
 v_mfma_f32_32x32x16_bf16 v[16:31], a[16:19], a[112:115], v[16:31]
 ds_read_b64_tr_b16 a[54:55], v241 offset:38912
 ds_read_b64_tr_b16 a[56:57], v242 offset:36864
 ds_read_b64_tr_b16 a[58:59], v242 offset:38912
 v_add_f32 v215, v112, v113
 v_cvt_pk_bf16_f32 v32, v112, v113
 v_mfma_f32_32x32x16_bf16 v[16:31], a[20:23], a[116:119], v[16:31]
 ds_read_b64_tr_b16 a[60:61], v243 offset:36864
 ds_read_b64_tr_b16 a[62:63], v243 offset:38912
 v_exp_f32 v116, v4
 v_exp_f32 v117, v5
 v_mfma_f32_32x32x16_bf16 v[16:31], a[24:27], a[120:123], v[16:31]
 v_add_f32 v215, v215, v114
 v_add_f32 v215, v215, v115
 v_cvt_pk_bf16_f32 v33, v114, v115
 v_exp_f32 v118, v6
 v_mfma_f32_32x32x16_bf16 v[16:31], a[28:31], a[124:127], v[16:31]
 v_exp_f32 v119, v7
 v_add_f32 v215, v215, v116
 v_add_f32 v215, v215, v117
 v_cvt_pk_bf16_f32 v34, v116, v117
 s_waitcnt lgkmcnt(0)
 v_mfma_f32_32x32x16_bf16 v[48:63], a[32:35], v[40:43], v[48:63]
 ds_read_b128 a[0:3], v228 offset:40960
 ds_read_b128 a[4:7], v229 offset:40960
 v_exp_f32 v120, v8
 v_exp_f32 v121, v9
 v_mfma_f32_32x32x16_bf16 v[64:79], a[36:39], v[40:43], v[64:79]
 buffer_load_dwordx4 v213, s[20:23], s34 offen offset:1024 nt lds
 ds_read_b128 a[8:11], v230 offset:40960
 v_mfma_f32_32x32x16_bf16 v[80:95], a[40:43], v[40:43], v[80:95]
 ds_read_b128 a[12:15], v231 offset:40960
 v_add_f32 v215, v215, v118
 v_add_f32 v215, v215, v119
 v_cvt_pk_bf16_f32 v35, v118, v119
 v_exp_f32 v122, v10
 v_mfma_f32_32x32x16_bf16 v[96:111], a[44:47], v[40:43], v[96:111]
 ds_read_b128 a[16:19], v232 offset:40960
 ds_read_b128 a[20:23], v233 offset:40960
 v_exp_f32 v123, v11
 v_add_f32 v215, v215, v120
 v_mfma_f32_32x32x16_bf16 v[48:63], a[48:51], v[44:47], v[48:63]
 ds_read_b128 a[24:27], v234 offset:40960
 v_add_f32 v215, v215, v121
 v_cvt_pk_bf16_f32 v36, v120, v121
 v_exp_f32 v124, v12
 v_mfma_f32_32x32x16_bf16 v[64:79], a[52:55], v[44:47], v[64:79]
 ds_read_b128 a[28:31], v235 offset:40960
 v_exp_f32 v125, v13
 v_add_f32 v215, v215, v122
 v_add_f32 v215, v215, v123
 v_mfma_f32_32x32x16_bf16 v[80:95], a[56:59], v[44:47], v[80:95]
 v_cvt_pk_bf16_f32 v37, v122, v123
 v_exp_f32 v126, v14
 v_exp_f32 v127, v15
 v_add_f32 v215, v215, v124
 v_mfma_f32_32x32x16_bf16 v[96:111], a[60:63], v[44:47], v[96:111]
 v_add_f32 v215, v215, v125
 v_cvt_pk_bf16_f32 v38, v124, v125
 v_add_f32 v215, v215, v126
 v_add_f32 v215, v215, v127
 v_cvt_pk_bf16_f32 v39, v126, v127
 v_add_f32 v219, v219, v215
 v_mov_b32 v185, v218
 s_nop 1
 v_permlane32_swap_b32 v185, v218
 v_add_f32 v185, v185, v218
 v_rcp_f32 v185, v185
 s_nop 0
 v_mov_b32 v244, v185
 v_mov_b32 v245, v185
 v_pk_mul_f32 v[48:49], v[48:49], v[244:245]
 v_pk_mul_f32 v[50:51], v[50:51], v[244:245]
 v_pk_mul_f32 v[52:53], v[52:53], v[244:245]
 v_pk_mul_f32 v[54:55], v[54:55], v[244:245]
 v_cvt_pk_bf16_f32 v112, v48, v49
 v_cvt_pk_bf16_f32 v113, v50, v51
 v_cvt_pk_bf16_f32 v114, v52, v53
 v_cvt_pk_bf16_f32 v115, v54, v55
 buffer_store_dwordx4 v[112:115], v214, s[24:27], s56 offen offset:0 sc1
 v_pk_mul_f32 v[56:57], v[56:57], v[244:245]
 v_pk_mul_f32 v[58:59], v[58:59], v[244:245]
 v_pk_mul_f32 v[60:61], v[60:61], v[244:245]
 v_pk_mul_f32 v[62:63], v[62:63], v[244:245]
 v_cvt_pk_bf16_f32 v116, v56, v57
 v_cvt_pk_bf16_f32 v117, v58, v59
 v_cvt_pk_bf16_f32 v118, v60, v61
 v_cvt_pk_bf16_f32 v119, v62, v63
 buffer_store_dwordx4 v[116:119], v214, s[24:27], s56 offen offset:512 sc1
 v_pk_mul_f32 v[64:65], v[64:65], v[244:245]
 v_pk_mul_f32 v[66:67], v[66:67], v[244:245]
 v_pk_mul_f32 v[68:69], v[68:69], v[244:245]
 v_pk_mul_f32 v[70:71], v[70:71], v[244:245]
 v_cvt_pk_bf16_f32 v120, v64, v65
 v_cvt_pk_bf16_f32 v121, v66, v67
 v_cvt_pk_bf16_f32 v122, v68, v69
 v_cvt_pk_bf16_f32 v123, v70, v71
 buffer_store_dwordx4 v[120:123], v214, s[24:27], s56 offen offset:1024 sc1
 v_pk_mul_f32 v[72:73], v[72:73], v[244:245]
 v_pk_mul_f32 v[74:75], v[74:75], v[244:245]
 v_pk_mul_f32 v[76:77], v[76:77], v[244:245]
 v_pk_mul_f32 v[78:79], v[78:79], v[244:245]
 v_cvt_pk_bf16_f32 v124, v72, v73
 v_cvt_pk_bf16_f32 v125, v74, v75
 v_cvt_pk_bf16_f32 v126, v76, v77
 v_cvt_pk_bf16_f32 v127, v78, v79
 buffer_store_dwordx4 v[124:127], v214, s[24:27], s56 offen offset:1536 sc1
 v_pk_mul_f32 v[80:81], v[80:81], v[244:245]
 v_pk_mul_f32 v[82:83], v[82:83], v[244:245]
 v_pk_mul_f32 v[84:85], v[84:85], v[244:245]
 v_pk_mul_f32 v[86:87], v[86:87], v[244:245]
 v_cvt_pk_bf16_f32 v112, v80, v81
 v_cvt_pk_bf16_f32 v113, v82, v83
 v_cvt_pk_bf16_f32 v114, v84, v85
 v_cvt_pk_bf16_f32 v115, v86, v87
 buffer_store_dwordx4 v[112:115], v214, s[24:27], s57 offen offset:0 sc1
 v_pk_mul_f32 v[88:89], v[88:89], v[244:245]
 v_pk_mul_f32 v[90:91], v[90:91], v[244:245]
 v_pk_mul_f32 v[92:93], v[92:93], v[244:245]
 v_pk_mul_f32 v[94:95], v[94:95], v[244:245]
 v_cvt_pk_bf16_f32 v116, v88, v89
 v_cvt_pk_bf16_f32 v117, v90, v91
 v_cvt_pk_bf16_f32 v118, v92, v93
 v_cvt_pk_bf16_f32 v119, v94, v95
 buffer_store_dwordx4 v[116:119], v214, s[24:27], s57 offen offset:512 sc1
 v_pk_mul_f32 v[96:97], v[96:97], v[244:245]
 v_pk_mul_f32 v[98:99], v[98:99], v[244:245]
 v_pk_mul_f32 v[100:101], v[100:101], v[244:245]
 v_pk_mul_f32 v[102:103], v[102:103], v[244:245]
 v_cvt_pk_bf16_f32 v120, v96, v97
 v_cvt_pk_bf16_f32 v121, v98, v99
 v_cvt_pk_bf16_f32 v122, v100, v101
 v_cvt_pk_bf16_f32 v123, v102, v103
 buffer_store_dwordx4 v[120:123], v214, s[24:27], s57 offen offset:1024 sc1
 v_pk_mul_f32 v[104:105], v[104:105], v[244:245]
 v_pk_mul_f32 v[106:107], v[106:107], v[244:245]
 v_pk_mul_f32 v[108:109], v[108:109], v[244:245]
 v_pk_mul_f32 v[110:111], v[110:111], v[244:245]
 v_cvt_pk_bf16_f32 v124, v104, v105
 v_cvt_pk_bf16_f32 v125, v106, v107
 v_cvt_pk_bf16_f32 v126, v108, v109
 v_cvt_pk_bf16_f32 v127, v110, v111
 buffer_store_dwordx4 v[124:127], v214, s[24:27], s57 offen offset:1536 sc1
 s_waitcnt vmcnt(18) lgkmcnt(0)
 s_barrier
 v_mfma_f32_32x32x16_bf16 v[0:15], a[0:3], a[96:99], v[128:143]
 ds_read_b64_tr_b16 a[32:33], v240 offset:49152
 ds_read_b64_tr_b16 a[34:35], v240 offset:51200
 ds_read_b64_tr_b16 a[36:37], v241 offset:49152
 v_exp_f32 v112, v16
 v_mfma_f32_32x32x16_bf16 v[0:15], a[4:7], a[100:103], v[0:15]
 ds_read_b64_tr_b16 a[38:39], v241 offset:51200
 ds_read_b64_tr_b16 a[40:41], v242 offset:49152
 ds_read_b64_tr_b16 a[42:43], v242 offset:51200
 s_add_u32 m0, s31, 40960
 s_mov_b32 s34, 4243456
 buffer_load_dwordx4 v211, s[16:19], s34 offen nt lds
 v_mfma_f32_32x32x16_bf16 v[0:15], a[8:11], a[104:107], v[0:15]
 ds_read_b64_tr_b16 a[44:45], v243 offset:49152
 ds_read_b64_tr_b16 a[46:47], v243 offset:51200
 v_exp_f32 v113, v17
 v_exp_f32 v114, v18
 v_mfma_f32_32x32x16_bf16 v[0:15], a[12:15], a[108:111], v[0:15]
 ds_read_b64_tr_b16 a[48:49], v240 offset:53248
 ds_read_b64_tr_b16 a[50:51], v240 offset:55296
 ds_read_b64_tr_b16 a[52:53], v241 offset:53248
 v_exp_f32 v115, v19
 v_mfma_f32_32x32x16_bf16 v[0:15], a[16:19], a[112:115], v[0:15]
 ds_read_b64_tr_b16 a[54:55], v241 offset:55296
 ds_read_b64_tr_b16 a[56:57], v242 offset:53248
 ds_read_b64_tr_b16 a[58:59], v242 offset:55296
 v_add_f32 v215, v112, v113
 v_cvt_pk_bf16_f32 v40, v112, v113
 v_mfma_f32_32x32x16_bf16 v[0:15], a[20:23], a[116:119], v[0:15]
 ds_read_b64_tr_b16 a[60:61], v243 offset:53248
 ds_read_b64_tr_b16 a[62:63], v243 offset:55296
 v_exp_f32 v116, v20
 v_exp_f32 v117, v21
 v_mfma_f32_32x32x16_bf16 v[0:15], a[24:27], a[120:123], v[0:15]
 v_add_f32 v215, v215, v114
 v_add_f32 v215, v215, v115
 v_cvt_pk_bf16_f32 v41, v114, v115
 v_exp_f32 v118, v22
 v_mfma_f32_32x32x16_bf16 v[0:15], a[28:31], a[124:127], v[0:15]
 v_exp_f32 v119, v23
 v_add_f32 v215, v215, v116
 v_add_f32 v215, v215, v117
 v_cvt_pk_bf16_f32 v42, v116, v117
 s_waitcnt lgkmcnt(0)
 v_mfma_f32_32x32x16_bf16 v[48:63], a[32:35], v[32:35], 0
 ds_read_b128 a[0:3], v228 offset:57344
 ds_read_b128 a[4:7], v229 offset:57344
 v_exp_f32 v120, v24
 v_exp_f32 v121, v25
 v_mfma_f32_32x32x16_bf16 v[64:79], a[36:39], v[32:35], 0
 buffer_load_dwordx4 v212, s[16:19], s34 offen offset:1024 nt lds
 ds_read_b128 a[8:11], v230 offset:57344
 v_mfma_f32_32x32x16_bf16 v[80:95], a[40:43], v[32:35], 0
 ds_read_b128 a[12:15], v231 offset:57344
 v_add_f32 v215, v215, v118
 v_add_f32 v215, v215, v119
 v_cvt_pk_bf16_f32 v43, v118, v119
 v_exp_f32 v122, v26
 v_mfma_f32_32x32x16_bf16 v[96:111], a[44:47], v[32:35], 0
 ds_read_b128 a[16:19], v232 offset:57344
 ds_read_b128 a[20:23], v233 offset:57344
 v_exp_f32 v123, v27
 v_add_f32 v215, v215, v120
 v_mfma_f32_32x32x16_bf16 v[48:63], a[48:51], v[36:39], v[48:63]
 ds_read_b128 a[24:27], v234 offset:57344
 v_add_f32 v215, v215, v121
 v_cvt_pk_bf16_f32 v44, v120, v121
 v_exp_f32 v124, v28
 v_mfma_f32_32x32x16_bf16 v[64:79], a[52:55], v[36:39], v[64:79]
 ds_read_b128 a[28:31], v235 offset:57344
 v_exp_f32 v125, v29
 v_add_f32 v215, v215, v122
 v_add_f32 v215, v215, v123
 v_mfma_f32_32x32x16_bf16 v[80:95], a[56:59], v[36:39], v[80:95]
 v_cvt_pk_bf16_f32 v45, v122, v123
 v_exp_f32 v126, v30
 v_exp_f32 v127, v31
 v_add_f32 v215, v215, v124
 v_mfma_f32_32x32x16_bf16 v[96:111], a[60:63], v[36:39], v[96:111]
 v_add_f32 v215, v215, v125
 v_cvt_pk_bf16_f32 v46, v124, v125
 v_add_f32 v215, v215, v126
 v_add_f32 v215, v215, v127
 v_cvt_pk_bf16_f32 v47, v126, v127
 v_cmp_lt_f32 vcc, 0x45800000, v215
 s_cbranch_vccnz L_stub15
L_back15:
 v_add_f32 v219, v219, v215
 s_waitcnt vmcnt(16) lgkmcnt(0)
 s_barrier
 v_mfma_f32_32x32x16_bf16 v[16:31], a[0:3], a[96:99], v[128:143]
 ds_read_b64_tr_b16 a[32:33], v236 offset:16384
 ds_read_b64_tr_b16 a[34:35], v236 offset:18432
 ds_read_b64_tr_b16 a[36:37], v237 offset:16384
 v_exp_f32 v112, v0
 v_mfma_f32_32x32x16_bf16 v[16:31], a[4:7], a[100:103], v[16:31]
 ds_read_b64_tr_b16 a[38:39], v237 offset:18432
 ds_read_b64_tr_b16 a[40:41], v238 offset:16384
 ds_read_b64_tr_b16 a[42:43], v238 offset:18432
 s_add_u32 m0, s31, 49152
 s_mov_b32 s34, 4227072
 buffer_load_dwordx4 v213, s[20:23], s34 offen nt lds
 v_mfma_f32_32x32x16_bf16 v[16:31], a[8:11], a[104:107], v[16:31]
 ds_read_b64_tr_b16 a[44:45], v239 offset:16384
 ds_read_b64_tr_b16 a[46:47], v239 offset:18432
 v_exp_f32 v113, v1
 v_exp_f32 v114, v2
 v_mfma_f32_32x32x16_bf16 v[16:31], a[12:15], a[108:111], v[16:31]
 ds_read_b64_tr_b16 a[48:49], v236 offset:20480
 ds_read_b64_tr_b16 a[50:51], v236 offset:22528
 ds_read_b64_tr_b16 a[52:53], v237 offset:20480
 v_exp_f32 v115, v3
 v_mfma_f32_32x32x16_bf16 v[16:31], a[16:19], a[112:115], v[16:31]
 ds_read_b64_tr_b16 a[54:55], v237 offset:22528
 ds_read_b64_tr_b16 a[56:57], v238 offset:20480
 ds_read_b64_tr_b16 a[58:59], v238 offset:22528
 v_add_f32 v215, v112, v113
 v_cvt_pk_bf16_f32 v32, v112, v113
 v_mfma_f32_32x32x16_bf16 v[16:31], a[20:23], a[116:119], v[16:31]
 ds_read_b64_tr_b16 a[60:61], v239 offset:20480
 ds_read_b64_tr_b16 a[62:63], v239 offset:22528
 v_exp_f32 v116, v4
 v_exp_f32 v117, v5
 v_mfma_f32_32x32x16_bf16 v[16:31], a[24:27], a[120:123], v[16:31]
 v_add_f32 v215, v215, v114
 v_add_f32 v215, v215, v115
 v_cvt_pk_bf16_f32 v33, v114, v115
 v_exp_f32 v118, v6
 v_mfma_f32_32x32x16_bf16 v[16:31], a[28:31], a[124:127], v[16:31]
 v_exp_f32 v119, v7
 v_add_f32 v215, v215, v116
 v_add_f32 v215, v215, v117
 v_cvt_pk_bf16_f32 v34, v116, v117
 s_waitcnt lgkmcnt(0)
 v_mfma_f32_32x32x16_bf16 v[48:63], a[32:35], v[40:43], v[48:63]
 ds_read_b128 a[0:3], v220 offset:24576
 ds_read_b128 a[4:7], v221 offset:24576
 v_exp_f32 v120, v8
 v_exp_f32 v121, v9
 v_mfma_f32_32x32x16_bf16 v[64:79], a[36:39], v[40:43], v[64:79]
 buffer_load_dwordx4 v213, s[20:23], s34 offen offset:1024 nt lds
 ds_read_b128 a[8:11], v222 offset:24576
 v_mfma_f32_32x32x16_bf16 v[80:95], a[40:43], v[40:43], v[80:95]
 ds_read_b128 a[12:15], v223 offset:24576
 v_add_f32 v215, v215, v118
 v_add_f32 v215, v215, v119
 v_cvt_pk_bf16_f32 v35, v118, v119
 v_exp_f32 v122, v10
 v_mfma_f32_32x32x16_bf16 v[96:111], a[44:47], v[40:43], v[96:111]
 ds_read_b128 a[16:19], v224 offset:24576
 ds_read_b128 a[20:23], v225 offset:24576
 v_exp_f32 v123, v11
 v_add_f32 v215, v215, v120
 v_mfma_f32_32x32x16_bf16 v[48:63], a[48:51], v[44:47], v[48:63]
 ds_read_b128 a[24:27], v226 offset:24576
 v_add_f32 v215, v215, v121
 v_cvt_pk_bf16_f32 v36, v120, v121
 v_exp_f32 v124, v12
 v_mfma_f32_32x32x16_bf16 v[64:79], a[52:55], v[44:47], v[64:79]
 ds_read_b128 a[28:31], v227 offset:24576
 v_exp_f32 v125, v13
 v_add_f32 v215, v215, v122
 v_add_f32 v215, v215, v123
 v_mfma_f32_32x32x16_bf16 v[80:95], a[56:59], v[44:47], v[80:95]
 v_cvt_pk_bf16_f32 v37, v122, v123
 v_exp_f32 v126, v14
 v_exp_f32 v127, v15
 v_add_f32 v215, v215, v124
 v_mfma_f32_32x32x16_bf16 v[96:111], a[60:63], v[44:47], v[96:111]
 v_add_f32 v215, v215, v125
 v_cvt_pk_bf16_f32 v38, v124, v125
 v_add_f32 v215, v215, v126
 v_add_f32 v215, v215, v127
 v_cvt_pk_bf16_f32 v39, v126, v127
 v_cmp_lt_f32 vcc, 0x45800000, v215
 s_cbranch_vccnz L_stub16
L_back16:
 v_add_f32 v219, v219, v215
 s_waitcnt vmcnt(14) lgkmcnt(0)
 s_barrier
 v_mfma_f32_32x32x16_bf16 v[0:15], a[0:3], a[96:99], v[128:143]
 ds_read_b64_tr_b16 a[32:33], v236 offset:0
 ds_read_b64_tr_b16 a[34:35], v236 offset:2048
 ds_read_b64_tr_b16 a[36:37], v237 offset:0
 v_exp_f32 v112, v16
 v_mfma_f32_32x32x16_bf16 v[0:15], a[4:7], a[100:103], v[0:15]
 ds_read_b64_tr_b16 a[38:39], v237 offset:2048
 ds_read_b64_tr_b16 a[40:41], v238 offset:0
 ds_read_b64_tr_b16 a[42:43], v238 offset:2048
 s_add_u32 m0, s31, 16384
 s_mov_b32 s34, 4251648
 buffer_load_dwordx4 v211, s[16:19], s34 offen nt lds
 v_mfma_f32_32x32x16_bf16 v[0:15], a[8:11], a[104:107], v[0:15]
 ds_read_b64_tr_b16 a[44:45], v239 offset:0
 ds_read_b64_tr_b16 a[46:47], v239 offset:2048
 v_exp_f32 v113, v17
 v_exp_f32 v114, v18
 v_mfma_f32_32x32x16_bf16 v[0:15], a[12:15], a[108:111], v[0:15]
 ds_read_b64_tr_b16 a[48:49], v236 offset:4096
 ds_read_b64_tr_b16 a[50:51], v236 offset:6144
 ds_read_b64_tr_b16 a[52:53], v237 offset:4096
 v_exp_f32 v115, v19
 v_mfma_f32_32x32x16_bf16 v[0:15], a[16:19], a[112:115], v[0:15]
 ds_read_b64_tr_b16 a[54:55], v237 offset:6144
 ds_read_b64_tr_b16 a[56:57], v238 offset:4096
 ds_read_b64_tr_b16 a[58:59], v238 offset:6144
 v_add_f32 v215, v112, v113
 v_cvt_pk_bf16_f32 v40, v112, v113
 v_mfma_f32_32x32x16_bf16 v[0:15], a[20:23], a[116:119], v[0:15]
 ds_read_b64_tr_b16 a[60:61], v239 offset:4096
 ds_read_b64_tr_b16 a[62:63], v239 offset:6144
 v_exp_f32 v116, v20
 v_exp_f32 v117, v21
 v_mfma_f32_32x32x16_bf16 v[0:15], a[24:27], a[120:123], v[0:15]
 v_add_f32 v215, v215, v114
 v_add_f32 v215, v215, v115
 v_cvt_pk_bf16_f32 v41, v114, v115
 v_exp_f32 v118, v22
 v_mfma_f32_32x32x16_bf16 v[0:15], a[28:31], a[124:127], v[0:15]
 v_exp_f32 v119, v23
 v_add_f32 v215, v215, v116
 v_add_f32 v215, v215, v117
 v_cvt_pk_bf16_f32 v42, v116, v117
 s_waitcnt lgkmcnt(0)
 v_mfma_f32_32x32x16_bf16 v[48:63], a[32:35], v[32:35], v[48:63]
 ds_read_b128 a[0:3], v220 offset:8192
 ds_read_b128 a[4:7], v221 offset:8192
 v_exp_f32 v120, v24
 v_exp_f32 v121, v25
 v_mfma_f32_32x32x16_bf16 v[64:79], a[36:39], v[32:35], v[64:79]
 buffer_load_dwordx4 v212, s[16:19], s34 offen offset:1024 nt lds
 ds_read_b128 a[8:11], v222 offset:8192
 v_mfma_f32_32x32x16_bf16 v[80:95], a[40:43], v[32:35], v[80:95]
 ds_read_b128 a[12:15], v223 offset:8192
 v_add_f32 v215, v215, v118
 v_add_f32 v215, v215, v119
 v_cvt_pk_bf16_f32 v43, v118, v119
 v_exp_f32 v122, v26
 v_mfma_f32_32x32x16_bf16 v[96:111], a[44:47], v[32:35], v[96:111]
 ds_read_b128 a[16:19], v224 offset:8192
 ds_read_b128 a[20:23], v225 offset:8192
 v_exp_f32 v123, v27
 v_add_f32 v215, v215, v120
 v_mfma_f32_32x32x16_bf16 v[48:63], a[48:51], v[36:39], v[48:63]
 ds_read_b128 a[24:27], v226 offset:8192
 v_add_f32 v215, v215, v121
 v_cvt_pk_bf16_f32 v44, v120, v121
 v_exp_f32 v124, v28
 v_mfma_f32_32x32x16_bf16 v[64:79], a[52:55], v[36:39], v[64:79]
 ds_read_b128 a[28:31], v227 offset:8192
 v_exp_f32 v125, v29
 v_add_f32 v215, v215, v122
 v_add_f32 v215, v215, v123
 v_mfma_f32_32x32x16_bf16 v[80:95], a[56:59], v[36:39], v[80:95]
 v_cvt_pk_bf16_f32 v45, v122, v123
 v_exp_f32 v126, v30
 v_exp_f32 v127, v31
 v_add_f32 v215, v215, v124
 v_mfma_f32_32x32x16_bf16 v[96:111], a[60:63], v[36:39], v[96:111]
 v_add_f32 v215, v215, v125
 v_cvt_pk_bf16_f32 v46, v124, v125
 v_add_f32 v215, v215, v126
 v_add_f32 v215, v215, v127
 v_cvt_pk_bf16_f32 v47, v126, v127
 v_cmp_lt_f32 vcc, 0x45800000, v215
 s_cbranch_vccnz L_stub17
L_back17:
 v_add_f32 v219, v219, v215
 s_waitcnt vmcnt(4) lgkmcnt(0)
 s_barrier
 v_mfma_f32_32x32x16_bf16 v[16:31], a[0:3], a[96:99], v[128:143]
 ds_read_b64_tr_b16 a[32:33], v236 offset:32768
 ds_read_b64_tr_b16 a[34:35], v236 offset:34816
 ds_read_b64_tr_b16 a[36:37], v237 offset:32768
 v_exp_f32 v112, v0
 v_mfma_f32_32x32x16_bf16 v[16:31], a[4:7], a[100:103], v[16:31]
 ds_read_b64_tr_b16 a[38:39], v237 offset:34816
 ds_read_b64_tr_b16 a[40:41], v238 offset:32768
 ds_read_b64_tr_b16 a[42:43], v238 offset:34816
 buffer_store_dword v198, v195, s[92:95], 0 offen offset:0 sc1
 v_mfma_f32_32x32x16_bf16 v[16:31], a[8:11], a[104:107], v[16:31]
 ds_read_b64_tr_b16 a[44:45], v239 offset:32768
 ds_read_b64_tr_b16 a[46:47], v239 offset:34816
 v_exp_f32 v113, v1
 v_exp_f32 v114, v2
 v_mfma_f32_32x32x16_bf16 v[16:31], a[12:15], a[108:111], v[16:31]
 ds_read_b64_tr_b16 a[48:49], v236 offset:36864
 ds_read_b64_tr_b16 a[50:51], v236 offset:38912
 ds_read_b64_tr_b16 a[52:53], v237 offset:36864
 v_exp_f32 v115, v3
 v_mfma_f32_32x32x16_bf16 v[16:31], a[16:19], a[112:115], v[16:31]
 ds_read_b64_tr_b16 a[54:55], v237 offset:38912
 ds_read_b64_tr_b16 a[56:57], v238 offset:36864
 ds_read_b64_tr_b16 a[58:59], v238 offset:38912
 s_add_u32 m0, s31, 0
 s_mov_b32 s34, 4235264
 buffer_load_dwordx4 v213, s[20:23], s34 offen nt lds
 v_mfma_f32_32x32x16_bf16 v[16:31], a[20:23], a[116:119], v[16:31]
 ds_read_b64_tr_b16 a[60:61], v239 offset:36864
 ds_read_b64_tr_b16 a[62:63], v239 offset:38912
 v_add_f32 v215, v112, v113
 v_cvt_pk_bf16_f32 v32, v112, v113
 v_exp_f32 v116, v4
 v_mfma_f32_32x32x16_bf16 v[16:31], a[24:27], a[120:123], v[16:31]
 v_exp_f32 v117, v5
 v_add_f32 v215, v215, v114
 v_add_f32 v215, v215, v115
 v_cvt_pk_bf16_f32 v33, v114, v115
 v_mfma_f32_32x32x16_bf16 v[16:31], a[28:31], a[124:127], v[16:31]
 v_exp_f32 v118, v6
 v_exp_f32 v119, v7
 v_add_f32 v215, v215, v116
 v_add_f32 v215, v215, v117
 s_waitcnt lgkmcnt(0)
 v_mfma_f32_32x32x16_bf16 v[48:63], a[32:35], v[40:43], v[48:63]
 ds_read_b128 a[0:3], v220 offset:40960
 ds_read_b128 a[4:7], v221 offset:40960
 v_cvt_pk_bf16_f32 v34, v116, v117
 v_exp_f32 v120, v8
 v_mfma_f32_32x32x16_bf16 v[64:79], a[36:39], v[40:43], v[64:79]
 ds_read_b128 a[8:11], v222 offset:40960
 v_exp_f32 v121, v9
 v_add_f32 v215, v215, v118
 v_add_f32 v215, v215, v119
 v_mfma_f32_32x32x16_bf16 v[80:95], a[40:43], v[40:43], v[80:95]
 buffer_load_dwordx4 v213, s[20:23], s34 offen offset:1024 nt lds
 ds_read_b128 a[12:15], v223 offset:40960
 v_cvt_pk_bf16_f32 v35, v118, v119
 v_mfma_f32_32x32x16_bf16 v[96:111], a[44:47], v[40:43], v[96:111]
 ds_read_b128 a[16:19], v224 offset:40960
 ds_read_b128 a[20:23], v225 offset:40960
 v_exp_f32 v122, v10
 v_exp_f32 v123, v11
 v_mfma_f32_32x32x16_bf16 v[48:63], a[48:51], v[44:47], v[48:63]
 ds_read_b128 a[24:27], v226 offset:40960
 v_add_f32 v215, v215, v120
 v_add_f32 v215, v215, v121
 v_cvt_pk_bf16_f32 v36, v120, v121
 v_exp_f32 v124, v12
 v_mfma_f32_32x32x16_bf16 v[64:79], a[52:55], v[44:47], v[64:79]
 ds_read_b128 a[28:31], v227 offset:40960
 v_exp_f32 v125, v13
 v_add_f32 v215, v215, v122
 v_add_f32 v215, v215, v123
 v_mfma_f32_32x32x16_bf16 v[80:95], a[56:59], v[44:47], v[80:95]
 v_cvt_pk_bf16_f32 v37, v122, v123
 v_exp_f32 v126, v14
 v_exp_f32 v127, v15
 v_add_f32 v215, v215, v124
 v_mfma_f32_32x32x16_bf16 v[96:111], a[60:63], v[44:47], v[96:111]
 v_add_f32 v215, v215, v125
 v_cvt_pk_bf16_f32 v38, v124, v125
 v_add_f32 v215, v215, v126
 v_add_f32 v215, v215, v127
 v_cvt_pk_bf16_f32 v39, v126, v127
 v_cmp_lt_f32 vcc, 0x45800000, v215
 s_cbranch_vccnz L_stub18
L_back18:
 v_add_f32 v219, v219, v215
 s_waitcnt vmcnt(3) lgkmcnt(0)
 s_barrier
 v_mfma_f32_32x32x16_bf16 v[0:15], a[0:3], a[96:99], v[128:143]
 ds_read_b64_tr_b16 a[32:33], v236 offset:49152
 ds_read_b64_tr_b16 a[34:35], v236 offset:51200
 ds_read_b64_tr_b16 a[36:37], v237 offset:49152
 v_exp_f32 v112, v16
 v_mfma_f32_32x32x16_bf16 v[0:15], a[4:7], a[100:103], v[0:15]
 ds_read_b64_tr_b16 a[38:39], v237 offset:51200
 ds_read_b64_tr_b16 a[40:41], v238 offset:49152
 ds_read_b64_tr_b16 a[42:43], v238 offset:51200
 s_add_u32 m0, s31, 8192
 s_mov_b32 s34, 4259840
 buffer_load_dwordx4 v211, s[16:19], s34 offen nt lds
 v_mfma_f32_32x32x16_bf16 v[0:15], a[8:11], a[104:107], v[0:15]
 ds_read_b64_tr_b16 a[44:45], v239 offset:49152
 ds_read_b64_tr_b16 a[46:47], v239 offset:51200
 v_exp_f32 v113, v17
 v_exp_f32 v114, v18
 v_mfma_f32_32x32x16_bf16 v[0:15], a[12:15], a[108:111], v[0:15]
 ds_read_b64_tr_b16 a[48:49], v236 offset:53248
 ds_read_b64_tr_b16 a[50:51], v236 offset:55296
 ds_read_b64_tr_b16 a[52:53], v237 offset:53248
 v_exp_f32 v115, v19
 v_add_f32 v215, v112, v113
 v_mfma_f32_32x32x16_bf16 v[0:15], a[16:19], a[112:115], v[0:15]
 ds_read_b64_tr_b16 a[54:55], v237 offset:55296
 ds_read_b64_tr_b16 a[56:57], v238 offset:53248
 ds_read_b64_tr_b16 a[58:59], v238 offset:55296
 v_cvt_pk_bf16_f32 v40, v112, v113
 v_exp_f32 v116, v20
 v_mfma_f32_32x32x16_bf16 v[0:15], a[20:23], a[116:119], v[0:15]
 ds_read_b64_tr_b16 a[60:61], v239 offset:53248
 ds_read_b64_tr_b16 a[62:63], v239 offset:55296
 buffer_load_dwordx4 v212, s[16:19], s34 offen offset:1024 nt lds
 v_exp_f32 v117, v21
 v_mfma_f32_32x32x16_bf16 v[0:15], a[24:27], a[120:123], v[0:15]
 v_add_f32 v215, v215, v114
 v_add_f32 v215, v215, v115
 v_cvt_pk_bf16_f32 v41, v114, v115
 v_exp_f32 v118, v22
 v_mfma_f32_32x32x16_bf16 v[0:15], a[28:31], a[124:127], v[0:15]
 s_add_u32 m0, s31, 24576
 s_mov_b32 s34, 4243456
 buffer_load_dwordx4 v213, s[20:23], s34 offen nt lds
 s_waitcnt lgkmcnt(0)
 v_mfma_f32_32x32x16_bf16 v[48:63], a[32:35], v[32:35], v[48:63]
 ds_read_b128 a[0:3], v220 offset:16384
 ds_read_b128 a[4:7], v221 offset:16384
 v_exp_f32 v119, v23
 v_add_f32 v215, v215, v116
 v_add_f32 v215, v215, v117
 v_mfma_f32_32x32x16_bf16 v[64:79], a[36:39], v[32:35], v[64:79]
 ds_read_b128 a[8:11], v222 offset:16384
 v_cvt_pk_bf16_f32 v42, v116, v117
 v_exp_f32 v120, v24
 v_exp_f32 v121, v25
 v_mfma_f32_32x32x16_bf16 v[80:95], a[40:43], v[32:35], v[80:95]
 ds_read_b128 a[12:15], v223 offset:16384
 v_add_f32 v215, v215, v118
 v_add_f32 v215, v215, v119
 v_cvt_pk_bf16_f32 v43, v118, v119
 v_exp_f32 v122, v26
 v_mfma_f32_32x32x16_bf16 v[96:111], a[44:47], v[32:35], v[96:111]
 buffer_load_dwordx4 v213, s[20:23], s34 offen offset:1024 nt lds
 ds_read_b128 a[16:19], v224 offset:16384
 ds_read_b128 a[20:23], v225 offset:16384
 v_mfma_f32_32x32x16_bf16 v[48:63], a[48:51], v[36:39], v[48:63]
 ds_read_b128 a[24:27], v226 offset:16384
 v_exp_f32 v123, v27
 v_add_f32 v215, v215, v120
 v_add_f32 v215, v215, v121
 v_cvt_pk_bf16_f32 v44, v120, v121
 v_mfma_f32_32x32x16_bf16 v[64:79], a[52:55], v[36:39], v[64:79]
 ds_read_b128 a[28:31], v227 offset:16384
 v_exp_f32 v124, v28
 v_exp_f32 v125, v29
 v_add_f32 v215, v215, v122
 v_mfma_f32_32x32x16_bf16 v[80:95], a[56:59], v[36:39], v[80:95]
 v_add_f32 v215, v215, v123
 v_cvt_pk_bf16_f32 v45, v122, v123
 v_exp_f32 v126, v30
 v_exp_f32 v127, v31
 v_mfma_f32_32x32x16_bf16 v[96:111], a[60:63], v[36:39], v[96:111]
 v_add_f32 v215, v215, v124
 v_add_f32 v215, v215, v125
 v_cvt_pk_bf16_f32 v46, v124, v125
 v_add_f32 v215, v215, v126
 v_add_f32 v215, v215, v127
 v_cvt_pk_bf16_f32 v47, v126, v127
 v_cmp_lt_f32 vcc, 0x45800000, v215
 s_cbranch_vccnz L_stub19
L_back19:
 v_add_f32 v219, v219, v215
 s_waitcnt vmcnt(2) lgkmcnt(0)
 s_barrier
 v_mfma_f32_32x32x16_bf16 v[16:31], a[0:3], a[96:99], v[128:143]
 ds_read_b64_tr_b16 a[32:33], v236 offset:0
 ds_read_b64_tr_b16 a[34:35], v236 offset:2048
 ds_read_b64_tr_b16 a[36:37], v237 offset:0
 v_exp_f32 v112, v0
 v_exp_f32 v113, v1
 v_mfma_f32_32x32x16_bf16 v[16:31], a[4:7], a[100:103], v[16:31]
 ds_read_b64_tr_b16 a[38:39], v237 offset:2048
 ds_read_b64_tr_b16 a[40:41], v238 offset:0
 ds_read_b64_tr_b16 a[42:43], v238 offset:2048
 s_add_u32 m0, s31, 16384
 s_mov_b32 s34, 4268032
 buffer_load_dwordx4 v211, s[16:19], s34 offen nt lds
 v_mfma_f32_32x32x16_bf16 v[16:31], a[8:11], a[104:107], v[16:31]
 ds_read_b64_tr_b16 a[44:45], v239 offset:0
 ds_read_b64_tr_b16 a[46:47], v239 offset:2048
 v_exp_f32 v114, v2
 v_exp_f32 v115, v3
 v_mfma_f32_32x32x16_bf16 v[16:31], a[12:15], a[108:111], v[16:31]
 ds_read_b64_tr_b16 a[48:49], v236 offset:4096
 ds_read_b64_tr_b16 a[50:51], v236 offset:6144
 ds_read_b64_tr_b16 a[52:53], v237 offset:4096
 buffer_load_dwordx4 v212, s[16:19], s34 offen offset:1024 nt lds
 v_mfma_f32_32x32x16_bf16 v[16:31], a[16:19], a[112:115], v[16:31]
 ds_read_b64_tr_b16 a[54:55], v237 offset:6144
 ds_read_b64_tr_b16 a[56:57], v238 offset:4096
 ds_read_b64_tr_b16 a[58:59], v238 offset:6144
 v_add_f32 v215, v112, v113
 v_cvt_pk_bf16_f32 v32, v112, v113
 v_exp_f32 v116, v4
 v_mfma_f32_32x32x16_bf16 v[16:31], a[20:23], a[116:119], v[16:31]
 ds_read_b64_tr_b16 a[60:61], v239 offset:4096
 ds_read_b64_tr_b16 a[62:63], v239 offset:6144
 s_add_u32 m0, s31, 32768
 s_mov_b32 s34, 4251648
 buffer_load_dwordx4 v213, s[20:23], s34 offen nt lds
 v_mfma_f32_32x32x16_bf16 v[16:31], a[24:27], a[120:123], v[16:31]
 v_exp_f32 v117, v5
 v_add_f32 v215, v215, v114
 v_add_f32 v215, v215, v115
 v_cvt_pk_bf16_f32 v33, v114, v115
 v_mfma_f32_32x32x16_bf16 v[16:31], a[28:31], a[124:127], v[16:31]
 v_exp_f32 v118, v6
 v_exp_f32 v119, v7
 v_add_f32 v215, v215, v116
 v_add_f32 v215, v215, v117
 v_cvt_pk_bf16_f32 v34, v116, v117
 s_waitcnt lgkmcnt(0)
 v_mfma_f32_32x32x16_bf16 v[48:63], a[32:35], v[40:43], v[48:63]
 buffer_load_dwordx4 v213, s[20:23], s34 offen offset:1024 nt lds
 ds_read_b128 a[0:3], v220 offset:8192
 ds_read_b128 a[4:7], v221 offset:8192
 v_exp_f32 v120, v8
 v_mfma_f32_32x32x16_bf16 v[64:79], a[36:39], v[40:43], v[64:79]
 s_add_u32 m0, s31, 40960
 s_mov_b32 s34, 4276224
 buffer_load_dwordx4 v211, s[16:19], s34 offen nt lds
 ds_read_b128 a[8:11], v222 offset:8192
 v_mfma_f32_32x32x16_bf16 v[80:95], a[40:43], v[40:43], v[80:95]
 ds_read_b128 a[12:15], v223 offset:8192
 v_exp_f32 v121, v9
 v_add_f32 v215, v215, v118
 v_add_f32 v215, v215, v119
 v_cvt_pk_bf16_f32 v35, v118, v119
 v_mfma_f32_32x32x16_bf16 v[96:111], a[44:47], v[40:43], v[96:111]
 ds_read_b128 a[16:19], v224 offset:8192
 ds_read_b128 a[20:23], v225 offset:8192
 v_exp_f32 v122, v10
 v_exp_f32 v123, v11
 v_mfma_f32_32x32x16_bf16 v[48:63], a[48:51], v[44:47], v[48:63]
 buffer_load_dwordx4 v212, s[16:19], s34 offen offset:1024 nt lds
 ds_read_b128 a[24:27], v226 offset:8192
 v_add_f32 v215, v215, v120
 v_add_f32 v215, v215, v121
 v_mfma_f32_32x32x16_bf16 v[64:79], a[52:55], v[44:47], v[64:79]
 ds_read_b128 a[28:31], v227 offset:8192
 v_cvt_pk_bf16_f32 v36, v120, v121
 v_exp_f32 v124, v12
 v_exp_f32 v125, v13
 v_mfma_f32_32x32x16_bf16 v[80:95], a[56:59], v[44:47], v[80:95]
 v_add_f32 v215, v215, v122
 v_add_f32 v215, v215, v123
 v_cvt_pk_bf16_f32 v37, v122, v123
 v_exp_f32 v126, v14
 v_exp_f32 v127, v15
 v_mfma_f32_32x32x16_bf16 v[96:111], a[60:63], v[44:47], v[96:111]
 v_add_f32 v215, v215, v124
 v_add_f32 v215, v215, v125
 v_cvt_pk_bf16_f32 v38, v124, v125
 v_add_f32 v215, v215, v126
 v_add_f32 v215, v215, v127
 v_cvt_pk_bf16_f32 v39, v126, v127
 v_cmp_lt_f32 vcc, 0x45800000, v215
 s_cbranch_vccnz L_stub20
L_back20:
 v_add_f32 v219, v219, v215
 s_waitcnt vmcnt(4) lgkmcnt(0)
 s_barrier
 v_mfma_f32_32x32x16_bf16 v[0:15], a[0:3], a[96:99], v[128:143]
 ds_read_b64_tr_b16 a[32:33], v236 offset:24576
 ds_read_b64_tr_b16 a[34:35], v236 offset:26624
 ds_read_b64_tr_b16 a[36:37], v237 offset:24576
 v_exp_f32 v112, v16
 v_exp_f32 v113, v17
 v_mfma_f32_32x32x16_bf16 v[0:15], a[4:7], a[100:103], v[0:15]
 ds_read_b64_tr_b16 a[38:39], v237 offset:26624
 ds_read_b64_tr_b16 a[40:41], v238 offset:24576
 ds_read_b64_tr_b16 a[42:43], v238 offset:26624
 s_add_u32 m0, s31, 0
 s_mov_b32 s34, 4259840
 buffer_load_dwordx4 v213, s[20:23], s34 offen nt lds
 v_mfma_f32_32x32x16_bf16 v[0:15], a[8:11], a[104:107], v[0:15]
 ds_read_b64_tr_b16 a[44:45], v239 offset:24576
 ds_read_b64_tr_b16 a[46:47], v239 offset:26624
 v_exp_f32 v114, v18
 v_exp_f32 v115, v19
 v_mfma_f32_32x32x16_bf16 v[0:15], a[12:15], a[108:111], v[0:15]
 ds_read_b64_tr_b16 a[48:49], v236 offset:28672
 ds_read_b64_tr_b16 a[50:51], v236 offset:30720
 ds_read_b64_tr_b16 a[52:53], v237 offset:28672
 buffer_load_dwordx4 v213, s[20:23], s34 offen offset:1024 nt lds
 v_mfma_f32_32x32x16_bf16 v[0:15], a[16:19], a[112:115], v[0:15]
 ds_read_b64_tr_b16 a[54:55], v237 offset:30720
 ds_read_b64_tr_b16 a[56:57], v238 offset:28672
 ds_read_b64_tr_b16 a[58:59], v238 offset:30720
 v_add_f32 v215, v112, v113
 v_cvt_pk_bf16_f32 v40, v112, v113
 v_exp_f32 v116, v20
 v_mfma_f32_32x32x16_bf16 v[0:15], a[20:23], a[116:119], v[0:15]
 ds_read_b64_tr_b16 a[60:61], v239 offset:28672
 ds_read_b64_tr_b16 a[62:63], v239 offset:30720
 s_add_u32 m0, s31, 8192
 s_mov_b32 s34, 4284416
 buffer_load_dwordx4 v211, s[16:19], s34 offen nt lds
 v_mfma_f32_32x32x16_bf16 v[0:15], a[24:27], a[120:123], v[0:15]
 v_exp_f32 v117, v21
 v_add_f32 v215, v215, v114
 v_add_f32 v215, v215, v115
 v_cvt_pk_bf16_f32 v41, v114, v115
 v_mfma_f32_32x32x16_bf16 v[0:15], a[28:31], a[124:127], v[0:15]
 v_exp_f32 v118, v22
 v_exp_f32 v119, v23
 v_add_f32 v215, v215, v116
 v_add_f32 v215, v215, v117
 v_cvt_pk_bf16_f32 v42, v116, v117
 s_waitcnt lgkmcnt(0)
 v_mfma_f32_32x32x16_bf16 v[48:63], a[32:35], v[32:35], v[48:63]
 buffer_load_dwordx4 v212, s[16:19], s34 offen offset:1024 nt lds
 ds_read_b128 a[0:3], v220 offset:16384
 ds_read_b128 a[4:7], v221 offset:16384
 v_exp_f32 v120, v24
 v_mfma_f32_32x32x16_bf16 v[64:79], a[36:39], v[32:35], v[64:79]
 s_add_u32 m0, s31, 49152
 s_mov_b32 s34, 4268032
 buffer_load_dwordx4 v213, s[20:23], s34 offen nt lds
 ds_read_b128 a[8:11], v222 offset:16384
 v_mfma_f32_32x32x16_bf16 v[80:95], a[40:43], v[32:35], v[80:95]
 ds_read_b128 a[12:15], v223 offset:16384
 v_exp_f32 v121, v25
 v_add_f32 v215, v215, v118
 v_add_f32 v215, v215, v119
 v_cvt_pk_bf16_f32 v43, v118, v119
 v_mfma_f32_32x32x16_bf16 v[96:111], a[44:47], v[32:35], v[96:111]
 ds_read_b128 a[16:19], v224 offset:16384
 ds_read_b128 a[20:23], v225 offset:16384
 v_exp_f32 v122, v26
 v_exp_f32 v123, v27
 v_mfma_f32_32x32x16_bf16 v[48:63], a[48:51], v[36:39], v[48:63]
 buffer_load_dwordx4 v213, s[20:23], s34 offen offset:1024 nt lds
 ds_read_b128 a[24:27], v226 offset:16384
 v_add_f32 v215, v215, v120
 v_add_f32 v215, v215, v121
 v_mfma_f32_32x32x16_bf16 v[64:79], a[52:55], v[36:39], v[64:79]
 ds_read_b128 a[28:31], v227 offset:16384
 v_cvt_pk_bf16_f32 v44, v120, v121
 v_exp_f32 v124, v28
 v_exp_f32 v125, v29
 v_mfma_f32_32x32x16_bf16 v[80:95], a[56:59], v[36:39], v[80:95]
 v_add_f32 v215, v215, v122
 v_add_f32 v215, v215, v123
 v_cvt_pk_bf16_f32 v45, v122, v123
 v_exp_f32 v126, v30
 v_exp_f32 v127, v31
 v_mfma_f32_32x32x16_bf16 v[96:111], a[60:63], v[36:39], v[96:111]
 v_add_f32 v215, v215, v124
 v_add_f32 v215, v215, v125
 v_cvt_pk_bf16_f32 v46, v124, v125
 v_add_f32 v215, v215, v126
 v_add_f32 v215, v215, v127
 v_cvt_pk_bf16_f32 v47, v126, v127
 v_cmp_lt_f32 vcc, 0x45800000, v215
 s_cbranch_vccnz L_stub21
L_back21:
 v_add_f32 v219, v219, v215
 s_waitcnt vmcnt(6) lgkmcnt(0)
 s_barrier
 v_mfma_f32_32x32x16_bf16 v[16:31], a[0:3], a[96:99], v[128:143]
 ds_read_b64_tr_b16 a[32:33], v236 offset:32768
 ds_read_b64_tr_b16 a[34:35], v236 offset:34816
 ds_read_b64_tr_b16 a[36:37], v237 offset:32768
 v_exp_f32 v112, v0
 v_mfma_f32_32x32x16_bf16 v[16:31], a[4:7], a[100:103], v[16:31]
 ds_read_b64_tr_b16 a[38:39], v237 offset:34816
 ds_read_b64_tr_b16 a[40:41], v238 offset:32768
 ds_read_b64_tr_b16 a[42:43], v238 offset:34816
 s_add_u32 m0, s31, 16384
 s_mov_b32 s34, 4292608
 buffer_load_dwordx4 v211, s[16:19], s34 offen nt lds
 v_mfma_f32_32x32x16_bf16 v[16:31], a[8:11], a[104:107], v[16:31]
 ds_read_b64_tr_b16 a[44:45], v239 offset:32768
 ds_read_b64_tr_b16 a[46:47], v239 offset:34816
 v_exp_f32 v113, v1
 v_exp_f32 v114, v2
 v_mfma_f32_32x32x16_bf16 v[16:31], a[12:15], a[108:111], v[16:31]
 ds_read_b64_tr_b16 a[48:49], v236 offset:36864
 ds_read_b64_tr_b16 a[50:51], v236 offset:38912
 ds_read_b64_tr_b16 a[52:53], v237 offset:36864
 v_exp_f32 v115, v3
 v_add_f32 v215, v112, v113
 v_mfma_f32_32x32x16_bf16 v[16:31], a[16:19], a[112:115], v[16:31]
 ds_read_b64_tr_b16 a[54:55], v237 offset:38912
 ds_read_b64_tr_b16 a[56:57], v238 offset:36864
 ds_read_b64_tr_b16 a[58:59], v238 offset:38912
 v_cvt_pk_bf16_f32 v32, v112, v113
 v_exp_f32 v116, v4
 v_mfma_f32_32x32x16_bf16 v[16:31], a[20:23], a[116:119], v[16:31]
 ds_read_b64_tr_b16 a[60:61], v239 offset:36864
 ds_read_b64_tr_b16 a[62:63], v239 offset:38912
 buffer_load_dwordx4 v212, s[16:19], s34 offen offset:1024 nt lds
 v_exp_f32 v117, v5
 v_mfma_f32_32x32x16_bf16 v[16:31], a[24:27], a[120:123], v[16:31]
 v_add_f32 v215, v215, v114
 v_add_f32 v215, v215, v115
 v_cvt_pk_bf16_f32 v33, v114, v115
 v_exp_f32 v118, v6
 v_mfma_f32_32x32x16_bf16 v[16:31], a[28:31], a[124:127], v[16:31]
 s_add_u32 m0, s31, 24576
 s_mov_b32 s34, 4276224
 buffer_load_dwordx4 v213, s[20:23], s34 offen nt lds
 s_waitcnt lgkmcnt(0)
 v_mfma_f32_32x32x16_bf16 v[48:63], a[32:35], v[40:43], v[48:63]
 ds_read_b128 a[0:3], v220 offset:40960
 ds_read_b128 a[4:7], v221 offset:40960
 v_exp_f32 v119, v7
 v_add_f32 v215, v215, v116
 v_add_f32 v215, v215, v117
 v_mfma_f32_32x32x16_bf16 v[64:79], a[36:39], v[40:43], v[64:79]
 ds_read_b128 a[8:11], v222 offset:40960
 v_cvt_pk_bf16_f32 v34, v116, v117
 v_exp_f32 v120, v8
 v_exp_f32 v121, v9
 v_mfma_f32_32x32x16_bf16 v[80:95], a[40:43], v[40:43], v[80:95]
 ds_read_b128 a[12:15], v223 offset:40960
 v_add_f32 v215, v215, v118
 v_add_f32 v215, v215, v119
 v_cvt_pk_bf16_f32 v35, v118, v119
 v_exp_f32 v122, v10
 v_mfma_f32_32x32x16_bf16 v[96:111], a[44:47], v[40:43], v[96:111]
 buffer_load_dwordx4 v213, s[20:23], s34 offen offset:1024 nt lds
 ds_read_b128 a[16:19], v224 offset:40960
 ds_read_b128 a[20:23], v225 offset:40960
 v_mfma_f32_32x32x16_bf16 v[48:63], a[48:51], v[44:47], v[48:63]
 ds_read_b128 a[24:27], v226 offset:40960
 v_exp_f32 v123, v11
 v_add_f32 v215, v215, v120
 v_add_f32 v215, v215, v121
 v_cvt_pk_bf16_f32 v36, v120, v121
 v_mfma_f32_32x32x16_bf16 v[64:79], a[52:55], v[44:47], v[64:79]
 ds_read_b128 a[28:31], v227 offset:40960
 v_exp_f32 v124, v12
 v_exp_f32 v125, v13
 v_add_f32 v215, v215, v122
 v_mfma_f32_32x32x16_bf16 v[80:95], a[56:59], v[44:47], v[80:95]
 v_add_f32 v215, v215, v123
 v_cvt_pk_bf16_f32 v37, v122, v123
 v_exp_f32 v126, v14
 v_exp_f32 v127, v15
 v_mfma_f32_32x32x16_bf16 v[96:111], a[60:63], v[44:47], v[96:111]
 v_add_f32 v215, v215, v124
 v_add_f32 v215, v215, v125
 v_cvt_pk_bf16_f32 v38, v124, v125
 v_add_f32 v215, v215, v126
 v_add_f32 v215, v215, v127
 v_cvt_pk_bf16_f32 v39, v126, v127
 v_cmp_lt_f32 vcc, 0x45800000, v215
 s_cbranch_vccnz L_stub22
L_back22:
 v_add_f32 v219, v219, v215
 s_waitcnt vmcnt(6) lgkmcnt(0)
 s_barrier
 v_mfma_f32_32x32x16_bf16 v[0:15], a[0:3], a[96:99], v[128:143]
 ds_read_b64_tr_b16 a[32:33], v236 offset:0
 ds_read_b64_tr_b16 a[34:35], v236 offset:2048
 ds_read_b64_tr_b16 a[36:37], v237 offset:0
 v_exp_f32 v112, v16
 v_exp_f32 v113, v17
 v_mfma_f32_32x32x16_bf16 v[0:15], a[4:7], a[100:103], v[0:15]
 ds_read_b64_tr_b16 a[38:39], v237 offset:2048
 ds_read_b64_tr_b16 a[40:41], v238 offset:0
 ds_read_b64_tr_b16 a[42:43], v238 offset:2048
 s_add_u32 m0, s31, 32768
 s_mov_b32 s34, 4300800
 buffer_load_dwordx4 v211, s[16:19], s34 offen nt lds
 v_mfma_f32_32x32x16_bf16 v[0:15], a[8:11], a[104:107], v[0:15]
 ds_read_b64_tr_b16 a[44:45], v239 offset:0
 ds_read_b64_tr_b16 a[46:47], v239 offset:2048
 v_exp_f32 v114, v18
 v_exp_f32 v115, v19
 v_mfma_f32_32x32x16_bf16 v[0:15], a[12:15], a[108:111], v[0:15]
 ds_read_b64_tr_b16 a[48:49], v236 offset:4096
 ds_read_b64_tr_b16 a[50:51], v236 offset:6144
 ds_read_b64_tr_b16 a[52:53], v237 offset:4096
 buffer_load_dwordx4 v212, s[16:19], s34 offen offset:1024 nt lds
 v_mfma_f32_32x32x16_bf16 v[0:15], a[16:19], a[112:115], v[0:15]
 ds_read_b64_tr_b16 a[54:55], v237 offset:6144
 ds_read_b64_tr_b16 a[56:57], v238 offset:4096
 ds_read_b64_tr_b16 a[58:59], v238 offset:6144
 s_add_u32 m0, s31, 40960
 s_mov_b32 s34, 4284416
 buffer_load_dwordx4 v213, s[20:23], s34 offen nt lds
 v_mfma_f32_32x32x16_bf16 v[0:15], a[20:23], a[116:119], v[0:15]
 ds_read_b64_tr_b16 a[60:61], v239 offset:4096
 ds_read_b64_tr_b16 a[62:63], v239 offset:6144
 v_add_f32 v215, v112, v113
 v_cvt_pk_bf16_f32 v40, v112, v113
 v_exp_f32 v116, v20
 v_mfma_f32_32x32x16_bf16 v[0:15], a[24:27], a[120:123], v[0:15]
 v_exp_f32 v117, v21
 v_add_f32 v215, v215, v114
 v_add_f32 v215, v215, v115
 v_cvt_pk_bf16_f32 v41, v114, v115
 v_exp_f32 v118, v22
 v_mfma_f32_32x32x16_bf16 v[0:15], a[28:31], a[124:127], v[0:15]
 buffer_load_dwordx4 v213, s[20:23], s34 offen offset:1024 nt lds
 v_exp_f32 v119, v23
 v_add_f32 v215, v215, v116
 s_waitcnt lgkmcnt(0)
 v_mfma_f32_32x32x16_bf16 v[48:63], a[32:35], v[32:35], v[48:63]
 s_add_u32 m0, s31, 57344
 s_mov_b32 s34, 4308992
 buffer_load_dwordx4 v211, s[16:19], s34 offen nt lds
 ds_read_b128 a[0:3], v220 offset:8192
 ds_read_b128 a[4:7], v221 offset:8192
 v_mfma_f32_32x32x16_bf16 v[64:79], a[36:39], v[32:35], v[64:79]
 ds_read_b128 a[8:11], v222 offset:8192
 v_add_f32 v215, v215, v117
 v_cvt_pk_bf16_f32 v42, v116, v117
 v_exp_f32 v120, v24
 v_exp_f32 v121, v25
 v_mfma_f32_32x32x16_bf16 v[80:95], a[40:43], v[32:35], v[80:95]
 ds_read_b128 a[12:15], v223 offset:8192
 v_add_f32 v215, v215, v118
 v_add_f32 v215, v215, v119
 v_cvt_pk_bf16_f32 v43, v118, v119
 v_exp_f32 v122, v26
 v_mfma_f32_32x32x16_bf16 v[96:111], a[44:47], v[32:35], v[96:111]
 buffer_load_dwordx4 v212, s[16:19], s34 offen offset:1024 nt lds
 ds_read_b128 a[16:19], v224 offset:8192
 ds_read_b128 a[20:23], v225 offset:8192
 v_exp_f32 v123, v27
 v_mfma_f32_32x32x16_bf16 v[48:63], a[48:51], v[36:39], v[48:63]
 buffer_load_dword v216, v197, s[92:95], 0 offen offset:0 sc1
 ds_read_b128 a[24:27], v226 offset:8192
 v_add_f32 v215, v215, v120
 v_add_f32 v215, v215, v121
 v_mfma_f32_32x32x16_bf16 v[64:79], a[52:55], v[36:39], v[64:79]
 ds_read_b128 a[28:31], v227 offset:8192
 v_cvt_pk_bf16_f32 v44, v120, v121
 v_exp_f32 v124, v28
 v_exp_f32 v125, v29
 v_mfma_f32_32x32x16_bf16 v[80:95], a[56:59], v[36:39], v[80:95]
 v_add_f32 v215, v215, v122
 v_add_f32 v215, v215, v123
 v_cvt_pk_bf16_f32 v45, v122, v123
 v_exp_f32 v126, v30
 v_exp_f32 v127, v31
 v_mfma_f32_32x32x16_bf16 v[96:111], a[60:63], v[36:39], v[96:111]
 v_add_f32 v215, v215, v124
 v_add_f32 v215, v215, v125
 v_cvt_pk_bf16_f32 v46, v124, v125
 v_add_f32 v215, v215, v126
 v_add_f32 v215, v215, v127
 v_cvt_pk_bf16_f32 v47, v126, v127
 v_cmp_lt_f32 vcc, 0x45800000, v215
 s_cbranch_vccnz L_stub23
L_back23:
 v_add_f32 v219, v219, v215
 s_waitcnt vmcnt(9) lgkmcnt(0)
 s_barrier
 v_mfma_f32_32x32x16_bf16 v[16:31], a[0:3], a[96:99], v[128:143]
 ds_read_b64_tr_b16 a[32:33], v236 offset:49152
 ds_read_b64_tr_b16 a[34:35], v236 offset:51200
 ds_read_b64_tr_b16 a[36:37], v237 offset:49152
 v_exp_f32 v112, v0
 v_mfma_f32_32x32x16_bf16 v[16:31], a[4:7], a[100:103], v[16:31]
 ds_read_b64_tr_b16 a[38:39], v237 offset:51200
 ds_read_b64_tr_b16 a[40:41], v238 offset:49152
 ds_read_b64_tr_b16 a[42:43], v238 offset:51200
 s_add_u32 m0, s31, 0
 s_mov_b32 s34, 4292608
 buffer_load_dwordx4 v213, s[20:23], s34 offen nt lds
 v_mfma_f32_32x32x16_bf16 v[16:31], a[8:11], a[104:107], v[16:31]
 ds_read_b64_tr_b16 a[44:45], v239 offset:49152
 ds_read_b64_tr_b16 a[46:47], v239 offset:51200
 v_exp_f32 v113, v1
 v_exp_f32 v114, v2
 v_mfma_f32_32x32x16_bf16 v[16:31], a[12:15], a[108:111], v[16:31]
 ds_read_b64_tr_b16 a[48:49], v236 offset:53248
 ds_read_b64_tr_b16 a[50:51], v236 offset:55296
 ds_read_b64_tr_b16 a[52:53], v237 offset:53248
 v_exp_f32 v115, v3
 v_add_f32 v215, v112, v113
 v_mfma_f32_32x32x16_bf16 v[16:31], a[16:19], a[112:115], v[16:31]
 ds_read_b64_tr_b16 a[54:55], v237 offset:55296
 ds_read_b64_tr_b16 a[56:57], v238 offset:53248
 ds_read_b64_tr_b16 a[58:59], v238 offset:55296
 v_cvt_pk_bf16_f32 v32, v112, v113
 v_exp_f32 v116, v4
 v_mfma_f32_32x32x16_bf16 v[16:31], a[20:23], a[116:119], v[16:31]
 ds_read_b64_tr_b16 a[60:61], v239 offset:53248
 ds_read_b64_tr_b16 a[62:63], v239 offset:55296
 buffer_load_dwordx4 v213, s[20:23], s34 offen offset:1024 nt lds
 v_exp_f32 v117, v5
 v_mfma_f32_32x32x16_bf16 v[16:31], a[24:27], a[120:123], v[16:31]
 v_add_f32 v215, v215, v114
 v_add_f32 v215, v215, v115
 v_cvt_pk_bf16_f32 v33, v114, v115
 v_exp_f32 v118, v6
 v_mfma_f32_32x32x16_bf16 v[16:31], a[28:31], a[124:127], v[16:31]
 s_add_u32 m0, s31, 8192
 s_mov_b32 s34, 4317184
 buffer_load_dwordx4 v211, s[16:19], s34 offen nt lds
 s_waitcnt lgkmcnt(0)
 v_mfma_f32_32x32x16_bf16 v[48:63], a[32:35], v[40:43], v[48:63]
 ds_read_b128 a[0:3], v220 offset:16384
 ds_read_b128 a[4:7], v221 offset:16384
 v_exp_f32 v119, v7
 v_add_f32 v215, v215, v116
 v_add_f32 v215, v215, v117
 v_mfma_f32_32x32x16_bf16 v[64:79], a[36:39], v[40:43], v[64:79]
 ds_read_b128 a[8:11], v222 offset:16384
 v_cvt_pk_bf16_f32 v34, v116, v117
 v_exp_f32 v120, v8
 v_exp_f32 v121, v9
 v_mfma_f32_32x32x16_bf16 v[80:95], a[40:43], v[40:43], v[80:95]
 ds_read_b128 a[12:15], v223 offset:16384
 v_add_f32 v215, v215, v118
 v_add_f32 v215, v215, v119
 v_cvt_pk_bf16_f32 v35, v118, v119
 v_exp_f32 v122, v10
 v_mfma_f32_32x32x16_bf16 v[96:111], a[44:47], v[40:43], v[96:111]
 buffer_load_dwordx4 v212, s[16:19], s34 offen offset:1024 nt lds
 ds_read_b128 a[16:19], v224 offset:16384
 ds_read_b128 a[20:23], v225 offset:16384
 v_mfma_f32_32x32x16_bf16 v[48:63], a[48:51], v[44:47], v[48:63]
 ds_read_b128 a[24:27], v226 offset:16384
 v_exp_f32 v123, v11
 v_add_f32 v215, v215, v120
 v_add_f32 v215, v215, v121
 v_cvt_pk_bf16_f32 v36, v120, v121
 v_mfma_f32_32x32x16_bf16 v[64:79], a[52:55], v[44:47], v[64:79]
 ds_read_b128 a[28:31], v227 offset:16384
 v_exp_f32 v124, v12
 v_exp_f32 v125, v13
 v_add_f32 v215, v215, v122
 v_mfma_f32_32x32x16_bf16 v[80:95], a[56:59], v[44:47], v[80:95]
 v_add_f32 v215, v215, v123
 v_cvt_pk_bf16_f32 v37, v122, v123
 v_exp_f32 v126, v14
 v_exp_f32 v127, v15
 v_mfma_f32_32x32x16_bf16 v[96:111], a[60:63], v[44:47], v[96:111]
 v_add_f32 v215, v215, v124
 v_add_f32 v215, v215, v125
 v_cvt_pk_bf16_f32 v38, v124, v125
 v_add_f32 v215, v215, v126
 v_add_f32 v215, v215, v127
 v_cvt_pk_bf16_f32 v39, v126, v127
 v_cmp_lt_f32 vcc, 0x45800000, v215
 s_cbranch_vccnz L_stub24
L_back24:
 v_add_f32 v219, v219, v215
 s_waitcnt vmcnt(9) lgkmcnt(0)
 s_barrier
 v_mfma_f32_32x32x16_bf16 v[0:15], a[0:3], a[96:99], v[128:143]
 ds_read_b64_tr_b16 a[32:33], v236 offset:24576
 ds_read_b64_tr_b16 a[34:35], v236 offset:26624
 ds_read_b64_tr_b16 a[36:37], v237 offset:24576
 v_exp_f32 v112, v16
 v_mfma_f32_32x32x16_bf16 v[0:15], a[4:7], a[100:103], v[0:15]
 ds_read_b64_tr_b16 a[38:39], v237 offset:26624
 ds_read_b64_tr_b16 a[40:41], v238 offset:24576
 ds_read_b64_tr_b16 a[42:43], v238 offset:26624
 s_add_u32 m0, s31, 16384
 s_mov_b32 s34, 4300800
 buffer_load_dwordx4 v213, s[20:23], s34 offen nt lds
 v_mfma_f32_32x32x16_bf16 v[0:15], a[8:11], a[104:107], v[0:15]
 ds_read_b64_tr_b16 a[44:45], v239 offset:24576
 ds_read_b64_tr_b16 a[46:47], v239 offset:26624
 v_exp_f32 v113, v17
 v_exp_f32 v114, v18
 v_mfma_f32_32x32x16_bf16 v[0:15], a[12:15], a[108:111], v[0:15]
 ds_read_b64_tr_b16 a[48:49], v236 offset:28672
 ds_read_b64_tr_b16 a[50:51], v236 offset:30720
 ds_read_b64_tr_b16 a[52:53], v237 offset:28672
 v_exp_f32 v115, v19
 v_add_f32 v215, v112, v113
 v_mfma_f32_32x32x16_bf16 v[0:15], a[16:19], a[112:115], v[0:15]
 ds_read_b64_tr_b16 a[54:55], v237 offset:30720
 ds_read_b64_tr_b16 a[56:57], v238 offset:28672
 ds_read_b64_tr_b16 a[58:59], v238 offset:30720
 v_cvt_pk_bf16_f32 v40, v112, v113
 v_exp_f32 v116, v20
 v_mfma_f32_32x32x16_bf16 v[0:15], a[20:23], a[116:119], v[0:15]
 ds_read_b64_tr_b16 a[60:61], v239 offset:28672
 ds_read_b64_tr_b16 a[62:63], v239 offset:30720
 buffer_load_dwordx4 v213, s[20:23], s34 offen offset:1024 nt lds
 v_exp_f32 v117, v21
 v_mfma_f32_32x32x16_bf16 v[0:15], a[24:27], a[120:123], v[0:15]
 v_add_f32 v215, v215, v114
 v_add_f32 v215, v215, v115
 v_cvt_pk_bf16_f32 v41, v114, v115
 v_exp_f32 v118, v22
 v_mfma_f32_32x32x16_bf16 v[0:15], a[28:31], a[124:127], v[0:15]
 s_add_u32 m0, s31, 49152
 s_mov_b32 s34, 4308992
 buffer_load_dwordx4 v213, s[20:23], s34 offen nt lds
 s_waitcnt lgkmcnt(0)
 v_mfma_f32_32x32x16_bf16 v[48:63], a[32:35], v[32:35], v[48:63]
 ds_read_b128 a[0:3], v220 offset:32768
 ds_read_b128 a[4:7], v221 offset:32768
 v_exp_f32 v119, v23
 v_add_f32 v215, v215, v116
 v_add_f32 v215, v215, v117
 v_mfma_f32_32x32x16_bf16 v[64:79], a[36:39], v[32:35], v[64:79]
 ds_read_b128 a[8:11], v222 offset:32768
 v_cvt_pk_bf16_f32 v42, v116, v117
 v_exp_f32 v120, v24
 v_exp_f32 v121, v25
 v_mfma_f32_32x32x16_bf16 v[80:95], a[40:43], v[32:35], v[80:95]
 ds_read_b128 a[12:15], v223 offset:32768
 v_add_f32 v215, v215, v118
 v_add_f32 v215, v215, v119
 v_cvt_pk_bf16_f32 v43, v118, v119
 v_exp_f32 v122, v26
 v_mfma_f32_32x32x16_bf16 v[96:111], a[44:47], v[32:35], v[96:111]
 buffer_load_dwordx4 v213, s[20:23], s34 offen offset:1024 nt lds
 ds_read_b128 a[16:19], v224 offset:32768
 ds_read_b128 a[20:23], v225 offset:32768
 v_mfma_f32_32x32x16_bf16 v[48:63], a[48:51], v[36:39], v[48:63]
 ds_read_b128 a[24:27], v226 offset:32768
 v_exp_f32 v123, v27
 v_add_f32 v215, v215, v120
 v_add_f32 v215, v215, v121
 v_cvt_pk_bf16_f32 v44, v120, v121
 v_mfma_f32_32x32x16_bf16 v[64:79], a[52:55], v[36:39], v[64:79]
 ds_read_b128 a[28:31], v227 offset:32768
 v_exp_f32 v124, v28
 v_exp_f32 v125, v29
 v_add_f32 v215, v215, v122
 v_mfma_f32_32x32x16_bf16 v[80:95], a[56:59], v[36:39], v[80:95]
 v_add_f32 v215, v215, v123
 v_cvt_pk_bf16_f32 v45, v122, v123
 v_exp_f32 v126, v30
 v_exp_f32 v127, v31
 v_mfma_f32_32x32x16_bf16 v[96:111], a[60:63], v[36:39], v[96:111]
 v_add_f32 v215, v215, v124
 v_add_f32 v215, v215, v125
 v_cvt_pk_bf16_f32 v46, v124, v125
 v_add_f32 v215, v215, v126
 v_add_f32 v215, v215, v127
 v_cvt_pk_bf16_f32 v47, v126, v127
 v_cmp_lt_f32 vcc, 0x45800000, v215
 s_cbranch_vccnz L_stub25
L_back25:
 v_add_f32 v219, v219, v215
 s_waitcnt vmcnt(9) lgkmcnt(0)
 s_barrier
 v_mfma_f32_32x32x16_bf16 v[16:31], a[0:3], a[96:99], v[128:143]
 ds_read_b64_tr_b16 a[32:33], v236 offset:40960
 ds_read_b64_tr_b16 a[34:35], v236 offset:43008
 ds_read_b64_tr_b16 a[36:37], v237 offset:40960
 v_exp_f32 v112, v0
 v_exp_f32 v113, v1
 v_mfma_f32_32x32x16_bf16 v[16:31], a[4:7], a[100:103], v[16:31]
 ds_read_b64_tr_b16 a[38:39], v237 offset:43008
 ds_read_b64_tr_b16 a[40:41], v238 offset:40960
 ds_read_b64_tr_b16 a[42:43], v238 offset:43008
 s_add_u32 m0, s31, 24576
 s_mov_b32 s34, 4317184
 buffer_load_dwordx4 v213, s[20:23], s34 offen nt lds
 v_mfma_f32_32x32x16_bf16 v[16:31], a[8:11], a[104:107], v[16:31]
 ds_read_b64_tr_b16 a[44:45], v239 offset:40960
 ds_read_b64_tr_b16 a[46:47], v239 offset:43008
 v_exp_f32 v114, v2
 v_exp_f32 v115, v3
 v_mfma_f32_32x32x16_bf16 v[16:31], a[12:15], a[108:111], v[16:31]
 ds_read_b64_tr_b16 a[48:49], v236 offset:45056
 ds_read_b64_tr_b16 a[50:51], v236 offset:47104
 ds_read_b64_tr_b16 a[52:53], v237 offset:45056
 buffer_load_dwordx4 v213, s[20:23], s34 offen offset:1024 nt lds
 v_add_f32 v215, v112, v113
 v_mfma_f32_32x32x16_bf16 v[16:31], a[16:19], a[112:115], v[16:31]
 ds_read_b64_tr_b16 a[54:55], v237 offset:47104
 ds_read_b64_tr_b16 a[56:57], v238 offset:45056
 ds_read_b64_tr_b16 a[58:59], v238 offset:47104
 s_waitcnt vmcnt(10)
 v_cmp_eq_u32 vcc, 1, v216
 s_and_b32 s42, vcc_lo, 255
 s_cmp_eq_u32 s42, 255
 s_cbranch_scc0 L_spin1
L_spun1:
 v_mfma_f32_32x32x16_bf16 v[16:31], a[20:23], a[116:119], v[16:31]
 ds_read_b64_tr_b16 a[60:61], v239 offset:45056
 ds_read_b64_tr_b16 a[62:63], v239 offset:47104
 v_cvt_pk_bf16_f32 v32, v112, v113
 v_exp_f32 v116, v4
 v_exp_f32 v117, v5
 v_mfma_f32_32x32x16_bf16 v[16:31], a[24:27], a[120:123], v[16:31]
 s_add_u32 m0, s33, 139264
 s_bfe_u32 s29, s4, 262144
 s_lshl_b32 s29, s29, 17
 buffer_load_dwordx4 v199, s[12:15], s29 offen lds
 v_mfma_f32_32x32x16_bf16 v[16:31], a[28:31], a[124:127], v[16:31]
 v_add_f32 v215, v215, v114
 v_add_f32 v215, v215, v115
 v_cvt_pk_bf16_f32 v33, v114, v115
 v_exp_f32 v118, v6
 v_exp_f32 v119, v7
 s_waitcnt lgkmcnt(0)
 v_mfma_f32_32x32x16_bf16 v[48:63], a[32:35], v[40:43], v[48:63]
 ds_read_b128 a[0:3], v220 offset:57344
 ds_read_b128 a[4:7], v221 offset:57344
 v_add_f32 v215, v215, v116
 v_add_f32 v215, v215, v117
 v_cvt_pk_bf16_f32 v34, v116, v117
 v_mfma_f32_32x32x16_bf16 v[64:79], a[36:39], v[40:43], v[64:79]
 buffer_load_dwordx4 v200, s[12:15], s29 offen offset:1024 lds
 ds_read_b128 a[8:11], v222 offset:57344
 v_exp_f32 v120, v8
 v_exp_f32 v121, v9
 v_mfma_f32_32x32x16_bf16 v[80:95], a[40:43], v[40:43], v[80:95]
 ds_read_b128 a[12:15], v223 offset:57344
 v_add_f32 v215, v215, v118
 v_add_f32 v215, v215, v119
 v_cvt_pk_bf16_f32 v35, v118, v119
 v_exp_f32 v122, v10
 v_mfma_f32_32x32x16_bf16 v[96:111], a[44:47], v[40:43], v[96:111]
 buffer_load_dwordx4 v201, s[12:15], s29 offen offset:2048 lds
 ds_read_b128 a[16:19], v224 offset:57344
 ds_read_b128 a[20:23], v225 offset:57344
 v_exp_f32 v123, v11
 v_mfma_f32_32x32x16_bf16 v[48:63], a[48:51], v[44:47], v[48:63]
 buffer_load_dwordx4 v202, s[12:15], s29 offen offset:3072 lds
 ds_read_b128 a[24:27], v226 offset:57344
 v_add_f32 v215, v215, v120
 v_add_f32 v215, v215, v121
 v_mfma_f32_32x32x16_bf16 v[64:79], a[52:55], v[44:47], v[64:79]
 ds_read_b128 a[28:31], v227 offset:57344
 v_cvt_pk_bf16_f32 v36, v120, v121
 v_exp_f32 v124, v12
 v_exp_f32 v125, v13
 v_mfma_f32_32x32x16_bf16 v[80:95], a[56:59], v[44:47], v[80:95]
 v_add_f32 v215, v215, v122
 v_add_f32 v215, v215, v123
 v_cvt_pk_bf16_f32 v37, v122, v123
 v_exp_f32 v126, v14
 v_exp_f32 v127, v15
 v_mfma_f32_32x32x16_bf16 v[96:111], a[60:63], v[44:47], v[96:111]
 v_add_f32 v215, v215, v124
 v_add_f32 v215, v215, v125
 v_cvt_pk_bf16_f32 v38, v124, v125
 v_add_f32 v215, v215, v126
 v_add_f32 v215, v215, v127
 v_cvt_pk_bf16_f32 v39, v126, v127
 v_cmp_lt_f32 vcc, 0x45800000, v215
 s_cbranch_vccnz L_stub26
L_back26:
 v_add_f32 v219, v219, v215
 s_waitcnt vmcnt(10) lgkmcnt(0)
 s_barrier
 v_mfma_f32_32x32x16_bf16 v[0:15], a[0:3], a[96:99], v[128:143]
 ds_read_b64_tr_b16 a[32:33], v236 offset:0
 ds_read_b64_tr_b16 a[34:35], v236 offset:2048
 ds_read_b64_tr_b16 a[36:37], v237 offset:0
 v_exp_f32 v112, v16
 v_mfma_f32_32x32x16_bf16 v[0:15], a[4:7], a[100:103], v[0:15]
 ds_read_b64_tr_b16 a[38:39], v237 offset:2048
 ds_read_b64_tr_b16 a[40:41], v238 offset:0
 ds_read_b64_tr_b16 a[42:43], v238 offset:2048
 v_exp_f32 v113, v17
 v_mfma_f32_32x32x16_bf16 v[0:15], a[8:11], a[104:107], v[0:15]
 ds_read_b64_tr_b16 a[44:45], v239 offset:0
 ds_read_b64_tr_b16 a[46:47], v239 offset:2048
 v_exp_f32 v114, v18
 v_mfma_f32_32x32x16_bf16 v[0:15], a[12:15], a[108:111], v[0:15]
 ds_read_b64_tr_b16 a[48:49], v236 offset:4096
 ds_read_b64_tr_b16 a[50:51], v236 offset:6144
 ds_read_b64_tr_b16 a[52:53], v237 offset:4096
 v_exp_f32 v115, v19
 v_add_f32 v215, v112, v113
 v_mfma_f32_32x32x16_bf16 v[0:15], a[16:19], a[112:115], v[0:15]
 ds_read_b64_tr_b16 a[54:55], v237 offset:6144
 ds_read_b64_tr_b16 a[56:57], v238 offset:4096
 ds_read_b64_tr_b16 a[58:59], v238 offset:6144
 v_cvt_pk_bf16_f32 v40, v112, v113
 v_mfma_f32_32x32x16_bf16 v[0:15], a[20:23], a[116:119], v[0:15]
 ds_read_b64_tr_b16 a[60:61], v239 offset:4096
 ds_read_b64_tr_b16 a[62:63], v239 offset:6144
 v_exp_f32 v116, v20
 v_exp_f32 v117, v21
 v_mfma_f32_32x32x16_bf16 v[0:15], a[24:27], a[120:123], v[0:15]
 v_add_f32 v215, v215, v114
 v_add_f32 v215, v215, v115
 v_cvt_pk_bf16_f32 v41, v114, v115
 v_exp_f32 v118, v22
 v_mfma_f32_32x32x16_bf16 v[0:15], a[28:31], a[124:127], v[0:15]
 v_exp_f32 v119, v23
 v_add_f32 v215, v215, v116
 v_add_f32 v215, v215, v117
 v_cvt_pk_bf16_f32 v42, v116, v117
 s_waitcnt lgkmcnt(0)
 v_mfma_f32_32x32x16_bf16 v[48:63], a[32:35], v[32:35], v[48:63]
 ds_read_b128 a[0:3], v220 offset:8192
 ds_read_b128 a[4:7], v221 offset:8192
 v_exp_f32 v120, v24
 v_mfma_f32_32x32x16_bf16 v[64:79], a[36:39], v[32:35], v[64:79]
 ds_read_b128 a[8:11], v222 offset:8192
 v_exp_f32 v121, v25
 v_add_f32 v215, v215, v118
 v_add_f32 v215, v215, v119
 v_mfma_f32_32x32x16_bf16 v[80:95], a[40:43], v[32:35], v[80:95]
 ds_read_b128 a[12:15], v223 offset:8192
 v_cvt_pk_bf16_f32 v43, v118, v119
 v_exp_f32 v122, v26
 v_exp_f32 v123, v27
 v_mfma_f32_32x32x16_bf16 v[96:111], a[44:47], v[32:35], v[96:111]
 ds_read_b128 a[16:19], v224 offset:8192
 ds_read_b128 a[20:23], v225 offset:8192
 v_add_f32 v215, v215, v120
 v_add_f32 v215, v215, v121
 v_mfma_f32_32x32x16_bf16 v[48:63], a[48:51], v[36:39], v[48:63]
 ds_read_b128 a[24:27], v226 offset:8192
 v_cvt_pk_bf16_f32 v44, v120, v121
 v_exp_f32 v124, v28
 v_exp_f32 v125, v29
 v_mfma_f32_32x32x16_bf16 v[64:79], a[52:55], v[36:39], v[64:79]
 ds_read_b128 a[28:31], v227 offset:8192
 v_add_f32 v215, v215, v122
 v_add_f32 v215, v215, v123
 v_cvt_pk_bf16_f32 v45, v122, v123
 v_mfma_f32_32x32x16_bf16 v[80:95], a[56:59], v[36:39], v[80:95]
 v_exp_f32 v126, v30
 v_exp_f32 v127, v31
 v_add_f32 v215, v215, v124
 v_mfma_f32_32x32x16_bf16 v[96:111], a[60:63], v[36:39], v[96:111]
 v_add_f32 v215, v215, v125
 v_cvt_pk_bf16_f32 v46, v124, v125
 v_add_f32 v215, v215, v126
 v_add_f32 v215, v215, v127
 v_cvt_pk_bf16_f32 v47, v126, v127
 v_cmp_lt_f32 vcc, 0x45800000, v215
 s_cbranch_vccnz L_stub27
L_back27:
 v_add_f32 v219, v219, v215
 s_waitcnt vmcnt(8) lgkmcnt(0)
 s_barrier
 v_mfma_f32_32x32x16_bf16 v[16:31], a[0:3], a[96:99], v[128:143]
 ds_read_b64_tr_b16 a[32:33], v236 offset:16384
 ds_read_b64_tr_b16 a[34:35], v236 offset:18432
 ds_read_b64_tr_b16 a[36:37], v237 offset:16384
 v_exp_f32 v112, v0
 v_mfma_f32_32x32x16_bf16 v[16:31], a[4:7], a[100:103], v[16:31]
 ds_read_b64_tr_b16 a[38:39], v237 offset:18432
 ds_read_b64_tr_b16 a[40:41], v238 offset:16384
 ds_read_b64_tr_b16 a[42:43], v238 offset:18432
 s_add_u32 m0, s33, 122880
 s_bfe_u32 s28, s4, 262144
 s_mul_i32 s28, s28, 28672
 buffer_load_dwordx4 v192, s[8:11], s28 offen sc1 lds
 v_mfma_f32_32x32x16_bf16 v[16:31], a[8:11], a[104:107], v[16:31]
 ds_read_b64_tr_b16 a[44:45], v239 offset:16384
 ds_read_b64_tr_b16 a[46:47], v239 offset:18432
 v_exp_f32 v113, v1
 v_exp_f32 v114, v2
 v_mfma_f32_32x32x16_bf16 v[16:31], a[12:15], a[108:111], v[16:31]
 ds_read_b64_tr_b16 a[48:49], v236 offset:20480
 ds_read_b64_tr_b16 a[50:51], v236 offset:22528
 ds_read_b64_tr_b16 a[52:53], v237 offset:20480
 v_exp_f32 v115, v3
 v_mfma_f32_32x32x16_bf16 v[16:31], a[16:19], a[112:115], v[16:31]
 ds_read_b64_tr_b16 a[54:55], v237 offset:22528
 ds_read_b64_tr_b16 a[56:57], v238 offset:20480
 ds_read_b64_tr_b16 a[58:59], v238 offset:22528
 v_add_f32 v215, v112, v113
 v_cvt_pk_bf16_f32 v32, v112, v113
 v_mfma_f32_32x32x16_bf16 v[16:31], a[20:23], a[116:119], v[16:31]
 ds_read_b64_tr_b16 a[60:61], v239 offset:20480
 ds_read_b64_tr_b16 a[62:63], v239 offset:22528
 v_exp_f32 v116, v4
 v_mfma_f32_32x32x16_bf16 v[16:31], a[24:27], a[120:123], v[16:31]
 buffer_load_dwordx4 v192, s[8:11], s28 offen offset:1024 sc1 lds
 v_exp_f32 v117, v5
 v_add_f32 v215, v215, v114
 v_mfma_f32_32x32x16_bf16 v[16:31], a[28:31], a[124:127], v[16:31]
 v_add_f32 v215, v215, v115
 v_cvt_pk_bf16_f32 v33, v114, v115
 v_exp_f32 v118, v6
 s_waitcnt lgkmcnt(0)
 v_mfma_f32_32x32x16_bf16 v[48:63], a[32:35], v[40:43], v[48:63]
 buffer_load_dwordx4 v193, s[8:11], s28 offen offset:2048 sc1 lds
 v_exp_f32 v119, v7
 v_add_f32 v215, v215, v116
 v_mfma_f32_32x32x16_bf16 v[64:79], a[36:39], v[40:43], v[64:79]
 v_add_f32 v215, v215, v117
 v_cvt_pk_bf16_f32 v34, v116, v117
 v_exp_f32 v120, v8
 v_exp_f32 v121, v9
 v_mfma_f32_32x32x16_bf16 v[80:95], a[40:43], v[40:43], v[80:95]
 v_add_f32 v215, v215, v118
 v_add_f32 v215, v215, v119
 v_cvt_pk_bf16_f32 v35, v118, v119
 v_exp_f32 v122, v10
 v_mfma_f32_32x32x16_bf16 v[96:111], a[44:47], v[40:43], v[96:111]
 buffer_load_dwordx4 v193, s[8:11], s28 offen offset:3072 sc1 lds
 v_exp_f32 v123, v11
 v_mfma_f32_32x32x16_bf16 v[48:63], a[48:51], v[44:47], v[48:63]
 v_add_f32 v215, v215, v120
 v_add_f32 v215, v215, v121
 v_cvt_pk_bf16_f32 v36, v120, v121
 v_exp_f32 v124, v12
 v_mfma_f32_32x32x16_bf16 v[64:79], a[52:55], v[44:47], v[64:79]
 v_exp_f32 v125, v13
 v_add_f32 v215, v215, v122
 v_add_f32 v215, v215, v123
 v_cvt_pk_bf16_f32 v37, v122, v123
 v_mfma_f32_32x32x16_bf16 v[80:95], a[56:59], v[44:47], v[80:95]
 v_exp_f32 v126, v14
 v_exp_f32 v127, v15
 v_add_f32 v215, v215, v124
 v_mfma_f32_32x32x16_bf16 v[96:111], a[60:63], v[44:47], v[96:111]
 v_add_f32 v215, v215, v125
 v_cvt_pk_bf16_f32 v38, v124, v125
 v_add_f32 v215, v215, v126
 v_add_f32 v215, v215, v127
 v_cvt_pk_bf16_f32 v39, v126, v127
 v_cmp_lt_f32 vcc, 0x45800000, v215
 s_cbranch_vccnz L_stub28
L_back28:
 v_add_f32 v219, v219, v215
 s_waitcnt vmcnt(10)
 s_barrier
 ds_read_b64_tr_b16 a[32:33], v236 offset:49152
 ds_read_b64_tr_b16 a[34:35], v236 offset:51200
 ds_read_b64_tr_b16 a[36:37], v237 offset:49152
 ds_read_b64_tr_b16 a[38:39], v237 offset:51200
 ds_read_b64_tr_b16 a[40:41], v238 offset:49152
 ds_read_b64_tr_b16 a[42:43], v238 offset:51200
 ds_read_b64_tr_b16 a[44:45], v239 offset:49152
 ds_read_b64_tr_b16 a[46:47], v239 offset:51200
 v_exp_f32 v112, v16
 v_exp_f32 v113, v17
 v_exp_f32 v114, v18
 v_exp_f32 v115, v19
 v_add_f32 v215, v112, v113
 v_cvt_pk_bf16_f32 v40, v112, v113
 v_exp_f32 v116, v20
 v_exp_f32 v117, v21
 ds_read_b64_tr_b16 a[48:49], v236 offset:53248
 ds_read_b64_tr_b16 a[50:51], v236 offset:55296
 ds_read_b64_tr_b16 a[52:53], v237 offset:53248
 ds_read_b64_tr_b16 a[54:55], v237 offset:55296
 ds_read_b64_tr_b16 a[56:57], v238 offset:53248
 ds_read_b64_tr_b16 a[58:59], v238 offset:55296
 ds_read_b64_tr_b16 a[60:61], v239 offset:53248
 ds_read_b64_tr_b16 a[62:63], v239 offset:55296
 v_add_f32 v215, v215, v114
 v_add_f32 v215, v215, v115
 v_cvt_pk_bf16_f32 v41, v114, v115
 v_exp_f32 v118, v22
 v_exp_f32 v119, v23
 v_add_f32 v215, v215, v116
 v_add_f32 v215, v215, v117
 v_cvt_pk_bf16_f32 v42, v116, v117
 s_waitcnt lgkmcnt(14)
 v_mfma_f32_32x32x16_bf16 v[48:63], a[32:35], v[32:35], v[48:63]
 s_add_u32 m0, s33, 106496
 s_bfe_u32 s29, s4, 262148
 s_lshl_b32 s29, s29, 17
 buffer_load_dwordx4 v199, s[12:15], s29 offen lds
 v_exp_f32 v120, v24
 v_exp_f32 v121, v25
 v_add_f32 v215, v215, v118
 s_waitcnt lgkmcnt(12)
 v_mfma_f32_32x32x16_bf16 v[64:79], a[36:39], v[32:35], v[64:79]
 v_add_f32 v215, v215, v119
 v_cvt_pk_bf16_f32 v43, v118, v119
 v_exp_f32 v122, v26
 s_waitcnt lgkmcnt(10)
 v_mfma_f32_32x32x16_bf16 v[80:95], a[40:43], v[32:35], v[80:95]
 v_exp_f32 v123, v27
 v_add_f32 v215, v215, v120
 v_add_f32 v215, v215, v121
 v_cvt_pk_bf16_f32 v44, v120, v121
 s_waitcnt lgkmcnt(8)
 v_mfma_f32_32x32x16_bf16 v[96:111], a[44:47], v[32:35], v[96:111]
 buffer_load_dwordx4 v200, s[12:15], s29 offen offset:1024 lds
 v_exp_f32 v124, v28
 v_exp_f32 v125, v29
 s_waitcnt lgkmcnt(6)
 v_mfma_f32_32x32x16_bf16 v[48:63], a[48:51], v[36:39], v[48:63]
 buffer_load_dwordx4 v201, s[12:15], s29 offen offset:2048 lds
 v_add_f32 v215, v215, v122
 v_add_f32 v215, v215, v123
 v_cvt_pk_bf16_f32 v45, v122, v123
 v_exp_f32 v126, v30
 s_waitcnt lgkmcnt(4)
 v_mfma_f32_32x32x16_bf16 v[64:79], a[52:55], v[36:39], v[64:79]
 v_exp_f32 v127, v31
 v_add_f32 v215, v215, v124
 v_add_f32 v215, v215, v125
 s_waitcnt lgkmcnt(2)
 v_mfma_f32_32x32x16_bf16 v[80:95], a[56:59], v[36:39], v[80:95]
 buffer_load_dwordx4 v202, s[12:15], s29 offen offset:3072 lds
 v_cvt_pk_bf16_f32 v46, v124, v125
 v_add_f32 v215, v215, v126
 v_add_f32 v215, v215, v127
 v_cvt_pk_bf16_f32 v47, v126, v127
 s_waitcnt lgkmcnt(0)
 v_mfma_f32_32x32x16_bf16 v[96:111], a[60:63], v[36:39], v[96:111]
 v_cmp_lt_f32 vcc, 0x45800000, v215
 s_cbranch_vccnz L_stub29
L_back29:
 v_add_f32 v219, v219, v215
 s_waitcnt vmcnt(12)
 s_barrier
 ds_read_b64_tr_b16 a[32:33], v236 offset:24576
 ds_read_b64_tr_b16 a[34:35], v236 offset:26624
 ds_read_b64_tr_b16 a[36:37], v237 offset:24576
 ds_read_b64_tr_b16 a[38:39], v237 offset:26624
 ds_read_b64_tr_b16 a[40:41], v238 offset:24576
 ds_read_b64_tr_b16 a[42:43], v238 offset:26624
 ds_read_b64_tr_b16 a[44:45], v239 offset:24576
 ds_read_b64_tr_b16 a[46:47], v239 offset:26624
 ds_read_b64_tr_b16 a[48:49], v236 offset:28672
 ds_read_b64_tr_b16 a[50:51], v236 offset:30720
 ds_read_b64_tr_b16 a[52:53], v237 offset:28672
 ds_read_b64_tr_b16 a[54:55], v237 offset:30720
 ds_read_b64_tr_b16 a[56:57], v238 offset:28672
 ds_read_b64_tr_b16 a[58:59], v238 offset:30720
 ds_read_b64_tr_b16 a[60:61], v239 offset:28672
 ds_read_b64_tr_b16 a[62:63], v239 offset:30720
 s_add_u32 m0, s33, 90112
 s_bfe_u32 s28, s4, 262148
 s_mul_i32 s28, s28, 28672
 buffer_load_dwordx4 v192, s[8:11], s28 offen sc1 lds
 buffer_load_dwordx4 v192, s[8:11], s28 offen offset:1024 sc1 lds
 buffer_load_dwordx4 v193, s[8:11], s28 offen offset:2048 sc1 lds
 buffer_load_dwordx4 v193, s[8:11], s28 offen offset:3072 sc1 lds
 s_waitcnt lgkmcnt(14)
 v_mfma_f32_32x32x16_bf16 v[48:63], a[32:35], v[40:43], v[48:63]
 s_waitcnt lgkmcnt(12)
 v_mfma_f32_32x32x16_bf16 v[64:79], a[36:39], v[40:43], v[64:79]
 s_waitcnt lgkmcnt(10)
 v_mfma_f32_32x32x16_bf16 v[80:95], a[40:43], v[40:43], v[80:95]
 s_waitcnt lgkmcnt(8)
 v_mfma_f32_32x32x16_bf16 v[96:111], a[44:47], v[40:43], v[96:111]
 s_waitcnt lgkmcnt(6)
 v_mfma_f32_32x32x16_bf16 v[48:63], a[48:51], v[44:47], v[48:63]
 s_waitcnt lgkmcnt(4)
 v_mfma_f32_32x32x16_bf16 v[64:79], a[52:55], v[44:47], v[64:79]
 s_waitcnt lgkmcnt(2)
 v_mfma_f32_32x32x16_bf16 v[80:95], a[56:59], v[44:47], v[80:95]
 s_waitcnt lgkmcnt(0)
 v_mfma_f32_32x32x16_bf16 v[96:111], a[60:63], v[44:47], v[96:111]
 s_waitcnt vmcnt(8)
 s_barrier
 s_add_u32 m0, s33, 73728
 s_bfe_u32 s28, s4, 262152
 s_mul_i32 s28, s28, 28672
 buffer_load_dwordx4 v192, s[8:11], s28 offen sc1 lds
 buffer_load_dwordx4 v192, s[8:11], s28 offen offset:1024 sc1 lds
 buffer_load_dwordx4 v193, s[8:11], s28 offen offset:2048 sc1 lds
 buffer_load_dwordx4 v193, s[8:11], s28 offen offset:3072 sc1 lds
 s_add_u32 m0, s33, 49152
 s_bfe_u32 s29, s4, 262152
 s_lshl_b32 s29, s29, 17
 buffer_load_dwordx4 v199, s[12:15], s29 offen lds
 buffer_load_dwordx4 v200, s[12:15], s29 offen offset:1024 lds
 buffer_load_dwordx4 v201, s[12:15], s29 offen offset:2048 lds
 buffer_load_dwordx4 v202, s[12:15], s29 offen offset:3072 lds
 s_add_u32 m0, s33, 32768
 s_bfe_u32 s28, s4, 262156
 s_mul_i32 s28, s28, 28672
 buffer_load_dwordx4 v192, s[8:11], s28 offen sc1 lds
 buffer_load_dwordx4 v192, s[8:11], s28 offen offset:1024 sc1 lds
 buffer_load_dwordx4 v193, s[8:11], s28 offen offset:2048 sc1 lds
 buffer_load_dwordx4 v193, s[8:11], s28 offen offset:3072 sc1 lds
 s_add_u32 m0, s33, 0
 s_bfe_u32 s29, s4, 262156
 s_lshl_b32 s29, s29, 17
 buffer_load_dwordx4 v199, s[12:15], s29 offen lds
 buffer_load_dwordx4 v200, s[12:15], s29 offen offset:1024 lds
 buffer_load_dwordx4 v201, s[12:15], s29 offen offset:2048 lds
 buffer_load_dwordx4 v202, s[12:15], s29 offen offset:3072 lds
 ds_read_b64_tr_b16 a[128:129], v207 offset:0
 ds_read_b64_tr_b16 a[130:131], v207 offset:2048
 ds_read_b64_tr_b16 a[132:133], v208 offset:0
 ds_read_b64_tr_b16 a[134:135], v208 offset:2048
 ds_read_b64_tr_b16 a[136:137], v207 offset:8192
 ds_read_b64_tr_b16 a[138:139], v207 offset:10240
 ds_read_b64_tr_b16 a[140:141], v208 offset:8192
 ds_read_b64_tr_b16 a[142:143], v208 offset:10240
 ds_read_b128 v[112:115], v209 offset:49152
 ds_read_b128 v[116:119], v209 offset:50176
 ds_read_b128 v[120:123], v209 offset:51200
 ds_read_b128 v[124:127], v209 offset:52224
 ds_read_b128 v[128:131], v209 offset:53248
 ds_read_b128 v[132:135], v209 offset:54272
 ds_read_b128 v[136:139], v209 offset:55296
 ds_read_b128 v[140:143], v209 offset:56320
 ds_read_b128 v[144:147], v209 offset:57344
 ds_read_b128 v[148:151], v209 offset:58368
 ds_read_b128 v[152:155], v209 offset:59392
 ds_read_b128 v[156:159], v209 offset:60416
 ds_read_b128 v[160:163], v209 offset:61440
 ds_read_b128 v[164:167], v209 offset:62464
 v_mov_b32 v185, v219
 s_nop 1
 v_permlane32_swap_b32 v185, v219
 v_add_f32 v185, v185, v219
 v_rcp_f32 v185, v185
 s_nop 0
 v_mov_b32 v244, v185
 v_mov_b32 v245, v185
 v_pk_mul_f32 v[48:49], v[48:49], v[244:245]
 v_pk_mul_f32 v[50:51], v[50:51], v[244:245]
 v_pk_mul_f32 v[52:53], v[52:53], v[244:245]
 v_pk_mul_f32 v[54:55], v[54:55], v[244:245]
 v_cvt_pk_bf16_f32 v0, v48, v49
 v_cvt_pk_bf16_f32 v1, v50, v51
 v_cvt_pk_bf16_f32 v2, v52, v53
 v_cvt_pk_bf16_f32 v3, v54, v55
 buffer_store_dwordx4 v[0:3], v214, s[24:27], s58 offen offset:0 sc1
 v_pk_mul_f32 v[56:57], v[56:57], v[244:245]
 v_pk_mul_f32 v[58:59], v[58:59], v[244:245]
 v_pk_mul_f32 v[60:61], v[60:61], v[244:245]
 v_pk_mul_f32 v[62:63], v[62:63], v[244:245]
 v_cvt_pk_bf16_f32 v4, v56, v57
 v_cvt_pk_bf16_f32 v5, v58, v59
 v_cvt_pk_bf16_f32 v6, v60, v61
 v_cvt_pk_bf16_f32 v7, v62, v63
 buffer_store_dwordx4 v[4:7], v214, s[24:27], s58 offen offset:512 sc1
 v_pk_mul_f32 v[64:65], v[64:65], v[244:245]
 v_pk_mul_f32 v[66:67], v[66:67], v[244:245]
 v_pk_mul_f32 v[68:69], v[68:69], v[244:245]
 v_pk_mul_f32 v[70:71], v[70:71], v[244:245]
 v_cvt_pk_bf16_f32 v8, v64, v65
 v_cvt_pk_bf16_f32 v9, v66, v67
 v_cvt_pk_bf16_f32 v10, v68, v69
 v_cvt_pk_bf16_f32 v11, v70, v71
 buffer_store_dwordx4 v[8:11], v214, s[24:27], s58 offen offset:1024 sc1
 v_pk_mul_f32 v[72:73], v[72:73], v[244:245]
 v_pk_mul_f32 v[74:75], v[74:75], v[244:245]
 v_pk_mul_f32 v[76:77], v[76:77], v[244:245]
 v_pk_mul_f32 v[78:79], v[78:79], v[244:245]
 v_cvt_pk_bf16_f32 v12, v72, v73
 v_cvt_pk_bf16_f32 v13, v74, v75
 v_cvt_pk_bf16_f32 v14, v76, v77
 v_cvt_pk_bf16_f32 v15, v78, v79
 buffer_store_dwordx4 v[12:15], v214, s[24:27], s58 offen offset:1536 sc1
 v_pk_mul_f32 v[80:81], v[80:81], v[244:245]
 v_pk_mul_f32 v[82:83], v[82:83], v[244:245]
 v_pk_mul_f32 v[84:85], v[84:85], v[244:245]
 v_pk_mul_f32 v[86:87], v[86:87], v[244:245]
 v_cvt_pk_bf16_f32 v0, v80, v81
 v_cvt_pk_bf16_f32 v1, v82, v83
 v_cvt_pk_bf16_f32 v2, v84, v85
 v_cvt_pk_bf16_f32 v3, v86, v87
 buffer_store_dwordx4 v[0:3], v214, s[24:27], s59 offen offset:0 sc1
 v_pk_mul_f32 v[88:89], v[88:89], v[244:245]
 v_pk_mul_f32 v[90:91], v[90:91], v[244:245]
 v_pk_mul_f32 v[92:93], v[92:93], v[244:245]
 v_pk_mul_f32 v[94:95], v[94:95], v[244:245]
 v_cvt_pk_bf16_f32 v4, v88, v89
 v_cvt_pk_bf16_f32 v5, v90, v91
 v_cvt_pk_bf16_f32 v6, v92, v93
 v_cvt_pk_bf16_f32 v7, v94, v95
 buffer_store_dwordx4 v[4:7], v214, s[24:27], s59 offen offset:512 sc1
 v_pk_mul_f32 v[96:97], v[96:97], v[244:245]
 v_pk_mul_f32 v[98:99], v[98:99], v[244:245]
 v_pk_mul_f32 v[100:101], v[100:101], v[244:245]
 v_pk_mul_f32 v[102:103], v[102:103], v[244:245]
 v_cvt_pk_bf16_f32 v8, v96, v97
 v_cvt_pk_bf16_f32 v9, v98, v99
 v_cvt_pk_bf16_f32 v10, v100, v101
 v_cvt_pk_bf16_f32 v11, v102, v103
 buffer_store_dwordx4 v[8:11], v214, s[24:27], s59 offen offset:1024 sc1
 v_pk_mul_f32 v[104:105], v[104:105], v[244:245]
 v_pk_mul_f32 v[106:107], v[106:107], v[244:245]
 v_pk_mul_f32 v[108:109], v[108:109], v[244:245]
 v_pk_mul_f32 v[110:111], v[110:111], v[244:245]
 v_cvt_pk_bf16_f32 v12, v104, v105
 v_cvt_pk_bf16_f32 v13, v106, v107
 v_cvt_pk_bf16_f32 v14, v108, v109
 v_cvt_pk_bf16_f32 v15, v110, v111
 buffer_store_dwordx4 v[12:15], v214, s[24:27], s59 offen offset:1536 sc1
 s_add_u32 s20, s8, 14336
 s_addc_u32 s21, s9, 0
 s_mov_b32 s22, 444416
 s_waitcnt vmcnt(24) lgkmcnt(0)
 s_barrier
 v_mfma_f32_16x16x32_bf16 v[0:3], a[128:131], v[112:115], 0
 ds_read_b128 v[168:171], v209 offset:16384
 ds_read_b128 v[172:175], v209 offset:17408
 v_mfma_f32_16x16x32_bf16 v[0:3], a[136:139], v[116:119], v[0:3]
 ds_read_b128 v[176:179], v209 offset:18432
 s_add_u32 m0, s33, 16384
 v_mfma_f32_16x16x32_bf16 v[28:31], a[132:135], v[112:115], 0
 ds_read_b128 v[180:183], v209 offset:19456
 v_mfma_f32_16x16x32_bf16 v[28:31], a[140:143], v[116:119], v[28:31]
 ds_read_b128 v[112:115], v209 offset:20480
 s_bfe_u32 s28, s4, 262160
 v_mfma_f32_16x16x32_bf16 v[4:7], a[128:131], v[120:123], 0
 ds_read_b128 v[116:119], v209 offset:21504
 ds_read_b64_tr_b16 a[144:145], v205 offset:32768
 v_mfma_f32_16x16x32_bf16 v[4:7], a[136:139], v[124:127], v[4:7]
 s_mul_i32 s28, s28, 28672
 v_mfma_f32_16x16x32_bf16 v[32:35], a[132:135], v[120:123], 0
 buffer_load_dwordx4 v192, s[8:11], s28 offen sc1 lds
 v_mfma_f32_16x16x32_bf16 v[32:35], a[140:143], v[124:127], v[32:35]
 ds_read_b128 v[120:123], v209 offset:22528
 ds_read_b64_tr_b16 a[146:147], v205 offset:34816
 v_mfma_f32_16x16x32_bf16 v[8:11], a[128:131], v[128:131], 0
 ds_read_b128 v[124:127], v209 offset:23552
 v_mfma_f32_16x16x32_bf16 v[8:11], a[136:139], v[132:135], v[8:11]
 buffer_load_dwordx4 v192, s[8:11], s28 offen offset:1024 sc1 lds
 v_mfma_f32_16x16x32_bf16 v[36:39], a[132:135], v[128:131], 0
 ds_read_b64_tr_b16 a[148:149], v206 offset:32768
 v_mfma_f32_16x16x32_bf16 v[36:39], a[140:143], v[132:135], v[36:39]
 ds_read_b128 v[128:131], v209 offset:24576
 buffer_load_dwordx4 v193, s[8:11], s28 offen offset:2048 sc1 lds
 v_mfma_f32_16x16x32_bf16 v[12:15], a[128:131], v[136:139], 0
 ds_read_b128 v[132:135], v209 offset:25600
 ds_read_b64_tr_b16 a[150:151], v206 offset:34816
 v_mfma_f32_16x16x32_bf16 v[12:15], a[136:139], v[140:143], v[12:15]
 ds_read_b64_tr_b16 a[152:153], v205 offset:40960
 v_mfma_f32_16x16x32_bf16 v[40:43], a[132:135], v[136:139], 0
 buffer_load_dwordx4 v193, s[8:11], s28 offen offset:3072 sc1 lds
 v_mfma_f32_16x16x32_bf16 v[40:43], a[140:143], v[140:143], v[40:43]
 ds_read_b128 v[136:139], v209 offset:26624
 v_mfma_f32_16x16x32_bf16 v[16:19], a[128:131], v[144:147], 0
 ds_read_b128 v[140:143], v209 offset:27648
 s_add_u32 m0, s33, 122880
 v_mfma_f32_16x16x32_bf16 v[16:19], a[136:139], v[148:151], v[16:19]
 s_bfe_u32 s29, s4, 262160
 ds_read_b64_tr_b16 a[154:155], v205 offset:43008
 v_mfma_f32_16x16x32_bf16 v[44:47], a[132:135], v[144:147], 0
 s_lshl_b32 s29, s29, 17
 v_mfma_f32_16x16x32_bf16 v[44:47], a[140:143], v[148:151], v[44:47]
 ds_read_b128 v[144:147], v209 offset:28672
 buffer_load_dwordx4 v199, s[12:15], s29 offen lds
 v_mfma_f32_16x16x32_bf16 v[20:23], a[128:131], v[152:155], 0
 ds_read_b128 v[148:151], v209 offset:29696
 ds_read_b64_tr_b16 a[156:157], v206 offset:40960
 v_mfma_f32_16x16x32_bf16 v[20:23], a[136:139], v[156:159], v[20:23]
 ds_read_b64_tr_b16 a[158:159], v206 offset:43008
 v_mfma_f32_16x16x32_bf16 v[48:51], a[132:135], v[152:155], 0
 buffer_load_dwordx4 v200, s[12:15], s29 offen offset:1024 lds
 v_mfma_f32_16x16x32_bf16 v[48:51], a[140:143], v[156:159], v[48:51]
 v_mfma_f32_16x16x32_bf16 v[24:27], a[128:131], v[160:163], 0
 buffer_load_dwordx4 v201, s[12:15], s29 offen offset:2048 lds
 v_mfma_f32_16x16x32_bf16 v[24:27], a[136:139], v[164:167], v[24:27]
 v_mfma_f32_16x16x32_bf16 v[52:55], a[132:135], v[160:163], 0
 buffer_load_dwordx4 v202, s[12:15], s29 offen offset:3072 lds
 v_mfma_f32_16x16x32_bf16 v[52:55], a[140:143], v[164:167], v[52:55]
 s_waitcnt vmcnt(24) lgkmcnt(0)
 s_barrier
 v_mfma_f32_16x16x32_bf16 v[0:3], a[144:147], v[168:171], v[0:3]
 ds_read_b128 v[152:155], v209 offset:0
 ds_read_b128 v[156:159], v209 offset:1024
 v_mfma_f32_16x16x32_bf16 v[0:3], a[152:155], v[172:175], v[0:3]
 ds_read_b128 v[160:163], v209 offset:2048
 s_add_u32 m0, s33, 139264
 v_mfma_f32_16x16x32_bf16 v[28:31], a[148:151], v[168:171], v[28:31]
 ds_read_b128 v[164:167], v209 offset:3072
 v_mfma_f32_16x16x32_bf16 v[28:31], a[156:159], v[172:175], v[28:31]
 ds_read_b128 v[168:171], v209 offset:4096
 s_bfe_u32 s28, s4, 262164
 v_mfma_f32_16x16x32_bf16 v[4:7], a[144:147], v[176:179], v[4:7]
 ds_read_b128 v[172:175], v209 offset:5120
 ds_read_b64_tr_b16 a[160:161], v203 offset:49152
 v_mfma_f32_16x16x32_bf16 v[4:7], a[152:155], v[180:183], v[4:7]
 s_mul_i32 s28, s28, 28672
 v_mfma_f32_16x16x32_bf16 v[32:35], a[148:151], v[176:179], v[32:35]
 buffer_load_dwordx4 v192, s[8:11], s28 offen sc1 lds
 v_mfma_f32_16x16x32_bf16 v[32:35], a[156:159], v[180:183], v[32:35]
 ds_read_b128 v[176:179], v209 offset:6144
 ds_read_b64_tr_b16 a[162:163], v203 offset:51200
 v_mfma_f32_16x16x32_bf16 v[8:11], a[144:147], v[112:115], v[8:11]
 ds_read_b128 v[180:183], v209 offset:7168
 v_mfma_f32_16x16x32_bf16 v[8:11], a[152:155], v[116:119], v[8:11]
 buffer_load_dwordx4 v192, s[8:11], s28 offen offset:1024 sc1 lds
 v_mfma_f32_16x16x32_bf16 v[36:39], a[148:151], v[112:115], v[36:39]
 ds_read_b64_tr_b16 a[164:165], v204 offset:49152
 v_mfma_f32_16x16x32_bf16 v[36:39], a[156:159], v[116:119], v[36:39]
 ds_read_b128 v[112:115], v209 offset:8192
 buffer_load_dwordx4 v193, s[8:11], s28 offen offset:2048 sc1 lds
 v_mfma_f32_16x16x32_bf16 v[12:15], a[144:147], v[120:123], v[12:15]
 ds_read_b128 v[116:119], v209 offset:9216
 ds_read_b64_tr_b16 a[166:167], v204 offset:51200
 v_mfma_f32_16x16x32_bf16 v[12:15], a[152:155], v[124:127], v[12:15]
 ds_read_b64_tr_b16 a[168:169], v203 offset:57344
 v_mfma_f32_16x16x32_bf16 v[40:43], a[148:151], v[120:123], v[40:43]
 buffer_load_dwordx4 v193, s[8:11], s28 offen offset:3072 sc1 lds
 v_mfma_f32_16x16x32_bf16 v[40:43], a[156:159], v[124:127], v[40:43]
 ds_read_b128 v[120:123], v209 offset:10240
 v_mfma_f32_16x16x32_bf16 v[16:19], a[144:147], v[128:131], v[16:19]
 ds_read_b128 v[124:127], v209 offset:11264
 s_add_u32 m0, s33, 90112
 v_mfma_f32_16x16x32_bf16 v[16:19], a[152:155], v[132:135], v[16:19]
 s_bfe_u32 s29, s4, 262164
 ds_read_b64_tr_b16 a[170:171], v203 offset:59392
 v_mfma_f32_16x16x32_bf16 v[44:47], a[148:151], v[128:131], v[44:47]
 s_lshl_b32 s29, s29, 17
 v_mfma_f32_16x16x32_bf16 v[44:47], a[156:159], v[132:135], v[44:47]
 ds_read_b128 v[128:131], v209 offset:12288
 buffer_load_dwordx4 v199, s[12:15], s29 offen lds
 v_mfma_f32_16x16x32_bf16 v[20:23], a[144:147], v[136:139], v[20:23]
 ds_read_b128 v[132:135], v209 offset:13312
 ds_read_b64_tr_b16 a[172:173], v204 offset:57344
 v_mfma_f32_16x16x32_bf16 v[20:23], a[152:155], v[140:143], v[20:23]
 ds_read_b64_tr_b16 a[174:175], v204 offset:59392
 v_mfma_f32_16x16x32_bf16 v[48:51], a[148:151], v[136:139], v[48:51]
 buffer_load_dwordx4 v200, s[12:15], s29 offen offset:1024 lds
 v_mfma_f32_16x16x32_bf16 v[48:51], a[156:159], v[140:143], v[48:51]
 v_mfma_f32_16x16x32_bf16 v[24:27], a[144:147], v[144:147], v[24:27]
 buffer_load_dwordx4 v201, s[12:15], s29 offen offset:2048 lds
 v_mfma_f32_16x16x32_bf16 v[24:27], a[152:155], v[148:151], v[24:27]
 v_mfma_f32_16x16x32_bf16 v[52:55], a[148:151], v[144:147], v[52:55]
 buffer_load_dwordx4 v202, s[12:15], s29 offen offset:3072 lds
 v_mfma_f32_16x16x32_bf16 v[52:55], a[156:159], v[148:151], v[52:55]
 s_waitcnt vmcnt(24) lgkmcnt(0)
 s_barrier
 v_mfma_f32_16x16x32_bf16 v[0:3], a[160:163], v[152:155], v[0:3]
 ds_read_b128 v[136:139], v194 offset:32768
 ds_read_b128 v[140:143], v194 offset:33792
 v_mfma_f32_16x16x32_bf16 v[0:3], a[168:171], v[156:159], v[0:3]
 ds_read_b128 v[144:147], v194 offset:34816
 s_add_u32 m0, s33, 106496
 v_mfma_f32_16x16x32_bf16 v[28:31], a[164:167], v[152:155], v[28:31]
 ds_read_b128 v[148:151], v194 offset:35840
 v_mfma_f32_16x16x32_bf16 v[28:31], a[172:175], v[156:159], v[28:31]
 ds_read_b128 v[152:155], v194 offset:36864
 s_bfe_u32 s28, s4, 262168
 v_mfma_f32_16x16x32_bf16 v[4:7], a[160:163], v[160:163], v[4:7]
 ds_read_b128 v[156:159], v194 offset:37888
 ds_read_b64_tr_b16 a[176:177], v203 offset:0
 v_mfma_f32_16x16x32_bf16 v[4:7], a[168:171], v[164:167], v[4:7]
 s_mul_i32 s28, s28, 28672
 v_mfma_f32_16x16x32_bf16 v[32:35], a[164:167], v[160:163], v[32:35]
 buffer_load_dwordx4 v192, s[8:11], s28 offen sc1 lds
 v_mfma_f32_16x16x32_bf16 v[32:35], a[172:175], v[164:167], v[32:35]
 ds_read_b128 v[160:163], v194 offset:38912
 ds_read_b64_tr_b16 a[178:179], v203 offset:2048
 v_mfma_f32_16x16x32_bf16 v[8:11], a[160:163], v[168:171], v[8:11]
 ds_read_b128 v[164:167], v194 offset:39936
 v_mfma_f32_16x16x32_bf16 v[8:11], a[168:171], v[172:175], v[8:11]
 buffer_load_dwordx4 v192, s[8:11], s28 offen offset:1024 sc1 lds
 v_mfma_f32_16x16x32_bf16 v[36:39], a[164:167], v[168:171], v[36:39]
 ds_read_b64_tr_b16 a[180:181], v204 offset:0
 v_mfma_f32_16x16x32_bf16 v[36:39], a[172:175], v[172:175], v[36:39]
 ds_read_b128 v[168:171], v194 offset:40960
 buffer_load_dwordx4 v193, s[8:11], s28 offen offset:2048 sc1 lds
 v_mfma_f32_16x16x32_bf16 v[12:15], a[160:163], v[176:179], v[12:15]
 ds_read_b128 v[172:175], v194 offset:41984
 ds_read_b64_tr_b16 a[182:183], v204 offset:2048
 v_mfma_f32_16x16x32_bf16 v[12:15], a[168:171], v[180:183], v[12:15]
 ds_read_b64_tr_b16 a[184:185], v203 offset:8192
 v_mfma_f32_16x16x32_bf16 v[40:43], a[164:167], v[176:179], v[40:43]
 buffer_load_dwordx4 v193, s[8:11], s28 offen offset:3072 sc1 lds
 v_mfma_f32_16x16x32_bf16 v[40:43], a[172:175], v[180:183], v[40:43]
 ds_read_b128 v[176:179], v194 offset:43008
 v_mfma_f32_16x16x32_bf16 v[16:19], a[160:163], v[112:115], v[16:19]
 ds_read_b128 v[180:183], v194 offset:44032
 s_add_u32 m0, s33, 73728
 v_mfma_f32_16x16x32_bf16 v[16:19], a[168:171], v[116:119], v[16:19]
 s_bfe_u32 s29, s4, 262168
 ds_read_b64_tr_b16 a[186:187], v203 offset:10240
 v_mfma_f32_16x16x32_bf16 v[44:47], a[164:167], v[112:115], v[44:47]
 s_lshl_b32 s29, s29, 17
 v_mfma_f32_16x16x32_bf16 v[44:47], a[172:175], v[116:119], v[44:47]
 ds_read_b128 v[112:115], v194 offset:45056
 buffer_load_dwordx4 v199, s[12:15], s29 offen lds
 v_mfma_f32_16x16x32_bf16 v[20:23], a[160:163], v[120:123], v[20:23]
 ds_read_b128 v[116:119], v194 offset:46080
 ds_read_b64_tr_b16 a[188:189], v204 offset:8192
 v_mfma_f32_16x16x32_bf16 v[20:23], a[168:171], v[124:127], v[20:23]
 ds_read_b64_tr_b16 a[190:191], v204 offset:10240
 v_mfma_f32_16x16x32_bf16 v[48:51], a[164:167], v[120:123], v[48:51]
 buffer_load_dwordx4 v200, s[12:15], s29 offen offset:1024 lds
 v_mfma_f32_16x16x32_bf16 v[48:51], a[172:175], v[124:127], v[48:51]
 v_mfma_f32_16x16x32_bf16 v[24:27], a[160:163], v[128:131], v[24:27]
 buffer_load_dwordx4 v201, s[12:15], s29 offen offset:2048 lds
 v_mfma_f32_16x16x32_bf16 v[24:27], a[168:171], v[132:135], v[24:27]
 v_mfma_f32_16x16x32_bf16 v[52:55], a[164:167], v[128:131], v[52:55]
 buffer_load_dwordx4 v202, s[12:15], s29 offen offset:3072 lds
 v_mfma_f32_16x16x32_bf16 v[52:55], a[172:175], v[132:135], v[52:55]
 s_waitcnt vmcnt(16) lgkmcnt(0)
 s_barrier
 v_mfma_f32_16x16x32_bf16 v[0:3], a[176:179], v[136:139], v[0:3]
 ds_read_b128 v[120:123], v194 offset:16384
 ds_read_b128 v[124:127], v194 offset:17408
 v_mfma_f32_16x16x32_bf16 v[0:3], a[184:187], v[140:143], v[0:3]
 ds_read_b128 v[128:131], v194 offset:18432
 v_mfma_f32_16x16x32_bf16 v[28:31], a[180:183], v[136:139], v[28:31]
 ds_read_b128 v[132:135], v194 offset:19456
 ds_read_b64_tr_b16 a[192:193], v205 offset:49152
 v_mfma_f32_16x16x32_bf16 v[28:31], a[188:191], v[140:143], v[28:31]
 ds_read_b128 v[136:139], v194 offset:20480
 buffer_store_dword v198, v195, s[92:95], 0 offen offset:32 sc1
 v_mfma_f32_16x16x32_bf16 v[4:7], a[176:179], v[144:147], v[4:7]
 ds_read_b128 v[140:143], v194 offset:21504
 v_mfma_f32_16x16x32_bf16 v[4:7], a[184:187], v[148:151], v[4:7]
 s_add_u32 m0, s33, 49152
 s_bfe_u32 s28, s4, 262172
 v_mfma_f32_16x16x32_bf16 v[32:35], a[180:183], v[144:147], v[32:35]
 s_mul_i32 s28, s28, 28672
 ds_read_b64_tr_b16 a[194:195], v205 offset:51200
 v_mfma_f32_16x16x32_bf16 v[32:35], a[188:191], v[148:151], v[32:35]
 ds_read_b128 v[144:147], v194 offset:22528
 v_mfma_f32_16x16x32_bf16 v[8:11], a[176:179], v[152:155], v[8:11]
 ds_read_b128 v[148:151], v194 offset:23552
 buffer_load_dwordx4 v192, s[8:11], s28 offen sc1 lds
 v_mfma_f32_16x16x32_bf16 v[8:11], a[184:187], v[156:159], v[8:11]
 ds_read_b64_tr_b16 a[196:197], v206 offset:49152
 v_mfma_f32_16x16x32_bf16 v[36:39], a[180:183], v[152:155], v[36:39]
 buffer_load_dwordx4 v192, s[8:11], s28 offen offset:1024 sc1 lds
 v_mfma_f32_16x16x32_bf16 v[36:39], a[188:191], v[156:159], v[36:39]
 ds_read_b128 v[152:155], v194 offset:24576
 ds_read_b64_tr_b16 a[198:199], v206 offset:51200
 v_mfma_f32_16x16x32_bf16 v[12:15], a[176:179], v[160:163], v[12:15]
 ds_read_b128 v[156:159], v194 offset:25600
 v_mfma_f32_16x16x32_bf16 v[12:15], a[184:187], v[164:167], v[12:15]
 buffer_load_dwordx4 v193, s[8:11], s28 offen offset:2048 sc1 lds
 v_mfma_f32_16x16x32_bf16 v[40:43], a[180:183], v[160:163], v[40:43]
 ds_read_b64_tr_b16 a[200:201], v205 offset:57344
 v_mfma_f32_16x16x32_bf16 v[40:43], a[188:191], v[164:167], v[40:43]
 ds_read_b128 v[160:163], v194 offset:26624
 buffer_load_dwordx4 v193, s[8:11], s28 offen offset:3072 sc1 lds
 v_mfma_f32_16x16x32_bf16 v[16:19], a[176:179], v[168:171], v[16:19]
 ds_read_b128 v[164:167], v194 offset:27648
 ds_read_b64_tr_b16 a[202:203], v205 offset:59392
 v_mfma_f32_16x16x32_bf16 v[16:19], a[184:187], v[172:175], v[16:19]
 s_add_u32 m0, s33, 32768
 v_mfma_f32_16x16x32_bf16 v[44:47], a[180:183], v[168:171], v[44:47]
 s_bfe_u32 s29, s4, 262172
 s_lshl_b32 s29, s29, 17
 v_mfma_f32_16x16x32_bf16 v[44:47], a[188:191], v[172:175], v[44:47]
 ds_read_b128 v[168:171], v194 offset:28672
 ds_read_b64_tr_b16 a[204:205], v206 offset:57344
 v_mfma_f32_16x16x32_bf16 v[20:23], a[176:179], v[176:179], v[20:23]
 ds_read_b128 v[172:175], v194 offset:29696
 buffer_load_dwordx4 v199, s[12:15], s29 offen lds
 v_mfma_f32_16x16x32_bf16 v[20:23], a[184:187], v[180:183], v[20:23]
 ds_read_b64_tr_b16 a[206:207], v206 offset:59392
 v_mfma_f32_16x16x32_bf16 v[48:51], a[180:183], v[176:179], v[48:51]
 buffer_load_dwordx4 v200, s[12:15], s29 offen offset:1024 lds
 v_mfma_f32_16x16x32_bf16 v[48:51], a[188:191], v[180:183], v[48:51]
 v_mfma_f32_16x16x32_bf16 v[24:27], a[176:179], v[112:115], v[24:27]
 buffer_load_dwordx4 v201, s[12:15], s29 offen offset:2048 lds
 v_mfma_f32_16x16x32_bf16 v[24:27], a[184:187], v[116:119], v[24:27]
 v_mfma_f32_16x16x32_bf16 v[52:55], a[180:183], v[112:115], v[52:55]
 buffer_load_dwordx4 v202, s[12:15], s29 offen offset:3072 lds
 v_mfma_f32_16x16x32_bf16 v[52:55], a[188:191], v[116:119], v[52:55]
 s_waitcnt vmcnt(17) lgkmcnt(0)
 s_barrier
 v_mfma_f32_16x16x32_bf16 v[0:3], a[192:195], v[120:123], v[0:3]
 ds_read_b128 v[176:179], v210 offset:0
 ds_read_b128 v[180:183], v210 offset:1024
 v_mfma_f32_16x16x32_bf16 v[0:3], a[200:203], v[124:127], v[0:3]
 ds_read_b128 v[112:115], v210 offset:2048
 s_add_u32 m0, s33, 0
 v_mfma_f32_16x16x32_bf16 v[28:31], a[196:199], v[120:123], v[28:31]
 ds_read_b128 v[116:119], v210 offset:3072
 v_mfma_f32_16x16x32_bf16 v[28:31], a[204:207], v[124:127], v[28:31]
 ds_read_b128 v[120:123], v210 offset:4096
 s_bfe_u32 s28, s5, 262144
 v_mfma_f32_16x16x32_bf16 v[4:7], a[192:195], v[128:131], v[4:7]
 ds_read_b128 v[124:127], v210 offset:5120
 ds_read_b64_tr_b16 a[208:209], v205 offset:16384
 v_mfma_f32_16x16x32_bf16 v[4:7], a[200:203], v[132:135], v[4:7]
 s_mul_i32 s28, s28, 28672
 v_mfma_f32_16x16x32_bf16 v[32:35], a[196:199], v[128:131], v[32:35]
 buffer_load_dwordx4 v192, s[8:11], s28 offen sc1 lds
 v_mfma_f32_16x16x32_bf16 v[32:35], a[204:207], v[132:135], v[32:35]
 ds_read_b128 v[128:131], v210 offset:6144
 ds_read_b64_tr_b16 a[210:211], v205 offset:18432
 v_mfma_f32_16x16x32_bf16 v[8:11], a[192:195], v[136:139], v[8:11]
 ds_read_b128 v[132:135], v210 offset:7168
 v_mfma_f32_16x16x32_bf16 v[8:11], a[200:203], v[140:143], v[8:11]
 buffer_load_dwordx4 v192, s[8:11], s28 offen offset:1024 sc1 lds
 v_mfma_f32_16x16x32_bf16 v[36:39], a[196:199], v[136:139], v[36:39]
 ds_read_b64_tr_b16 a[212:213], v206 offset:16384
 v_mfma_f32_16x16x32_bf16 v[36:39], a[204:207], v[140:143], v[36:39]
 ds_read_b128 v[136:139], v210 offset:8192
 buffer_load_dwordx4 v193, s[8:11], s28 offen offset:2048 sc1 lds
 v_mfma_f32_16x16x32_bf16 v[12:15], a[192:195], v[144:147], v[12:15]
 ds_read_b128 v[140:143], v210 offset:9216
 ds_read_b64_tr_b16 a[214:215], v206 offset:18432
 v_mfma_f32_16x16x32_bf16 v[12:15], a[200:203], v[148:151], v[12:15]
 ds_read_b64_tr_b16 a[216:217], v205 offset:24576
 v_mfma_f32_16x16x32_bf16 v[40:43], a[196:199], v[144:147], v[40:43]
 buffer_load_dwordx4 v193, s[8:11], s28 offen offset:3072 sc1 lds
 v_mfma_f32_16x16x32_bf16 v[40:43], a[204:207], v[148:151], v[40:43]
 ds_read_b128 v[144:147], v210 offset:10240
 v_mfma_f32_16x16x32_bf16 v[16:19], a[192:195], v[152:155], v[16:19]
 ds_read_b128 v[148:151], v210 offset:11264
 s_add_u32 m0, s33, 16384
 v_mfma_f32_16x16x32_bf16 v[16:19], a[200:203], v[156:159], v[16:19]
 s_bfe_u32 s29, s5, 262144
 ds_read_b64_tr_b16 a[218:219], v205 offset:26624
 v_mfma_f32_16x16x32_bf16 v[44:47], a[196:199], v[152:155], v[44:47]
 s_lshl_b32 s29, s29, 17
 v_mfma_f32_16x16x32_bf16 v[44:47], a[204:207], v[156:159], v[44:47]
 ds_read_b128 v[152:155], v210 offset:12288
 buffer_load_dwordx4 v199, s[12:15], s29 offen lds
 v_mfma_f32_16x16x32_bf16 v[20:23], a[192:195], v[160:163], v[20:23]
 ds_read_b128 v[156:159], v210 offset:13312
 ds_read_b64_tr_b16 a[220:221], v206 offset:24576
 v_mfma_f32_16x16x32_bf16 v[20:23], a[200:203], v[164:167], v[20:23]
 ds_read_b64_tr_b16 a[222:223], v206 offset:26624
 v_mfma_f32_16x16x32_bf16 v[48:51], a[196:199], v[160:163], v[48:51]
 buffer_load_dwordx4 v200, s[12:15], s29 offen offset:1024 lds
 v_mfma_f32_16x16x32_bf16 v[48:51], a[204:207], v[164:167], v[48:51]
 v_mfma_f32_16x16x32_bf16 v[24:27], a[192:195], v[168:171], v[24:27]
 buffer_load_dwordx4 v201, s[12:15], s29 offen offset:2048 lds
 v_mfma_f32_16x16x32_bf16 v[24:27], a[200:203], v[172:175], v[24:27]
 v_mfma_f32_16x16x32_bf16 v[52:55], a[196:199], v[168:171], v[52:55]
 buffer_load_dwordx4 v202, s[12:15], s29 offen offset:3072 lds
 v_mfma_f32_16x16x32_bf16 v[52:55], a[204:207], v[172:175], v[52:55]
 s_waitcnt vmcnt(17) lgkmcnt(0)
 s_barrier
 v_mfma_f32_16x16x32_bf16 v[0:3], a[208:211], v[176:179], v[0:3]
 ds_read_b128 v[160:163], v209 offset:32768
 ds_read_b128 v[164:167], v209 offset:33792
 v_mfma_f32_16x16x32_bf16 v[0:3], a[216:219], v[180:183], v[0:3]
 ds_read_b128 v[168:171], v209 offset:34816
 s_add_u32 m0, s33, 122880
 v_mfma_f32_16x16x32_bf16 v[28:31], a[212:215], v[176:179], v[28:31]
 ds_read_b128 v[172:175], v209 offset:35840
 v_mfma_f32_16x16x32_bf16 v[28:31], a[220:223], v[180:183], v[28:31]
 ds_read_b128 v[176:179], v209 offset:36864
 s_bfe_u32 s28, s5, 262148
 v_mfma_f32_16x16x32_bf16 v[4:7], a[208:211], v[112:115], v[4:7]
 ds_read_b128 v[180:183], v209 offset:37888
 ds_read_b64_tr_b16 a[224:225], v205 offset:0
 v_mfma_f32_16x16x32_bf16 v[4:7], a[216:219], v[116:119], v[4:7]
 s_mul_i32 s28, s28, 28672
 v_mfma_f32_16x16x32_bf16 v[32:35], a[212:215], v[112:115], v[32:35]
 buffer_load_dwordx4 v192, s[8:11], s28 offen sc1 lds
 v_mfma_f32_16x16x32_bf16 v[32:35], a[220:223], v[116:119], v[32:35]
 ds_read_b128 v[112:115], v209 offset:38912
 ds_read_b64_tr_b16 a[226:227], v205 offset:2048
 v_mfma_f32_16x16x32_bf16 v[8:11], a[208:211], v[120:123], v[8:11]
 ds_read_b128 v[116:119], v209 offset:39936
 v_mfma_f32_16x16x32_bf16 v[8:11], a[216:219], v[124:127], v[8:11]
 buffer_load_dwordx4 v192, s[8:11], s28 offen offset:1024 sc1 lds
 v_mfma_f32_16x16x32_bf16 v[36:39], a[212:215], v[120:123], v[36:39]
 ds_read_b64_tr_b16 a[228:229], v206 offset:0
 v_mfma_f32_16x16x32_bf16 v[36:39], a[220:223], v[124:127], v[36:39]
 ds_read_b128 v[120:123], v209 offset:40960
 buffer_load_dwordx4 v193, s[8:11], s28 offen offset:2048 sc1 lds
 v_mfma_f32_16x16x32_bf16 v[12:15], a[208:211], v[128:131], v[12:15]
 ds_read_b128 v[124:127], v209 offset:41984
 ds_read_b64_tr_b16 a[230:231], v206 offset:2048
 v_mfma_f32_16x16x32_bf16 v[12:15], a[216:219], v[132:135], v[12:15]
 ds_read_b64_tr_b16 a[232:233], v205 offset:8192
 v_mfma_f32_16x16x32_bf16 v[40:43], a[212:215], v[128:131], v[40:43]
 buffer_load_dwordx4 v193, s[8:11], s28 offen offset:3072 sc1 lds
 v_mfma_f32_16x16x32_bf16 v[40:43], a[220:223], v[132:135], v[40:43]
 ds_read_b128 v[128:131], v209 offset:43008
 v_mfma_f32_16x16x32_bf16 v[16:19], a[208:211], v[136:139], v[16:19]
 ds_read_b128 v[132:135], v209 offset:44032
 s_add_u32 m0, s33, 139264
 v_mfma_f32_16x16x32_bf16 v[16:19], a[216:219], v[140:143], v[16:19]
 s_bfe_u32 s29, s5, 262148
 ds_read_b64_tr_b16 a[234:235], v205 offset:10240
 v_mfma_f32_16x16x32_bf16 v[44:47], a[212:215], v[136:139], v[44:47]
 s_lshl_b32 s29, s29, 17
 v_mfma_f32_16x16x32_bf16 v[44:47], a[220:223], v[140:143], v[44:47]
 ds_read_b128 v[136:139], v209 offset:45056
 buffer_load_dwordx4 v199, s[12:15], s29 offen lds
 v_mfma_f32_16x16x32_bf16 v[20:23], a[208:211], v[144:147], v[20:23]
 ds_read_b128 v[140:143], v209 offset:46080
 ds_read_b64_tr_b16 a[236:237], v206 offset:8192
 v_mfma_f32_16x16x32_bf16 v[20:23], a[216:219], v[148:151], v[20:23]
 ds_read_b64_tr_b16 a[238:239], v206 offset:10240
 v_mfma_f32_16x16x32_bf16 v[48:51], a[212:215], v[144:147], v[48:51]
 buffer_load_dwordx4 v200, s[12:15], s29 offen offset:1024 lds
 v_mfma_f32_16x16x32_bf16 v[48:51], a[220:223], v[148:151], v[48:51]
 v_mfma_f32_16x16x32_bf16 v[24:27], a[208:211], v[152:155], v[24:27]
 buffer_load_dwordx4 v201, s[12:15], s29 offen offset:2048 lds
 v_mfma_f32_16x16x32_bf16 v[24:27], a[216:219], v[156:159], v[24:27]
 v_mfma_f32_16x16x32_bf16 v[52:55], a[212:215], v[152:155], v[52:55]
 buffer_load_dwordx4 v202, s[12:15], s29 offen offset:3072 lds
 v_mfma_f32_16x16x32_bf16 v[52:55], a[220:223], v[156:159], v[52:55]
 s_waitcnt vmcnt(16) lgkmcnt(0)
 s_barrier
 v_mfma_f32_16x16x32_bf16 v[0:3], a[224:227], v[160:163], v[0:3]
 ds_read_b128 v[144:147], v194 offset:49152
 ds_read_b128 v[148:151], v194 offset:50176
 v_mfma_f32_16x16x32_bf16 v[0:3], a[232:235], v[164:167], v[0:3]
 ds_read_b128 v[152:155], v194 offset:51200
 s_add_u32 m0, s33, 90112
 v_mfma_f32_16x16x32_bf16 v[28:31], a[228:231], v[160:163], v[28:31]
 ds_read_b128 v[156:159], v194 offset:52224
 v_mfma_f32_16x16x32_bf16 v[28:31], a[236:239], v[164:167], v[28:31]
 ds_read_b128 v[160:163], v194 offset:53248
 s_bfe_u32 s28, s5, 262152
 v_mfma_f32_16x16x32_bf16 v[4:7], a[224:227], v[168:171], v[4:7]
 ds_read_b128 v[164:167], v194 offset:54272
 ds_read_b64_tr_b16 a[240:241], v203 offset:32768
 v_mfma_f32_16x16x32_bf16 v[4:7], a[232:235], v[172:175], v[4:7]
 s_mul_i32 s28, s28, 28672
 v_mfma_f32_16x16x32_bf16 v[32:35], a[228:231], v[168:171], v[32:35]
 buffer_load_dwordx4 v192, s[8:11], s28 offen sc1 lds
 v_mfma_f32_16x16x32_bf16 v[32:35], a[236:239], v[172:175], v[32:35]
 ds_read_b128 v[168:171], v194 offset:55296
 ds_read_b64_tr_b16 a[242:243], v203 offset:34816
 v_mfma_f32_16x16x32_bf16 v[8:11], a[224:227], v[176:179], v[8:11]
 ds_read_b128 v[172:175], v194 offset:56320
 v_mfma_f32_16x16x32_bf16 v[8:11], a[232:235], v[180:183], v[8:11]
 buffer_load_dwordx4 v192, s[8:11], s28 offen offset:1024 sc1 lds
 v_mfma_f32_16x16x32_bf16 v[36:39], a[228:231], v[176:179], v[36:39]
 ds_read_b64_tr_b16 a[244:245], v204 offset:32768
 v_mfma_f32_16x16x32_bf16 v[36:39], a[236:239], v[180:183], v[36:39]
 ds_read_b128 v[176:179], v194 offset:57344
 buffer_load_dwordx4 v193, s[8:11], s28 offen offset:2048 sc1 lds
 v_mfma_f32_16x16x32_bf16 v[12:15], a[224:227], v[112:115], v[12:15]
 ds_read_b128 v[180:183], v194 offset:58368
 ds_read_b64_tr_b16 a[246:247], v204 offset:34816
 v_mfma_f32_16x16x32_bf16 v[12:15], a[232:235], v[116:119], v[12:15]
 ds_read_b64_tr_b16 a[248:249], v203 offset:40960
 v_mfma_f32_16x16x32_bf16 v[40:43], a[228:231], v[112:115], v[40:43]
 buffer_load_dwordx4 v193, s[8:11], s28 offen offset:3072 sc1 lds
 v_mfma_f32_16x16x32_bf16 v[40:43], a[236:239], v[116:119], v[40:43]
 ds_read_b128 v[112:115], v194 offset:59392
 v_mfma_f32_16x16x32_bf16 v[16:19], a[224:227], v[120:123], v[16:19]
 ds_read_b128 v[116:119], v194 offset:60416
 s_add_u32 m0, s33, 106496
 v_mfma_f32_16x16x32_bf16 v[16:19], a[232:235], v[124:127], v[16:19]
 s_bfe_u32 s29, s5, 262152
 ds_read_b64_tr_b16 a[250:251], v203 offset:43008
 v_mfma_f32_16x16x32_bf16 v[44:47], a[228:231], v[120:123], v[44:47]
 s_lshl_b32 s29, s29, 17
 v_mfma_f32_16x16x32_bf16 v[44:47], a[236:239], v[124:127], v[44:47]
 ds_read_b128 v[120:123], v194 offset:61440
 buffer_load_dwordx4 v199, s[12:15], s29 offen lds
 v_mfma_f32_16x16x32_bf16 v[20:23], a[224:227], v[128:131], v[20:23]
 ds_read_b128 v[124:127], v194 offset:62464
 ds_read_b64_tr_b16 a[252:253], v204 offset:40960
 v_mfma_f32_16x16x32_bf16 v[20:23], a[232:235], v[132:135], v[20:23]
 ds_read_b64_tr_b16 a[254:255], v204 offset:43008
 v_mfma_f32_16x16x32_bf16 v[48:51], a[228:231], v[128:131], v[48:51]
 buffer_load_dwordx4 v200, s[12:15], s29 offen offset:1024 lds
 v_mfma_f32_16x16x32_bf16 v[48:51], a[236:239], v[132:135], v[48:51]
 v_mfma_f32_16x16x32_bf16 v[24:27], a[224:227], v[136:139], v[24:27]
 buffer_load_dwordx4 v201, s[12:15], s29 offen offset:2048 lds
 v_mfma_f32_16x16x32_bf16 v[24:27], a[232:235], v[140:143], v[24:27]
 v_mfma_f32_16x16x32_bf16 v[52:55], a[228:231], v[136:139], v[52:55]
 buffer_load_dwordx4 v202, s[12:15], s29 offen offset:3072 lds
 v_mfma_f32_16x16x32_bf16 v[52:55], a[236:239], v[140:143], v[52:55]
 s_waitcnt vmcnt(16) lgkmcnt(0)
 s_barrier
 v_mfma_f32_16x16x32_bf16 v[0:3], a[240:243], v[144:147], v[0:3]
 ds_read_b128 v[128:131], v194 offset:0
 ds_read_b128 v[132:135], v194 offset:1024
 v_mfma_f32_16x16x32_bf16 v[0:3], a[248:251], v[148:151], v[0:3]
 ds_read_b128 v[136:139], v194 offset:2048
 v_mfma_f32_16x16x32_bf16 v[28:31], a[244:247], v[144:147], v[28:31]
 ds_read_b128 v[140:143], v194 offset:3072
 ds_read_b64_tr_b16 a[0:1], v203 offset:16384
 v_mfma_f32_16x16x32_bf16 v[28:31], a[252:255], v[148:151], v[28:31]
 ds_read_b128 v[144:147], v194 offset:4096
 buffer_load_dword v216, v197, s[92:95], 0 offen offset:32 sc1
 v_mfma_f32_16x16x32_bf16 v[4:7], a[240:243], v[152:155], v[4:7]
 ds_read_b128 v[148:151], v194 offset:5120
 v_mfma_f32_16x16x32_bf16 v[4:7], a[248:251], v[156:159], v[4:7]
 s_add_u32 m0, s33, 73728
 s_bfe_u32 s28, s5, 262156
 v_mfma_f32_16x16x32_bf16 v[32:35], a[244:247], v[152:155], v[32:35]
 s_mul_i32 s28, s28, 28672
 ds_read_b64_tr_b16 a[2:3], v203 offset:18432
 v_mfma_f32_16x16x32_bf16 v[32:35], a[252:255], v[156:159], v[32:35]
 ds_read_b128 v[152:155], v194 offset:6144
 v_mfma_f32_16x16x32_bf16 v[8:11], a[240:243], v[160:163], v[8:11]
 ds_read_b128 v[156:159], v194 offset:7168
 buffer_load_dwordx4 v192, s[8:11], s28 offen sc1 lds
 v_mfma_f32_16x16x32_bf16 v[8:11], a[248:251], v[164:167], v[8:11]
 ds_read_b64_tr_b16 a[4:5], v204 offset:16384
 v_mfma_f32_16x16x32_bf16 v[36:39], a[244:247], v[160:163], v[36:39]
 buffer_load_dwordx4 v192, s[8:11], s28 offen offset:1024 sc1 lds
 v_mfma_f32_16x16x32_bf16 v[36:39], a[252:255], v[164:167], v[36:39]
 ds_read_b128 v[160:163], v194 offset:8192
 ds_read_b64_tr_b16 a[6:7], v204 offset:18432
 v_mfma_f32_16x16x32_bf16 v[12:15], a[240:243], v[168:171], v[12:15]
 ds_read_b128 v[164:167], v194 offset:9216
 v_mfma_f32_16x16x32_bf16 v[12:15], a[248:251], v[172:175], v[12:15]
 buffer_load_dwordx4 v193, s[8:11], s28 offen offset:2048 sc1 lds
 v_mfma_f32_16x16x32_bf16 v[40:43], a[244:247], v[168:171], v[40:43]
 ds_read_b64_tr_b16 a[8:9], v203 offset:24576
 v_mfma_f32_16x16x32_bf16 v[40:43], a[252:255], v[172:175], v[40:43]
 ds_read_b128 v[168:171], v194 offset:10240
 buffer_load_dwordx4 v193, s[8:11], s28 offen offset:3072 sc1 lds
 v_mfma_f32_16x16x32_bf16 v[16:19], a[240:243], v[176:179], v[16:19]
 ds_read_b128 v[172:175], v194 offset:11264
 ds_read_b64_tr_b16 a[10:11], v203 offset:26624
 v_mfma_f32_16x16x32_bf16 v[16:19], a[248:251], v[180:183], v[16:19]
 s_add_u32 m0, s33, 49152
 v_mfma_f32_16x16x32_bf16 v[44:47], a[244:247], v[176:179], v[44:47]
 s_bfe_u32 s29, s5, 262156
 s_lshl_b32 s29, s29, 17
 v_mfma_f32_16x16x32_bf16 v[44:47], a[252:255], v[180:183], v[44:47]
 ds_read_b128 v[176:179], v194 offset:12288
 ds_read_b64_tr_b16 a[12:13], v204 offset:24576
 v_mfma_f32_16x16x32_bf16 v[20:23], a[240:243], v[112:115], v[20:23]
 ds_read_b128 v[180:183], v194 offset:13312
 buffer_load_dwordx4 v199, s[12:15], s29 offen lds
 v_mfma_f32_16x16x32_bf16 v[20:23], a[248:251], v[116:119], v[20:23]
 ds_read_b64_tr_b16 a[14:15], v204 offset:26624
 v_mfma_f32_16x16x32_bf16 v[48:51], a[244:247], v[112:115], v[48:51]
 buffer_load_dwordx4 v200, s[12:15], s29 offen offset:1024 lds
 v_mfma_f32_16x16x32_bf16 v[48:51], a[252:255], v[116:119], v[48:51]
 v_mfma_f32_16x16x32_bf16 v[24:27], a[240:243], v[120:123], v[24:27]
 buffer_load_dwordx4 v201, s[12:15], s29 offen offset:2048 lds
 v_mfma_f32_16x16x32_bf16 v[24:27], a[248:251], v[124:127], v[24:27]
 v_mfma_f32_16x16x32_bf16 v[52:55], a[244:247], v[120:123], v[52:55]
 buffer_load_dwordx4 v202, s[12:15], s29 offen offset:3072 lds
 v_mfma_f32_16x16x32_bf16 v[52:55], a[252:255], v[124:127], v[52:55]
 s_waitcnt vmcnt(17) lgkmcnt(0)
 s_barrier
 v_mfma_f32_16x16x32_bf16 v[0:3], a[0:3], v[128:131], v[0:3]
 ds_read_b128 v[112:115], v209 offset:49152
 ds_read_b128 v[116:119], v209 offset:50176
 v_mfma_f32_16x16x32_bf16 v[0:3], a[8:11], v[132:135], v[0:3]
 ds_read_b128 v[120:123], v209 offset:51200
 s_add_u32 m0, s33, 32768
 v_mfma_f32_16x16x32_bf16 v[28:31], a[4:7], v[128:131], v[28:31]
 ds_read_b128 v[124:127], v209 offset:52224
 v_mfma_f32_16x16x32_bf16 v[28:31], a[12:15], v[132:135], v[28:31]
 ds_read_b128 v[128:131], v209 offset:53248
 s_bfe_u32 s29, s5, 262160
 v_mfma_f32_16x16x32_bf16 v[4:7], a[0:3], v[136:139], v[4:7]
 ds_read_b128 v[132:135], v209 offset:54272
 ds_read_b64_tr_b16 a[16:17], v207 offset:0
 v_mfma_f32_16x16x32_bf16 v[4:7], a[8:11], v[140:143], v[4:7]
 s_lshl_b32 s29, s29, 17
 v_mfma_f32_16x16x32_bf16 v[32:35], a[4:7], v[136:139], v[32:35]
 buffer_load_dwordx4 v199, s[12:15], s29 offen lds
 v_mfma_f32_16x16x32_bf16 v[32:35], a[12:15], v[140:143], v[32:35]
 ds_read_b128 v[136:139], v209 offset:55296
 ds_read_b64_tr_b16 a[18:19], v207 offset:2048
 v_mfma_f32_16x16x32_bf16 v[8:11], a[0:3], v[144:147], v[8:11]
 ds_read_b128 v[140:143], v209 offset:56320
 v_mfma_f32_16x16x32_bf16 v[8:11], a[8:11], v[148:151], v[8:11]
 buffer_load_dwordx4 v200, s[12:15], s29 offen offset:1024 lds
 v_mfma_f32_16x16x32_bf16 v[36:39], a[4:7], v[144:147], v[36:39]
 ds_read_b64_tr_b16 a[20:21], v208 offset:0
 v_mfma_f32_16x16x32_bf16 v[36:39], a[12:15], v[148:151], v[36:39]
 ds_read_b128 v[144:147], v209 offset:57344
 buffer_load_dwordx4 v201, s[12:15], s29 offen offset:2048 lds
 v_mfma_f32_16x16x32_bf16 v[12:15], a[0:3], v[152:155], v[12:15]
 ds_read_b128 v[148:151], v209 offset:58368
 ds_read_b64_tr_b16 a[22:23], v208 offset:2048
 v_mfma_f32_16x16x32_bf16 v[12:15], a[8:11], v[156:159], v[12:15]
 ds_read_b64_tr_b16 a[24:25], v207 offset:8192
 v_mfma_f32_16x16x32_bf16 v[40:43], a[4:7], v[152:155], v[40:43]
 buffer_load_dwordx4 v202, s[12:15], s29 offen offset:3072 lds
 v_mfma_f32_16x16x32_bf16 v[40:43], a[12:15], v[156:159], v[40:43]
 ds_read_b128 v[152:155], v209 offset:59392
 v_mfma_f32_16x16x32_bf16 v[16:19], a[0:3], v[160:163], v[16:19]
 ds_read_b128 v[156:159], v209 offset:60416
 s_add_u32 m0, s33, 0
 v_mfma_f32_16x16x32_bf16 v[16:19], a[8:11], v[164:167], v[16:19]
 s_bfe_u32 s29, s5, 262164
 ds_read_b64_tr_b16 a[26:27], v207 offset:10240
 v_mfma_f32_16x16x32_bf16 v[44:47], a[4:7], v[160:163], v[44:47]
 s_lshl_b32 s29, s29, 17
 v_mfma_f32_16x16x32_bf16 v[44:47], a[12:15], v[164:167], v[44:47]
 ds_read_b128 v[160:163], v209 offset:61440
 buffer_load_dwordx4 v199, s[12:15], s29 offen lds
 v_mfma_f32_16x16x32_bf16 v[20:23], a[0:3], v[168:171], v[20:23]
 ds_read_b128 v[164:167], v209 offset:62464
 ds_read_b64_tr_b16 a[28:29], v208 offset:8192
 v_mfma_f32_16x16x32_bf16 v[20:23], a[8:11], v[172:175], v[20:23]
 ds_read_b64_tr_b16 a[30:31], v208 offset:10240
 v_mfma_f32_16x16x32_bf16 v[48:51], a[4:7], v[168:171], v[48:51]
 buffer_load_dwordx4 v200, s[12:15], s29 offen offset:1024 lds
 v_mfma_f32_16x16x32_bf16 v[48:51], a[12:15], v[172:175], v[48:51]
 v_mfma_f32_16x16x32_bf16 v[24:27], a[0:3], v[176:179], v[24:27]
 buffer_load_dwordx4 v201, s[12:15], s29 offen offset:2048 lds
 v_mfma_f32_16x16x32_bf16 v[24:27], a[8:11], v[180:183], v[24:27]
 v_mfma_f32_16x16x32_bf16 v[52:55], a[4:7], v[176:179], v[52:55]
 buffer_load_dwordx4 v202, s[12:15], s29 offen offset:3072 lds
 v_mfma_f32_16x16x32_bf16 v[52:55], a[12:15], v[180:183], v[52:55]
 s_waitcnt vmcnt(17) lgkmcnt(0)
 s_barrier
 v_mfma_f32_16x16x32_bf16 v[0:3], a[16:19], v[112:115], v[0:3]
 ds_read_b128 v[168:171], v209 offset:16384
 ds_read_b128 v[172:175], v209 offset:17408
 v_mfma_f32_16x16x32_bf16 v[0:3], a[24:27], v[116:119], v[0:3]
 ds_read_b128 v[176:179], v209 offset:18432
 ds_read_b64_tr_b16 a[32:33], v205 offset:32768
 v_mfma_f32_16x16x32_bf16 v[28:31], a[20:23], v[112:115], v[28:31]
 ds_read_b128 v[180:183], v209 offset:19456
 v_mfma_f32_16x16x32_bf16 v[28:31], a[28:31], v[116:119], v[28:31]
 ds_read_b128 v[112:115], v209 offset:20480
 s_waitcnt vmcnt(16)
 v_cmp_eq_u32 vcc, 1, v216
 s_and_b32 s42, vcc_lo, 255
 s_cmp_eq_u32 s42, 255
 s_cbranch_scc0 L_spin2
L_spun2:
 v_mfma_f32_16x16x32_bf16 v[4:7], a[16:19], v[120:123], v[4:7]
 ds_read_b128 v[116:119], v209 offset:21504
 ds_read_b64_tr_b16 a[34:35], v205 offset:34816
 v_mfma_f32_16x16x32_bf16 v[4:7], a[24:27], v[124:127], v[4:7]
 s_add_u32 m0, s33, 16384
 v_mfma_f32_16x16x32_bf16 v[32:35], a[20:23], v[120:123], v[32:35]
 s_bfe_u32 s28, s4, 262144
 s_mul_i32 s28, s28, 28672
 v_mfma_f32_16x16x32_bf16 v[32:35], a[28:31], v[124:127], v[32:35]
 ds_read_b128 v[120:123], v209 offset:22528
 ds_read_b64_tr_b16 a[36:37], v206 offset:32768
 v_mfma_f32_16x16x32_bf16 v[8:11], a[16:19], v[128:131], v[8:11]
 ds_read_b128 v[124:127], v209 offset:23552
 v_mfma_f32_16x16x32_bf16 v[8:11], a[24:27], v[132:135], v[8:11]
 buffer_load_dwordx4 v192, s[20:23], s28 offen sc1 lds
 v_mfma_f32_16x16x32_bf16 v[36:39], a[20:23], v[128:131], v[36:39]
 buffer_load_dwordx4 v192, s[20:23], s28 offen offset:1024 sc1 lds
 v_mfma_f32_16x16x32_bf16 v[36:39], a[28:31], v[132:135], v[36:39]
 ds_read_b128 v[128:131], v209 offset:24576
 ds_read_b64_tr_b16 a[38:39], v206 offset:34816
 v_mfma_f32_16x16x32_bf16 v[12:15], a[16:19], v[136:139], v[12:15]
 ds_read_b128 v[132:135], v209 offset:25600
 v_mfma_f32_16x16x32_bf16 v[12:15], a[24:27], v[140:143], v[12:15]
 buffer_load_dwordx4 v193, s[20:23], s28 offen offset:2048 sc1 lds
 v_mfma_f32_16x16x32_bf16 v[40:43], a[20:23], v[136:139], v[40:43]
 ds_read_b64_tr_b16 a[40:41], v205 offset:40960
 ds_read_b64_tr_b16 a[42:43], v205 offset:43008
 v_mfma_f32_16x16x32_bf16 v[40:43], a[28:31], v[140:143], v[40:43]
 ds_read_b128 v[136:139], v209 offset:26624
 buffer_load_dwordx4 v193, s[20:23], s28 offen offset:3072 sc1 lds
 v_mfma_f32_16x16x32_bf16 v[16:19], a[16:19], v[144:147], v[16:19]
 ds_read_b128 v[140:143], v209 offset:27648
 v_mfma_f32_16x16x32_bf16 v[16:19], a[24:27], v[148:151], v[16:19]
 s_add_u32 m0, s33, 122880
 ds_read_b64_tr_b16 a[44:45], v206 offset:40960
 v_mfma_f32_16x16x32_bf16 v[44:47], a[20:23], v[144:147], v[44:47]
 s_bfe_u32 s28, s5, 262160
 s_mul_i32 s28, s28, 28672
 v_mfma_f32_16x16x32_bf16 v[44:47], a[28:31], v[148:151], v[44:47]
 ds_read_b128 v[144:147], v209 offset:28672
 v_mfma_f32_16x16x32_bf16 v[20:23], a[16:19], v[152:155], v[20:23]
 ds_read_b128 v[148:151], v209 offset:29696
 ds_read_b64_tr_b16 a[46:47], v206 offset:43008
 v_mfma_f32_16x16x32_bf16 v[20:23], a[24:27], v[156:159], v[20:23]
 buffer_load_dwordx4 v192, s[8:11], s28 offen sc1 lds
 v_mfma_f32_16x16x32_bf16 v[48:51], a[20:23], v[152:155], v[48:51]
 buffer_load_dwordx4 v192, s[8:11], s28 offen offset:1024 sc1 lds
 v_mfma_f32_16x16x32_bf16 v[48:51], a[28:31], v[156:159], v[48:51]
 v_mfma_f32_16x16x32_bf16 v[24:27], a[16:19], v[160:163], v[24:27]
 buffer_load_dwordx4 v193, s[8:11], s28 offen offset:2048 sc1 lds
 v_mfma_f32_16x16x32_bf16 v[24:27], a[24:27], v[164:167], v[24:27]
 v_mfma_f32_16x16x32_bf16 v[52:55], a[20:23], v[160:163], v[52:55]
 buffer_load_dwordx4 v193, s[8:11], s28 offen offset:3072 sc1 lds
 v_mfma_f32_16x16x32_bf16 v[52:55], a[28:31], v[164:167], v[52:55]
 s_waitcnt vmcnt(16) lgkmcnt(0)
 s_barrier
 v_mfma_f32_16x16x32_bf16 v[0:3], a[32:35], v[168:171], v[0:3]
 ds_read_b128 v[152:155], v209 offset:0
 ds_read_b128 v[156:159], v209 offset:1024
 v_mfma_f32_16x16x32_bf16 v[0:3], a[40:43], v[172:175], v[0:3]
 ds_read_b128 v[160:163], v209 offset:2048
 s_add_u32 m0, s33, 139264
 v_mfma_f32_16x16x32_bf16 v[28:31], a[36:39], v[168:171], v[28:31]
 ds_read_b128 v[164:167], v209 offset:3072
 s_lshr_b32 s52, s30, 1
 v_mfma_f32_16x16x32_bf16 v[28:31], a[44:47], v[172:175], v[28:31]
 ds_read_b128 v[168:171], v209 offset:4096
 s_bfe_u32 s28, s4, 262148
 s_and_b32 s53, s30, 1
 v_mfma_f32_16x16x32_bf16 v[4:7], a[32:35], v[176:179], v[4:7]
 ds_read_b128 v[172:175], v209 offset:5120
 ds_read_b64_tr_b16 a[48:49], v203 offset:49152
 v_mfma_f32_16x16x32_bf16 v[4:7], a[40:43], v[180:183], v[4:7]
 s_mul_i32 s28, s28, 28672
 s_mul_i32 s53, s53, 3584
 v_mfma_f32_16x16x32_bf16 v[32:35], a[36:39], v[176:179], v[32:35]
 buffer_load_dwordx4 v192, s[20:23], s28 offen sc1 lds
 v_mfma_f32_16x16x32_bf16 v[32:35], a[44:47], v[180:183], v[32:35]
 ds_read_b128 v[176:179], v209 offset:6144
 ds_read_b64_tr_b16 a[50:51], v203 offset:51200
 v_mfma_f32_16x16x32_bf16 v[8:11], a[32:35], v[112:115], v[8:11]
 ds_read_b128 v[180:183], v209 offset:7168
 s_lshl_b32 s54, s52, 1
 s_add_u32 s54, s54, 0
 v_mfma_f32_16x16x32_bf16 v[8:11], a[40:43], v[116:119], v[8:11]
 buffer_load_dwordx4 v192, s[20:23], s28 offen offset:1024 sc1 lds
 v_mfma_f32_16x16x32_bf16 v[36:39], a[36:39], v[112:115], v[36:39]
 ds_read_b64_tr_b16 a[52:53], v204 offset:49152
 s_xor_b32 s55, s54, s49
 v_mfma_f32_16x16x32_bf16 v[36:39], a[44:47], v[116:119], v[36:39]
 ds_read_b128 v[112:115], v209 offset:8192
 buffer_load_dwordx4 v193, s[20:23], s28 offen offset:2048 sc1 lds
 v_mfma_f32_16x16x32_bf16 v[12:15], a[32:35], v[120:123], v[12:15]
 ds_read_b128 v[116:119], v209 offset:9216
 ds_read_b64_tr_b16 a[54:55], v204 offset:51200
 v_mfma_f32_16x16x32_bf16 v[12:15], a[40:43], v[124:127], v[12:15]
 ds_read_b64_tr_b16 a[56:57], v203 offset:57344
 s_mul_i32 s55, s55, 21504
 s_max_u32 s54, s54, 1
 v_mfma_f32_16x16x32_bf16 v[40:43], a[36:39], v[120:123], v[40:43]
 buffer_load_dwordx4 v193, s[20:23], s28 offen offset:3072 sc1 lds
 v_mfma_f32_16x16x32_bf16 v[40:43], a[44:47], v[124:127], v[40:43]
 ds_read_b128 v[120:123], v209 offset:10240
 s_sub_u32 s54, s54, 1
 v_mfma_f32_16x16x32_bf16 v[16:19], a[32:35], v[128:131], v[16:19]
 ds_read_b128 v[124:127], v209 offset:11264
 s_add_u32 m0, s33, 90112
 v_mfma_f32_16x16x32_bf16 v[16:19], a[40:43], v[132:135], v[16:19]
 s_bfe_u32 s28, s5, 262164
 ds_read_b64_tr_b16 a[58:59], v203 offset:59392
 s_mul_i32 s54, s54, 7168
 v_mfma_f32_16x16x32_bf16 v[44:47], a[36:39], v[128:131], v[44:47]
 s_mul_i32 s28, s28, 28672
 s_add_u32 s55, s55, s54
 v_mfma_f32_16x16x32_bf16 v[44:47], a[44:47], v[132:135], v[44:47]
 ds_read_b128 v[128:131], v209 offset:12288
 buffer_load_dwordx4 v192, s[8:11], s28 offen sc1 lds
 v_mfma_f32_16x16x32_bf16 v[20:23], a[32:35], v[136:139], v[20:23]
 ds_read_b128 v[132:135], v209 offset:13312
 ds_read_b64_tr_b16 a[60:61], v204 offset:57344
 v_mfma_f32_16x16x32_bf16 v[20:23], a[40:43], v[140:143], v[20:23]
 ds_read_b64_tr_b16 a[62:63], v204 offset:59392
 s_add_u32 s56, s55, s53
 v_mfma_f32_16x16x32_bf16 v[48:51], a[36:39], v[136:139], v[48:51]
 buffer_load_dwordx4 v192, s[8:11], s28 offen offset:1024 sc1 lds
 v_mfma_f32_16x16x32_bf16 v[48:51], a[44:47], v[140:143], v[48:51]
 s_lshl_b32 s54, s52, 1
 s_add_u32 s54, s54, 1
 s_xor_b32 s55, s54, s49
 v_mfma_f32_16x16x32_bf16 v[24:27], a[32:35], v[144:147], v[24:27]
 buffer_load_dwordx4 v193, s[8:11], s28 offen offset:2048 sc1 lds
 v_mfma_f32_16x16x32_bf16 v[24:27], a[40:43], v[148:151], v[24:27]
 s_mul_i32 s55, s55, 21504
 s_max_u32 s54, s54, 1
 v_mfma_f32_16x16x32_bf16 v[52:55], a[36:39], v[144:147], v[52:55]
 buffer_load_dwordx4 v193, s[8:11], s28 offen offset:3072 sc1 lds
 v_mfma_f32_16x16x32_bf16 v[52:55], a[44:47], v[148:151], v[52:55]
 s_waitcnt vmcnt(12) lgkmcnt(0)
 s_barrier
 v_mfma_f32_16x16x32_bf16 v[0:3], a[48:51], v[152:155], v[0:3]
 ds_read_b128 v[136:139], v194 offset:16384
 ds_read_b128 v[140:143], v194 offset:17408
 v_mfma_f32_16x16x32_bf16 v[0:3], a[56:59], v[156:159], v[0:3]
 ds_read_b128 v[144:147], v194 offset:18432
 s_add_u32 m0, s33, 106496
 v_mfma_f32_16x16x32_bf16 v[28:31], a[52:55], v[152:155], v[28:31]
 ds_read_b128 v[148:151], v194 offset:19456
 s_sub_u32 s54, s54, 1
 v_mfma_f32_16x16x32_bf16 v[28:31], a[60:63], v[156:159], v[28:31]
 ds_read_b128 v[152:155], v194 offset:20480
 s_bfe_u32 s28, s4, 262152
 v_mfma_f32_16x16x32_bf16 v[4:7], a[48:51], v[160:163], v[4:7]
 ds_read_b128 v[156:159], v194 offset:21504
 s_mul_i32 s54, s54, 7168
 v_mfma_f32_16x16x32_bf16 v[4:7], a[56:59], v[164:167], v[4:7]
 s_mul_i32 s28, s28, 28672
 s_add_u32 s55, s55, s54
 v_mfma_f32_16x16x32_bf16 v[32:35], a[52:55], v[160:163], v[32:35]
 buffer_load_dwordx4 v192, s[20:23], s28 offen sc1 lds
 v_mfma_f32_16x16x32_bf16 v[32:35], a[60:63], v[164:167], v[32:35]
 ds_read_b128 v[160:163], v194 offset:22528
 s_add_u32 s57, s55, s53
 v_mfma_f32_16x16x32_bf16 v[8:11], a[48:51], v[168:171], v[8:11]
 ds_read_b128 v[164:167], v194 offset:23552
 s_mul_i32 s55, s49, 21504
 v_mfma_f32_16x16x32_bf16 v[8:11], a[56:59], v[172:175], v[8:11]
 buffer_load_dwordx4 v192, s[20:23], s28 offen offset:1024 sc1 lds
 v_mfma_f32_16x16x32_bf16 v[36:39], a[52:55], v[168:171], v[36:39]
 s_add_u32 s58, s55, s53
 v_mfma_f32_16x16x32_bf16 v[36:39], a[60:63], v[172:175], v[36:39]
 ds_read_b128 v[168:171], v194 offset:24576
 buffer_load_dwordx4 v193, s[20:23], s28 offen offset:2048 sc1 lds
 v_mfma_f32_16x16x32_bf16 v[12:15], a[48:51], v[176:179], v[12:15]
 ds_read_b128 v[172:175], v194 offset:25600
 s_cmp_eq_u32 s52, 0
 s_cselect_b32 s54, 1073741824, 0
 s_cselect_b32 s55, 0, 1073741824
 v_mfma_f32_16x16x32_bf16 v[12:15], a[56:59], v[180:183], v[12:15]
 v_mfma_f32_16x16x32_bf16 v[40:43], a[52:55], v[176:179], v[40:43]
 buffer_load_dwordx4 v193, s[20:23], s28 offen offset:3072 sc1 lds
 v_mfma_f32_16x16x32_bf16 v[40:43], a[60:63], v[180:183], v[40:43]
 ds_read_b128 v[176:179], v194 offset:26624
 v_lshlrev_b32 v250, 4, v184
 v_mfma_f32_16x16x32_bf16 v[16:19], a[48:51], v[112:115], v[16:19]
 ds_read_b128 v[180:183], v194 offset:27648
 s_add_u32 m0, s33, 73728
 v_mfma_f32_16x16x32_bf16 v[16:19], a[56:59], v[116:119], v[16:19]
 s_bfe_u32 s28, s5, 262168
 v_lshlrev_b32 v251, 3, v184
 v_mfma_f32_16x16x32_bf16 v[44:47], a[52:55], v[112:115], v[44:47]
 s_mul_i32 s28, s28, 28672
 v_add_u32 v251, 3072, v251
 v_mfma_f32_16x16x32_bf16 v[44:47], a[60:63], v[116:119], v[44:47]
 ds_read_b128 v[112:115], v194 offset:28672
 buffer_load_dwordx4 v192, s[8:11], s28 offen sc1 lds
 v_mfma_f32_16x16x32_bf16 v[20:23], a[48:51], v[120:123], v[20:23]
 ds_read_b128 v[116:119], v194 offset:29696
 v_add_u32 v252, s54, v250
 v_mfma_f32_16x16x32_bf16 v[20:23], a[56:59], v[124:127], v[20:23]
 v_add_u32 v253, s54, v251
 v_add_u32 v254, s55, v250
 v_mfma_f32_16x16x32_bf16 v[48:51], a[52:55], v[120:123], v[48:51]
 buffer_load_dwordx4 v192, s[8:11], s28 offen offset:1024 sc1 lds
 v_mfma_f32_16x16x32_bf16 v[48:51], a[60:63], v[124:127], v[48:51]
 v_add_u32 v255, s55, v251
 s_mov_b32 s16, s84
 v_mfma_f32_16x16x32_bf16 v[24:27], a[48:51], v[128:131], v[24:27]
 buffer_load_dwordx4 v193, s[8:11], s28 offen offset:2048 sc1 lds
 v_mfma_f32_16x16x32_bf16 v[24:27], a[56:59], v[132:135], v[24:27]
 s_mov_b32 s17, s85
 s_mov_b32 s18, 3670016
 v_mfma_f32_16x16x32_bf16 v[52:55], a[52:55], v[128:131], v[52:55]
 buffer_load_dwordx4 v193, s[8:11], s28 offen offset:3072 sc1 lds
 v_mfma_f32_16x16x32_bf16 v[52:55], a[60:63], v[132:135], v[52:55]
 s_waitcnt vmcnt(16) lgkmcnt(0)
 s_barrier
 v_mfma_f32_16x16x32_bf16 v[56:59], a[128:131], v[136:139], 0
 ds_read_b128 v[120:123], v209 offset:49152
 ds_read_b128 v[124:127], v209 offset:50176
 v_mfma_f32_16x16x32_bf16 v[56:59], a[136:139], v[140:143], v[56:59]
 ds_read_b128 v[128:131], v209 offset:51200
 s_add_u32 m0, s33, 49152
 v_mfma_f32_16x16x32_bf16 v[84:87], a[132:135], v[136:139], 0
 ds_read_b128 v[132:135], v209 offset:52224
 s_mov_b32 s19, 0x20000
 v_mfma_f32_16x16x32_bf16 v[84:87], a[140:143], v[140:143], v[84:87]
 ds_read_b128 v[136:139], v209 offset:53248
 s_bfe_u32 s29, s5, 262168
 s_mul_i32 s52, s51, 917504
 v_mfma_f32_16x16x32_bf16 v[60:63], a[128:131], v[144:147], 0
 ds_read_b128 v[140:143], v209 offset:54272
 ds_read_b64_tr_b16 a[64:65], v203 offset:32768
 v_mfma_f32_16x16x32_bf16 v[60:63], a[136:139], v[148:151], v[60:63]
 s_lshl_b32 s29, s29, 17
 s_lshl_b32 s53, s48, 11
 v_mfma_f32_16x16x32_bf16 v[88:91], a[132:135], v[144:147], 0
 buffer_load_dwordx4 v199, s[12:15], s29 offen lds
 v_mfma_f32_16x16x32_bf16 v[88:91], a[140:143], v[148:151], v[88:91]
 ds_read_b128 v[144:147], v209 offset:55296
 ds_read_b64_tr_b16 a[66:67], v203 offset:34816
 v_mfma_f32_16x16x32_bf16 v[64:67], a[128:131], v[152:155], 0
 ds_read_b128 v[148:151], v209 offset:56320
 s_add_u32 s52, s52, s53
 s_lshl_b32 s53, s37, 8
 v_mfma_f32_16x16x32_bf16 v[64:67], a[136:139], v[156:159], v[64:67]
 buffer_load_dwordx4 v200, s[12:15], s29 offen offset:1024 lds
 v_mfma_f32_16x16x32_bf16 v[92:95], a[132:135], v[152:155], 0
 ds_read_b64_tr_b16 a[68:69], v204 offset:32768
 s_add_u32 s52, s52, s53
 v_mfma_f32_16x16x32_bf16 v[92:95], a[140:143], v[156:159], v[92:95]
 ds_read_b128 v[152:155], v209 offset:57344
 buffer_load_dwordx4 v201, s[12:15], s29 offen offset:2048 lds
 v_mfma_f32_16x16x32_bf16 v[68:71], a[128:131], v[160:163], 0
 ds_read_b128 v[156:159], v209 offset:58368
 ds_read_b64_tr_b16 a[70:71], v204 offset:34816
 v_mfma_f32_16x16x32_bf16 v[68:71], a[136:139], v[164:167], v[68:71]
 ds_read_b64_tr_b16 a[72:73], v203 offset:40960
 s_lshl_b32 s53, s49, 6
 s_add_u32 s52, s52, s53
 v_mfma_f32_16x16x32_bf16 v[96:99], a[132:135], v[160:163], 0
 buffer_load_dwordx4 v202, s[12:15], s29 offen offset:3072 lds
 v_mfma_f32_16x16x32_bf16 v[96:99], a[140:143], v[164:167], v[96:99]
 ds_read_b128 v[160:163], v209 offset:59392
 s_and_b32 s53, s30, 1
 v_mfma_f32_16x16x32_bf16 v[72:75], a[128:131], v[168:171], 0
 ds_read_b128 v[164:167], v209 offset:60416
 s_add_u32 m0, s33, 16384
 v_mfma_f32_16x16x32_bf16 v[72:75], a[136:139], v[172:175], v[72:75]
 s_bfe_u32 s28, s4, 262156
 ds_read_b64_tr_b16 a[74:75], v203 offset:43008
 s_lshl_b32 s53, s53, 5
 v_mfma_f32_16x16x32_bf16 v[100:103], a[132:135], v[168:171], 0
 s_mul_i32 s28, s28, 28672
 s_add_u32 s52, s52, s53
 v_mfma_f32_16x16x32_bf16 v[100:103], a[140:143], v[172:175], v[100:103]
 ds_read_b128 v[168:171], v209 offset:61440
 buffer_load_dwordx4 v192, s[20:23], s28 offen sc1 lds
 v_mfma_f32_16x16x32_bf16 v[76:79], a[128:131], v[176:179], 0
 ds_read_b128 v[172:175], v209 offset:62464
 ds_read_b64_tr_b16 a[76:77], v204 offset:40960
 v_mfma_f32_16x16x32_bf16 v[76:79], a[136:139], v[180:183], v[76:79]
 ds_read_b64_tr_b16 a[78:79], v204 offset:43008
 s_add_u32 s52, s52, s55
 v_mfma_f32_16x16x32_bf16 v[104:107], a[132:135], v[176:179], 0
 buffer_load_dwordx4 v192, s[20:23], s28 offen offset:1024 sc1 lds
 v_mfma_f32_16x16x32_bf16 v[104:107], a[140:143], v[180:183], v[104:107]
 v_and_b32 v186, 15, v184
 v_lshrrev_b32 v187, 4, v184
 v_lshlrev_b32 v188, 3, v187
 v_mfma_f32_16x16x32_bf16 v[80:83], a[128:131], v[112:115], 0
 buffer_load_dwordx4 v193, s[20:23], s28 offen offset:2048 sc1 lds
 v_mfma_f32_16x16x32_bf16 v[80:83], a[136:139], v[116:119], v[80:83]
 v_lshl_add_u32 v188, v186, 12, v188
 v_add_u32 v211, s52, v188
 v_mfma_f32_16x16x32_bf16 v[108:111], a[132:135], v[112:115], 0
 buffer_load_dwordx4 v193, s[20:23], s28 offen offset:3072 sc1 lds
 v_mfma_f32_16x16x32_bf16 v[108:111], a[140:143], v[116:119], v[108:111]
 s_waitcnt vmcnt(20) lgkmcnt(0)
 s_barrier
 v_mfma_f32_16x16x32_bf16 v[0:3], a[64:67], v[120:123], v[0:3]
 ds_read_b128 v[176:179], v210 offset:0
 ds_read_b128 v[180:183], v210 offset:1024
 v_mfma_f32_16x16x32_bf16 v[0:3], a[72:75], v[124:127], v[0:3]
 ds_read_b128 v[112:115], v210 offset:2048
 s_add_u32 m0, s33, 122880
 v_mfma_f32_16x16x32_bf16 v[28:31], a[68:71], v[120:123], v[28:31]
 ds_read_b128 v[116:119], v210 offset:3072
 v_lshlrev_b32 v187, 2, v187
 v_mfma_f32_16x16x32_bf16 v[28:31], a[76:79], v[124:127], v[28:31]
 ds_read_b128 v[120:123], v210 offset:4096
 s_bfe_u32 s28, s5, 262172
 v_mfma_f32_16x16x32_bf16 v[4:7], a[64:67], v[128:131], v[4:7]
 ds_read_b128 v[124:127], v210 offset:5120
 v_mfma_f32_16x16x32_bf16 v[4:7], a[72:75], v[132:135], v[4:7]
 s_mul_i32 s28, s28, 28672
 v_sub_u32 v186, v186, v187
 v_mfma_f32_16x16x32_bf16 v[32:35], a[68:71], v[128:131], v[32:35]
 buffer_load_dwordx4 v192, s[8:11], s28 offen sc1 lds
 v_mfma_f32_16x16x32_bf16 v[32:35], a[76:79], v[132:135], v[32:35]
 ds_read_b128 v[128:131], v210 offset:6144
 v_mov_b32 v187, 0x3f80
 v_mfma_f32_16x16x32_bf16 v[8:11], a[64:67], v[136:139], v[8:11]
 ds_read_b128 v[132:135], v210 offset:7168
 v_mov_b32 v188, 0x3f800000
 v_mfma_f32_16x16x32_bf16 v[8:11], a[72:75], v[140:143], v[8:11]
 buffer_load_dwordx4 v192, s[8:11], s28 offen offset:1024 sc1 lds
 v_mfma_f32_16x16x32_bf16 v[36:39], a[68:71], v[136:139], v[36:39]
 v_mov_b32 v244, 0
 v_mfma_f32_16x16x32_bf16 v[36:39], a[76:79], v[140:143], v[36:39]
 ds_read_b128 v[136:139], v210 offset:8192
 buffer_load_dwordx4 v193, s[8:11], s28 offen offset:2048 sc1 lds
 v_mfma_f32_16x16x32_bf16 v[12:15], a[64:67], v[144:147], v[12:15]
 ds_read_b128 v[140:143], v210 offset:9216
 v_mov_b32 v245, 0
 v_mfma_f32_16x16x32_bf16 v[12:15], a[72:75], v[148:151], v[12:15]
 v_mov_b32 v248, 0
 v_mov_b32 v249, 0
 v_mfma_f32_16x16x32_bf16 v[40:43], a[68:71], v[144:147], v[40:43]
 buffer_load_dwordx4 v193, s[8:11], s28 offen offset:3072 sc1 lds
 v_mfma_f32_16x16x32_bf16 v[40:43], a[76:79], v[148:151], v[40:43]
 ds_read_b128 v[144:147], v210 offset:10240
 v_cmp_eq_u32 vcc, 0, v186
 v_mfma_f32_16x16x32_bf16 v[16:19], a[64:67], v[152:155], v[16:19]
 ds_read_b128 v[148:151], v210 offset:11264
 s_add_u32 m0, s33, 32768
 v_mfma_f32_16x16x32_bf16 v[16:19], a[72:75], v[156:159], v[16:19]
 s_bfe_u32 s29, s5, 262172
 v_mfma_f32_16x16x32_bf16 v[44:47], a[68:71], v[152:155], v[44:47]
 s_lshl_b32 s29, s29, 17
 v_cndmask_b32 v246, v244, v187, vcc
 v_mfma_f32_16x16x32_bf16 v[44:47], a[76:79], v[156:159], v[44:47]
 ds_read_b128 v[152:155], v210 offset:12288
 buffer_load_dwordx4 v199, s[12:15], s29 offen lds
 v_mfma_f32_16x16x32_bf16 v[20:23], a[64:67], v[160:163], v[20:23]
 ds_read_b128 v[156:159], v210 offset:13312
 v_cmp_eq_u32 vcc, 1, v186
 v_mfma_f32_16x16x32_bf16 v[20:23], a[72:75], v[164:167], v[20:23]
 s_nop 0
 v_cndmask_b32 v246, v246, v188, vcc
 v_cmp_eq_u32 vcc, 2, v186
 v_mfma_f32_16x16x32_bf16 v[48:51], a[68:71], v[160:163], v[48:51]
 buffer_load_dwordx4 v200, s[12:15], s29 offen offset:1024 lds
 v_mfma_f32_16x16x32_bf16 v[48:51], a[76:79], v[164:167], v[48:51]
 v_cndmask_b32 v247, v244, v187, vcc
 v_mfma_f32_16x16x32_bf16 v[24:27], a[64:67], v[168:171], v[24:27]
 buffer_load_dwordx4 v201, s[12:15], s29 offen offset:2048 lds
 v_mfma_f32_16x16x32_bf16 v[24:27], a[72:75], v[172:175], v[24:27]
 v_cmp_eq_u32 vcc, 3, v186
 s_nop 1
 v_cndmask_b32 v247, v247, v188, vcc
 v_mfma_f32_16x16x32_bf16 v[52:55], a[68:71], v[168:171], v[52:55]
 buffer_load_dwordx4 v202, s[12:15], s29 offen offset:3072 lds
 v_mfma_f32_16x16x32_bf16 v[52:55], a[76:79], v[172:175], v[52:55]
 s_waitcnt vmcnt(24) lgkmcnt(0)
 s_barrier
 v_mfma_f32_16x16x32_bf16 v[56:59], a[144:147], v[176:179], v[56:59]
 ds_read_b128 v[160:163], v209 offset:16384
 ds_read_b128 v[164:167], v209 offset:17408
 v_mfma_f32_16x16x32_bf16 v[56:59], a[152:155], v[180:183], v[56:59]
 ds_read_b128 v[168:171], v209 offset:18432
 v_mfma_f32_16x16x32_bf16 v[84:87], a[148:151], v[176:179], v[84:87]
 ds_read_b128 v[172:175], v209 offset:19456
 v_mfma_f32_16x16x32_bf16 v[84:87], a[156:159], v[180:183], v[84:87]
 ds_read_b128 v[176:179], v209 offset:20480
 ds_read_b64_tr_b16 a[80:81], v203 offset:0
 v_mfma_f32_16x16x32_bf16 v[60:63], a[144:147], v[112:115], v[60:63]
 ds_read_b128 v[180:183], v209 offset:21504
 v_mfma_f32_16x16x32_bf16 v[60:63], a[152:155], v[116:119], v[60:63]
 s_add_u32 m0, s33, 139264
 v_mfma_f32_16x16x32_bf16 v[88:91], a[148:151], v[112:115], v[88:91]
 s_bfe_u32 s28, s4, 262160
 v_mfma_f32_16x16x32_bf16 v[88:91], a[156:159], v[116:119], v[88:91]
 ds_read_b128 v[112:115], v209 offset:22528
 v_mfma_f32_16x16x32_bf16 v[64:67], a[144:147], v[120:123], v[64:67]
 ds_read_b128 v[116:119], v209 offset:23552
 ds_read_b64_tr_b16 a[82:83], v203 offset:2048
 v_mfma_f32_16x16x32_bf16 v[64:67], a[152:155], v[124:127], v[64:67]
 s_mul_i32 s28, s28, 28672
 v_mfma_f32_16x16x32_bf16 v[92:95], a[148:151], v[120:123], v[92:95]
 ds_read_b64_tr_b16 a[84:85], v204 offset:0
 v_mfma_f32_16x16x32_bf16 v[92:95], a[156:159], v[124:127], v[92:95]
 ds_read_b128 v[120:123], v209 offset:24576
 v_mfma_f32_16x16x32_bf16 v[68:71], a[144:147], v[128:131], v[68:71]
 ds_read_b128 v[124:127], v209 offset:25600
 ds_read_b64_tr_b16 a[86:87], v204 offset:2048
 v_mfma_f32_16x16x32_bf16 v[68:71], a[152:155], v[132:135], v[68:71]
 buffer_load_dwordx4 v192, s[20:23], s28 offen sc1 lds
 v_mfma_f32_16x16x32_bf16 v[96:99], a[148:151], v[128:131], v[96:99]
 ds_read_b64_tr_b16 a[88:89], v203 offset:8192
 v_mfma_f32_16x16x32_bf16 v[96:99], a[156:159], v[132:135], v[96:99]
 ds_read_b128 v[128:131], v209 offset:26624
 v_mfma_f32_16x16x32_bf16 v[72:75], a[144:147], v[136:139], v[72:75]
 ds_read_b128 v[132:135], v209 offset:27648
 v_mfma_f32_16x16x32_bf16 v[72:75], a[152:155], v[140:143], v[72:75]
 buffer_load_dwordx4 v192, s[20:23], s28 offen offset:1024 sc1 lds
 v_mfma_f32_16x16x32_bf16 v[100:103], a[148:151], v[136:139], v[100:103]
 ds_read_b64_tr_b16 a[90:91], v203 offset:10240
 v_mfma_f32_16x16x32_bf16 v[100:103], a[156:159], v[140:143], v[100:103]
 ds_read_b128 v[136:139], v209 offset:28672
 ds_read_b64_tr_b16 a[92:93], v204 offset:8192
 v_mfma_f32_16x16x32_bf16 v[76:79], a[144:147], v[144:147], v[76:79]
 ds_read_b128 v[140:143], v209 offset:29696
 v_mfma_f32_16x16x32_bf16 v[76:79], a[152:155], v[148:151], v[76:79]
 ds_read_b64_tr_b16 a[94:95], v204 offset:10240
 v_mfma_f32_16x16x32_bf16 v[104:107], a[148:151], v[144:147], v[104:107]
 buffer_load_dwordx4 v193, s[20:23], s28 offen offset:2048 sc1 lds
 v_mfma_f32_16x16x32_bf16 v[104:107], a[156:159], v[148:151], v[104:107]
 v_mfma_f32_16x16x32_bf16 v[80:83], a[144:147], v[152:155], v[80:83]
 v_mfma_f32_16x16x32_bf16 v[80:83], a[152:155], v[156:159], v[80:83]
 buffer_load_dwordx4 v193, s[20:23], s28 offen offset:3072 sc1 lds
 v_mfma_f32_16x16x32_bf16 v[108:111], a[148:151], v[152:155], v[108:111]
 v_mfma_f32_16x16x32_bf16 v[108:111], a[156:159], v[156:159], v[108:111]
 s_waitcnt vmcnt(24) lgkmcnt(0)
 s_barrier
 v_mfma_f32_16x16x32_bf16 v[0:3], a[80:83], v[160:163], v[0:3]
 ds_read_b128 v[144:147], v209 offset:32768
 ds_read_b128 v[148:151], v209 offset:33792
 v_mfma_f32_16x16x32_bf16 v[0:3], a[88:91], v[164:167], v[0:3]
 ds_read_b128 v[152:155], v209 offset:34816
 s_add_u32 m0, s33, 90112
 v_mfma_f32_16x16x32_bf16 v[28:31], a[84:87], v[160:163], v[28:31]
 ds_read_b128 v[156:159], v209 offset:35840
 v_mfma_f32_16x16x32_bf16 v[28:31], a[92:95], v[164:167], v[28:31]
 ds_read_b128 v[160:163], v209 offset:36864
 s_bfe_u32 s28, s4, 262164
 v_mfma_f32_16x16x32_bf16 v[4:7], a[80:83], v[168:171], v[4:7]
 ds_read_b128 v[164:167], v209 offset:37888
 v_mfma_f32_16x16x32_bf16 v[4:7], a[88:91], v[172:175], v[4:7]
 s_mul_i32 s28, s28, 28672
 v_mfma_f32_16x16x32_bf16 v[32:35], a[84:87], v[168:171], v[32:35]
 buffer_load_dwordx4 v192, s[20:23], s28 offen sc1 lds
 v_mfma_f32_16x16x32_bf16 v[32:35], a[92:95], v[172:175], v[32:35]
 ds_read_b128 v[168:171], v209 offset:38912
 v_mfma_f32_16x16x32_bf16 v[8:11], a[80:83], v[176:179], v[8:11]
 ds_read_b128 v[172:175], v209 offset:39936
 v_mfma_f32_16x16x32_bf16 v[8:11], a[88:91], v[180:183], v[8:11]
 buffer_load_dwordx4 v192, s[20:23], s28 offen offset:1024 sc1 lds
 v_mfma_f32_16x16x32_bf16 v[36:39], a[84:87], v[176:179], v[36:39]
 v_mfma_f32_16x16x32_bf16 v[36:39], a[92:95], v[180:183], v[36:39]
 ds_read_b128 v[176:179], v209 offset:40960
 buffer_load_dwordx4 v193, s[20:23], s28 offen offset:2048 sc1 lds
 v_mfma_f32_16x16x32_bf16 v[12:15], a[80:83], v[112:115], v[12:15]
 ds_read_b128 v[180:183], v209 offset:41984
 v_mfma_f32_16x16x32_bf16 v[12:15], a[88:91], v[116:119], v[12:15]
 v_mfma_f32_16x16x32_bf16 v[40:43], a[84:87], v[112:115], v[40:43]
 buffer_load_dwordx4 v193, s[20:23], s28 offen offset:3072 sc1 lds
 v_mfma_f32_16x16x32_bf16 v[40:43], a[92:95], v[116:119], v[40:43]
 ds_read_b128 v[112:115], v209 offset:43008
 v_mfma_f32_16x16x32_bf16 v[16:19], a[80:83], v[120:123], v[16:19]
 ds_read_b128 v[116:119], v209 offset:44032
 s_add_u32 m0, s33, 0
 v_mfma_f32_16x16x32_bf16 v[16:19], a[88:91], v[124:127], v[16:19]
 s_bfe_u32 s28, s4, 262168
 v_mfma_f32_16x16x32_bf16 v[44:47], a[84:87], v[120:123], v[44:47]
 s_mul_i32 s28, s28, 28672
 v_mfma_f32_16x16x32_bf16 v[44:47], a[92:95], v[124:127], v[44:47]
 ds_read_b128 v[120:123], v209 offset:45056
 buffer_load_dwordx4 v192, s[20:23], s28 offen sc1 lds
 v_mfma_f32_16x16x32_bf16 v[20:23], a[80:83], v[128:131], v[20:23]
 ds_read_b128 v[124:127], v209 offset:46080
 v_mfma_f32_16x16x32_bf16 v[20:23], a[88:91], v[132:135], v[20:23]
 v_mfma_f32_16x16x32_bf16 v[48:51], a[84:87], v[128:131], v[48:51]
 buffer_load_dwordx4 v192, s[20:23], s28 offen offset:1024 sc1 lds
 v_mfma_f32_16x16x32_bf16 v[48:51], a[92:95], v[132:135], v[48:51]
 v_mfma_f32_16x16x32_bf16 v[24:27], a[80:83], v[136:139], v[24:27]
 buffer_load_dwordx4 v193, s[20:23], s28 offen offset:2048 sc1 lds
 v_mfma_f32_16x16x32_bf16 v[24:27], a[88:91], v[140:143], v[24:27]
 v_mfma_f32_16x16x32_bf16 v[52:55], a[84:87], v[136:139], v[52:55]
 buffer_load_dwordx4 v193, s[20:23], s28 offen offset:3072 sc1 lds
 v_mfma_f32_16x16x32_bf16 v[52:55], a[92:95], v[140:143], v[52:55]
 s_waitcnt vmcnt(24) lgkmcnt(0)
 s_barrier
 v_mfma_f32_16x16x32_bf16 v[56:59], a[160:163], v[144:147], v[56:59]
 ds_read_b128 v[128:131], v209 offset:0
 ds_read_b128 v[132:135], v209 offset:1024
 v_mfma_f32_16x16x32_bf16 v[56:59], a[168:171], v[148:151], v[56:59]
 ds_read_b128 v[136:139], v209 offset:2048
 v_mfma_f32_16x16x32_bf16 v[84:87], a[164:167], v[144:147], v[84:87]
 ds_read_b128 v[140:143], v209 offset:3072
 v_mfma_f32_16x16x32_bf16 v[84:87], a[172:175], v[148:151], v[84:87]
 ds_read_b128 v[144:147], v209 offset:4096
 ds_read_b64_tr_b16 a[96:97], v203 offset:49152
 v_mfma_f32_16x16x32_bf16 v[60:63], a[160:163], v[152:155], v[60:63]
 ds_read_b128 v[148:151], v209 offset:5120
 v_mfma_f32_16x16x32_bf16 v[60:63], a[168:171], v[156:159], v[60:63]
 s_add_u32 m0, s33, 106496
 v_mfma_f32_16x16x32_bf16 v[88:91], a[164:167], v[152:155], v[88:91]
 s_bfe_u32 s28, s4, 262172
 v_mfma_f32_16x16x32_bf16 v[88:91], a[172:175], v[156:159], v[88:91]
 ds_read_b128 v[152:155], v209 offset:6144
 v_mfma_f32_16x16x32_bf16 v[64:67], a[160:163], v[160:163], v[64:67]
 ds_read_b128 v[156:159], v209 offset:7168
 ds_read_b64_tr_b16 a[98:99], v203 offset:51200
 v_mfma_f32_16x16x32_bf16 v[64:67], a[168:171], v[164:167], v[64:67]
 s_mul_i32 s28, s28, 28672
 v_mfma_f32_16x16x32_bf16 v[92:95], a[164:167], v[160:163], v[92:95]
 ds_read_b64_tr_b16 a[100:101], v204 offset:49152
 v_mfma_f32_16x16x32_bf16 v[92:95], a[172:175], v[164:167], v[92:95]
 ds_read_b128 v[160:163], v209 offset:8192
 v_mfma_f32_16x16x32_bf16 v[68:71], a[160:163], v[168:171], v[68:71]
 ds_read_b128 v[164:167], v209 offset:9216
 ds_read_b64_tr_b16 a[102:103], v204 offset:51200
 v_mfma_f32_16x16x32_bf16 v[68:71], a[168:171], v[172:175], v[68:71]
 buffer_load_dwordx4 v192, s[20:23], s28 offen sc1 lds
 v_mfma_f32_16x16x32_bf16 v[96:99], a[164:167], v[168:171], v[96:99]
 ds_read_b64_tr_b16 a[104:105], v203 offset:57344
 v_mfma_f32_16x16x32_bf16 v[96:99], a[172:175], v[172:175], v[96:99]
 ds_read_b128 v[168:171], v209 offset:10240
 v_mfma_f32_16x16x32_bf16 v[72:75], a[160:163], v[176:179], v[72:75]
 ds_read_b128 v[172:175], v209 offset:11264
 v_mfma_f32_16x16x32_bf16 v[72:75], a[168:171], v[180:183], v[72:75]
 buffer_load_dwordx4 v192, s[20:23], s28 offen offset:1024 sc1 lds
 v_mfma_f32_16x16x32_bf16 v[100:103], a[164:167], v[176:179], v[100:103]
 ds_read_b64_tr_b16 a[106:107], v203 offset:59392
 v_mfma_f32_16x16x32_bf16 v[100:103], a[172:175], v[180:183], v[100:103]
 ds_read_b128 v[176:179], v209 offset:12288
 ds_read_b64_tr_b16 a[108:109], v204 offset:57344
 v_mfma_f32_16x16x32_bf16 v[76:79], a[160:163], v[112:115], v[76:79]
 ds_read_b128 v[180:183], v209 offset:13312
 v_mfma_f32_16x16x32_bf16 v[76:79], a[168:171], v[116:119], v[76:79]
 ds_read_b64_tr_b16 a[110:111], v204 offset:59392
 v_mfma_f32_16x16x32_bf16 v[104:107], a[164:167], v[112:115], v[104:107]
 buffer_load_dwordx4 v193, s[20:23], s28 offen offset:2048 sc1 lds
 v_mfma_f32_16x16x32_bf16 v[104:107], a[172:175], v[116:119], v[104:107]
 v_mfma_f32_16x16x32_bf16 v[80:83], a[160:163], v[120:123], v[80:83]
 v_mfma_f32_16x16x32_bf16 v[80:83], a[168:171], v[124:127], v[80:83]
 buffer_load_dwordx4 v193, s[20:23], s28 offen offset:3072 sc1 lds
 v_mfma_f32_16x16x32_bf16 v[108:111], a[164:167], v[120:123], v[108:111]
 v_mfma_f32_16x16x32_bf16 v[108:111], a[172:175], v[124:127], v[108:111]
 s_waitcnt vmcnt(24) lgkmcnt(0)
 s_barrier
 v_mfma_f32_16x16x32_bf16 v[0:3], a[96:99], v[128:131], v[0:3]
 ds_read_b128 v[112:115], v194 offset:16384
 ds_read_b128 v[116:119], v194 offset:17408
 v_mfma_f32_16x16x32_bf16 v[0:3], a[104:107], v[132:135], v[0:3]
 ds_read_b128 v[120:123], v194 offset:18432
 s_add_u32 m0, s33, 73728
 v_mfma_f32_16x16x32_bf16 v[28:31], a[100:103], v[128:131], v[28:31]
 ds_read_b128 v[124:127], v194 offset:19456
 v_mfma_f32_16x16x32_bf16 v[28:31], a[108:111], v[132:135], v[28:31]
 ds_read_b128 v[128:131], v194 offset:20480
 s_bfe_u32 s28, s5, 262144
 v_mfma_f32_16x16x32_bf16 v[4:7], a[96:99], v[136:139], v[4:7]
 ds_read_b128 v[132:135], v194 offset:21504
 v_mfma_f32_16x16x32_bf16 v[4:7], a[104:107], v[140:143], v[4:7]
 s_mul_i32 s28, s28, 28672
 v_mfma_f32_16x16x32_bf16 v[32:35], a[100:103], v[136:139], v[32:35]
 buffer_load_dwordx4 v192, s[20:23], s28 offen sc1 lds
 v_mfma_f32_16x16x32_bf16 v[32:35], a[108:111], v[140:143], v[32:35]
 ds_read_b128 v[136:139], v194 offset:22528
 v_mfma_f32_16x16x32_bf16 v[8:11], a[96:99], v[144:147], v[8:11]
 ds_read_b128 v[140:143], v194 offset:23552
 v_mfma_f32_16x16x32_bf16 v[8:11], a[104:107], v[148:151], v[8:11]
 buffer_load_dwordx4 v192, s[20:23], s28 offen offset:1024 sc1 lds
 v_mfma_f32_16x16x32_bf16 v[36:39], a[100:103], v[144:147], v[36:39]
 v_mfma_f32_16x16x32_bf16 v[36:39], a[108:111], v[148:151], v[36:39]
 ds_read_b128 v[144:147], v194 offset:24576
 buffer_load_dwordx4 v193, s[20:23], s28 offen offset:2048 sc1 lds
 v_mfma_f32_16x16x32_bf16 v[12:15], a[96:99], v[152:155], v[12:15]
 ds_read_b128 v[148:151], v194 offset:25600
 v_mfma_f32_16x16x32_bf16 v[12:15], a[104:107], v[156:159], v[12:15]
 v_mfma_f32_16x16x32_bf16 v[40:43], a[100:103], v[152:155], v[40:43]
 buffer_load_dwordx4 v193, s[20:23], s28 offen offset:3072 sc1 lds
 v_mfma_f32_16x16x32_bf16 v[40:43], a[108:111], v[156:159], v[40:43]
 ds_read_b128 v[152:155], v194 offset:26624
 v_mfma_f32_16x16x32_bf16 v[16:19], a[96:99], v[160:163], v[16:19]
 ds_read_b128 v[156:159], v194 offset:27648
 s_add_u32 m0, s33, 49152
 v_mfma_f32_16x16x32_bf16 v[16:19], a[104:107], v[164:167], v[16:19]
 s_bfe_u32 s28, s5, 262148
 v_mfma_f32_16x16x32_bf16 v[44:47], a[100:103], v[160:163], v[44:47]
 s_mul_i32 s28, s28, 28672
 v_mfma_f32_16x16x32_bf16 v[44:47], a[108:111], v[164:167], v[44:47]
 ds_read_b128 v[160:163], v194 offset:28672
 buffer_load_dwordx4 v192, s[20:23], s28 offen sc1 lds
 v_mfma_f32_16x16x32_bf16 v[20:23], a[96:99], v[168:171], v[20:23]
 ds_read_b128 v[164:167], v194 offset:29696
 v_mfma_f32_16x16x32_bf16 v[20:23], a[104:107], v[172:175], v[20:23]
 v_mfma_f32_16x16x32_bf16 v[48:51], a[100:103], v[168:171], v[48:51]
 buffer_load_dwordx4 v192, s[20:23], s28 offen offset:1024 sc1 lds
 v_mfma_f32_16x16x32_bf16 v[48:51], a[108:111], v[172:175], v[48:51]
 v_mfma_f32_16x16x32_bf16 v[24:27], a[96:99], v[176:179], v[24:27]
 buffer_load_dwordx4 v193, s[20:23], s28 offen offset:2048 sc1 lds
 v_mfma_f32_16x16x32_bf16 v[24:27], a[104:107], v[180:183], v[24:27]
 v_mfma_f32_16x16x32_bf16 v[52:55], a[100:103], v[176:179], v[52:55]
 buffer_load_dwordx4 v193, s[20:23], s28 offen offset:3072 sc1 lds
 v_mfma_f32_16x16x32_bf16 v[52:55], a[108:111], v[180:183], v[52:55]
 s_waitcnt vmcnt(24) lgkmcnt(0)
 s_barrier
 v_mfma_f32_16x16x32_bf16 v[56:59], a[176:179], v[112:115], v[56:59]
 ds_read_b128 v[168:171], v209 offset:49152
 ds_read_b128 v[172:175], v209 offset:50176
 v_mfma_f32_16x16x32_bf16 v[56:59], a[184:187], v[116:119], v[56:59]
 ds_read_b128 v[176:179], v209 offset:51200
 v_mfma_f32_16x16x32_bf16 v[84:87], a[180:183], v[112:115], v[84:87]
 ds_read_b128 v[180:183], v209 offset:52224
 v_mfma_f32_16x16x32_bf16 v[84:87], a[188:191], v[116:119], v[84:87]
 ds_read_b128 v[112:115], v209 offset:53248
 ds_read_b64_tr_b16 a[112:113], v203 offset:32768
 v_mfma_f32_16x16x32_bf16 v[60:63], a[176:179], v[120:123], v[60:63]
 ds_read_b128 v[116:119], v209 offset:54272
 v_mfma_f32_16x16x32_bf16 v[60:63], a[184:187], v[124:127], v[60:63]
 s_add_u32 m0, s33, 16384
 v_mfma_f32_16x16x32_bf16 v[88:91], a[180:183], v[120:123], v[88:91]
 s_bfe_u32 s28, s5, 262152
 v_mfma_f32_16x16x32_bf16 v[88:91], a[188:191], v[124:127], v[88:91]
 ds_read_b128 v[120:123], v209 offset:55296
 v_mfma_f32_16x16x32_bf16 v[64:67], a[176:179], v[128:131], v[64:67]
 ds_read_b128 v[124:127], v209 offset:56320
 ds_read_b64_tr_b16 a[114:115], v203 offset:34816
 v_mfma_f32_16x16x32_bf16 v[64:67], a[184:187], v[132:135], v[64:67]
 s_mul_i32 s28, s28, 28672
 v_mfma_f32_16x16x32_bf16 v[92:95], a[180:183], v[128:131], v[92:95]
 ds_read_b64_tr_b16 a[116:117], v204 offset:32768
 v_mfma_f32_16x16x32_bf16 v[92:95], a[188:191], v[132:135], v[92:95]
 ds_read_b128 v[128:131], v209 offset:57344
 v_mfma_f32_16x16x32_bf16 v[68:71], a[176:179], v[136:139], v[68:71]
 ds_read_b128 v[132:135], v209 offset:58368
 ds_read_b64_tr_b16 a[118:119], v204 offset:34816
 v_mfma_f32_16x16x32_bf16 v[68:71], a[184:187], v[140:143], v[68:71]
 buffer_load_dwordx4 v192, s[20:23], s28 offen sc1 lds
 v_mfma_f32_16x16x32_bf16 v[96:99], a[180:183], v[136:139], v[96:99]
 ds_read_b64_tr_b16 a[120:121], v203 offset:40960
 v_mfma_f32_16x16x32_bf16 v[96:99], a[188:191], v[140:143], v[96:99]
 ds_read_b128 v[136:139], v209 offset:59392
 v_mfma_f32_16x16x32_bf16 v[72:75], a[176:179], v[144:147], v[72:75]
 ds_read_b128 v[140:143], v209 offset:60416
 v_mfma_f32_16x16x32_bf16 v[72:75], a[184:187], v[148:151], v[72:75]
 buffer_load_dwordx4 v192, s[20:23], s28 offen offset:1024 sc1 lds
 v_mfma_f32_16x16x32_bf16 v[100:103], a[180:183], v[144:147], v[100:103]
 ds_read_b64_tr_b16 a[122:123], v203 offset:43008
 v_mfma_f32_16x16x32_bf16 v[100:103], a[188:191], v[148:151], v[100:103]
 ds_read_b128 v[144:147], v209 offset:61440
 ds_read_b64_tr_b16 a[124:125], v204 offset:40960
 v_mfma_f32_16x16x32_bf16 v[76:79], a[176:179], v[152:155], v[76:79]
 ds_read_b128 v[148:151], v209 offset:62464
 v_mfma_f32_16x16x32_bf16 v[76:79], a[184:187], v[156:159], v[76:79]
 ds_read_b64_tr_b16 a[126:127], v204 offset:43008
 v_mfma_f32_16x16x32_bf16 v[104:107], a[180:183], v[152:155], v[104:107]
 buffer_load_dwordx4 v193, s[20:23], s28 offen offset:2048 sc1 lds
 v_mfma_f32_16x16x32_bf16 v[104:107], a[188:191], v[156:159], v[104:107]
 v_mfma_f32_16x16x32_bf16 v[80:83], a[176:179], v[160:163], v[80:83]
 v_mfma_f32_16x16x32_bf16 v[80:83], a[184:187], v[164:167], v[80:83]
 buffer_load_dwordx4 v193, s[20:23], s28 offen offset:3072 sc1 lds
 v_mfma_f32_16x16x32_bf16 v[108:111], a[180:183], v[160:163], v[108:111]
 v_mfma_f32_16x16x32_bf16 v[108:111], a[188:191], v[164:167], v[108:111]
 s_waitcnt vmcnt(24) lgkmcnt(0)
 s_barrier
 v_mfma_f32_16x16x32_bf16 v[0:3], a[112:115], v[168:171], v[0:3]
 ds_read_b128 v[152:155], v210 offset:0
 ds_read_b128 v[156:159], v210 offset:1024
 v_mfma_f32_16x16x32_bf16 v[0:3], a[120:123], v[172:175], v[0:3]
 ds_read_b128 v[160:163], v210 offset:2048
 s_add_u32 m0, s33, 122880
 v_mfma_f32_16x16x32_bf16 v[28:31], a[116:119], v[168:171], v[28:31]
 ds_read_b128 v[164:167], v210 offset:3072
 v_mfma_f32_16x16x32_bf16 v[28:31], a[124:127], v[172:175], v[28:31]
 ds_read_b128 v[168:171], v210 offset:4096
 s_bfe_u32 s28, s5, 262156
 v_mfma_f32_16x16x32_bf16 v[4:7], a[112:115], v[176:179], v[4:7]
 ds_read_b128 v[172:175], v210 offset:5120
 v_mfma_f32_16x16x32_bf16 v[4:7], a[120:123], v[180:183], v[4:7]
 s_mul_i32 s28, s28, 28672
 v_mfma_f32_16x16x32_bf16 v[32:35], a[116:119], v[176:179], v[32:35]
 buffer_load_dwordx4 v192, s[20:23], s28 offen sc1 lds
 v_mfma_f32_16x16x32_bf16 v[32:35], a[124:127], v[180:183], v[32:35]
 ds_read_b128 v[176:179], v210 offset:6144
 v_mfma_f32_16x16x32_bf16 v[8:11], a[112:115], v[112:115], v[8:11]
 ds_read_b128 v[180:183], v210 offset:7168
 v_mfma_f32_16x16x32_bf16 v[8:11], a[120:123], v[116:119], v[8:11]
 buffer_load_dwordx4 v192, s[20:23], s28 offen offset:1024 sc1 lds
 v_mfma_f32_16x16x32_bf16 v[36:39], a[116:119], v[112:115], v[36:39]
 v_mfma_f32_16x16x32_bf16 v[36:39], a[124:127], v[116:119], v[36:39]
 ds_read_b128 v[112:115], v210 offset:8192
 buffer_load_dwordx4 v193, s[20:23], s28 offen offset:2048 sc1 lds
 v_mfma_f32_16x16x32_bf16 v[12:15], a[112:115], v[120:123], v[12:15]
 ds_read_b128 v[116:119], v210 offset:9216
 v_mfma_f32_16x16x32_bf16 v[12:15], a[120:123], v[124:127], v[12:15]
 v_mfma_f32_16x16x32_bf16 v[40:43], a[116:119], v[120:123], v[40:43]
 buffer_load_dwordx4 v193, s[20:23], s28 offen offset:3072 sc1 lds
 v_mfma_f32_16x16x32_bf16 v[40:43], a[124:127], v[124:127], v[40:43]
 ds_read_b128 v[120:123], v210 offset:10240
 v_mfma_f32_16x16x32_bf16 v[16:19], a[112:115], v[128:131], v[16:19]
 ds_read_b128 v[124:127], v210 offset:11264
 s_add_u32 m0, s33, 32768
 v_mfma_f32_16x16x32_bf16 v[16:19], a[120:123], v[132:135], v[16:19]
 s_bfe_u32 s28, s5, 262160
 v_mfma_f32_16x16x32_bf16 v[44:47], a[116:119], v[128:131], v[44:47]
 s_mul_i32 s28, s28, 28672
 v_mfma_f32_16x16x32_bf16 v[44:47], a[124:127], v[132:135], v[44:47]
 ds_read_b128 v[128:131], v210 offset:12288
 buffer_load_dwordx4 v192, s[20:23], s28 offen sc1 lds
 v_mfma_f32_16x16x32_bf16 v[20:23], a[112:115], v[136:139], v[20:23]
 ds_read_b128 v[132:135], v210 offset:13312
 v_mfma_f32_16x16x32_bf16 v[20:23], a[120:123], v[140:143], v[20:23]
 v_mfma_f32_16x16x32_bf16 v[48:51], a[116:119], v[136:139], v[48:51]
 buffer_load_dwordx4 v192, s[20:23], s28 offen offset:1024 sc1 lds
 v_mfma_f32_16x16x32_bf16 v[48:51], a[124:127], v[140:143], v[48:51]
 v_mfma_f32_16x16x32_bf16 v[24:27], a[112:115], v[144:147], v[24:27]
 buffer_load_dwordx4 v193, s[20:23], s28 offen offset:2048 sc1 lds
 v_mfma_f32_16x16x32_bf16 v[24:27], a[120:123], v[148:151], v[24:27]
 v_mfma_f32_16x16x32_bf16 v[52:55], a[116:119], v[144:147], v[52:55]
 buffer_load_dwordx4 v193, s[20:23], s28 offen offset:3072 sc1 lds
 v_mfma_f32_16x16x32_bf16 v[52:55], a[124:127], v[148:151], v[52:55]
 s_waitcnt vmcnt(28) lgkmcnt(0)
 s_barrier
 v_mfma_f32_16x16x32_bf16 v[56:59], a[192:195], v[152:155], v[56:59]
 ds_read_b128 v[136:139], v209 offset:16384
 ds_read_b128 v[140:143], v209 offset:17408
 v_mfma_f32_16x16x32_bf16 v[56:59], a[200:203], v[156:159], v[56:59]
 ds_read_b128 v[144:147], v209 offset:18432
 v_mfma_f32_16x16x32_bf16 v[84:87], a[196:199], v[152:155], v[84:87]
 ds_read_b128 v[148:151], v209 offset:19456
 v_mfma_f32_16x16x32_bf16 v[84:87], a[204:207], v[156:159], v[84:87]
 ds_read_b128 v[152:155], v209 offset:20480
 s_add_u32 m0, s33, 139264
 s_bfe_u32 s28, s5, 262164
 v_mfma_f32_16x16x32_bf16 v[60:63], a[192:195], v[160:163], v[60:63]
 ds_read_b128 v[156:159], v209 offset:21504
 s_mul_i32 s28, s28, 28672
 buffer_load_dwordx4 v192, s[20:23], s28 offen sc1 lds
 v_mfma_f32_16x16x32_bf16 v[60:63], a[200:203], v[164:167], v[60:63]
 buffer_load_dwordx4 v192, s[20:23], s28 offen offset:1024 sc1 lds
 v_mfma_f32_16x16x32_bf16 v[88:91], a[196:199], v[160:163], v[88:91]
 buffer_load_dwordx4 v193, s[20:23], s28 offen offset:2048 sc1 lds
 v_mfma_f32_16x16x32_bf16 v[88:91], a[204:207], v[164:167], v[88:91]
 ds_read_b128 v[160:163], v209 offset:22528
 v_mfma_f32_16x16x32_bf16 v[64:67], a[192:195], v[168:171], v[64:67]
 ds_read_b128 v[164:167], v209 offset:23552
 buffer_load_dwordx4 v193, s[20:23], s28 offen offset:3072 sc1 lds
 v_cvt_pk_bf16_f32 v28, v28, v29
 v_mfma_f32_16x16x32_bf16 v[64:67], a[200:203], v[172:175], v[64:67]
 v_cvt_pk_bf16_f32 v29, v30, v31
 v_cvt_pk_bf16_f32 v30, v32, v33
 v_cvt_pk_bf16_f32 v31, v34, v35
 v_mfma_f32_16x16x32_bf16 v[92:95], a[196:199], v[168:171], v[92:95]
 buffer_store_dwordx4 v[28:31], v250, s[44:47], s57 offen offset:0 sc1
 v_mfma_f32_16x16x32_bf16 v[92:95], a[204:207], v[172:175], v[92:95]
 ds_read_b128 v[168:171], v209 offset:24576
 v_cvt_pk_bf16_f32 v36, v36, v37
 v_cvt_pk_bf16_f32 v37, v38, v39
 v_cvt_pk_bf16_f32 v38, v40, v41
 v_mfma_f32_16x16x32_bf16 v[68:71], a[192:195], v[176:179], v[68:71]
 ds_read_b128 v[172:175], v209 offset:25600
 v_cvt_pk_bf16_f32 v39, v42, v43
 v_mfma_f32_16x16x32_bf16 v[68:71], a[200:203], v[180:183], v[68:71]
 buffer_store_dwordx4 v[36:39], v250, s[44:47], s57 offen offset:1024 sc1
 v_cvt_pk_bf16_f32 v44, v44, v45
 v_mfma_f32_16x16x32_bf16 v[96:99], a[196:199], v[176:179], v[96:99]
 v_cvt_pk_bf16_f32 v45, v46, v47
 v_cvt_pk_bf16_f32 v46, v48, v49
 v_cvt_pk_bf16_f32 v47, v50, v51
 v_mfma_f32_16x16x32_bf16 v[96:99], a[204:207], v[180:183], v[96:99]
 ds_read_b128 v[176:179], v209 offset:26624
 buffer_store_dwordx4 v[44:47], v250, s[44:47], s57 offen offset:2048 sc1
 v_mfma_f32_16x16x32_bf16 v[72:75], a[192:195], v[112:115], v[72:75]
 ds_read_b128 v[180:183], v209 offset:27648
 v_cvt_pk_bf16_f32 v52, v52, v53
 v_cvt_pk_bf16_f32 v53, v54, v55
 v_mfma_f32_16x16x32_bf16 v[72:75], a[200:203], v[116:119], v[72:75]
 buffer_store_dwordx2 v[52:53], v251, s[44:47], s57 offen offset:0 sc1
 v_mfma_f32_16x16x32_bf16 v[100:103], a[196:199], v[112:115], v[100:103]
 v_cvt_pk_bf16_f32 v32, v0, v1
 v_cvt_pk_bf16_f32 v33, v2, v3
 v_cvt_pk_bf16_f32 v34, v4, v5
 v_cvt_pk_bf16_f32 v35, v6, v7
 v_mfma_f32_16x16x32_bf16 v[100:103], a[204:207], v[116:119], v[100:103]
 ds_read_b128 v[112:115], v209 offset:28672
 buffer_store_dwordx4 v[32:35], v252, s[44:47], s56 offen offset:0 sc1
 v_mfma_f32_16x16x32_bf16 v[76:79], a[192:195], v[120:123], v[76:79]
 ds_read_b128 v[116:119], v209 offset:29696
 v_cvt_pk_bf16_f32 v40, v8, v9
 v_mfma_f32_16x16x32_bf16 v[76:79], a[200:203], v[124:127], v[76:79]
 v_cvt_pk_bf16_f32 v41, v10, v11
 v_cvt_pk_bf16_f32 v42, v12, v13
 v_cvt_pk_bf16_f32 v43, v14, v15
 v_mfma_f32_16x16x32_bf16 v[104:107], a[196:199], v[120:123], v[104:107]
 buffer_store_dwordx4 v[40:43], v252, s[44:47], s56 offen offset:1024 sc1
 v_cvt_pk_bf16_f32 v48, v16, v17
 v_mfma_f32_16x16x32_bf16 v[104:107], a[204:207], v[124:127], v[104:107]
 v_cvt_pk_bf16_f32 v49, v18, v19
 v_cvt_pk_bf16_f32 v50, v20, v21
 v_cvt_pk_bf16_f32 v51, v22, v23
 v_mfma_f32_16x16x32_bf16 v[80:83], a[192:195], v[128:131], v[80:83]
 buffer_store_dwordx4 v[48:51], v252, s[44:47], s56 offen offset:2048 sc1
 v_mfma_f32_16x16x32_bf16 v[80:83], a[200:203], v[132:135], v[80:83]
 v_cvt_pk_bf16_f32 v54, v24, v25
 v_cvt_pk_bf16_f32 v55, v26, v27
 buffer_store_dwordx2 v[54:55], v253, s[44:47], s56 offen offset:0 sc1
 v_mfma_f32_16x16x32_bf16 v[108:111], a[196:199], v[128:131], v[108:111]
 s_add_u32 s56, s56, 86016
 s_add_u32 s57, s57, 86016
 v_mfma_f32_16x16x32_bf16 v[108:111], a[204:207], v[132:135], v[108:111]
 s_waitcnt vmcnt(36) lgkmcnt(0)
 s_barrier
 v_mfma_f32_16x16x32_bf16 v[56:59], a[208:211], v[136:139], v[56:59]
 ds_read_b128 v[120:123], v194 offset:0
 ds_read_b128 v[124:127], v194 offset:1024
 v_mfma_f32_16x16x32_bf16 v[56:59], a[216:219], v[140:143], v[56:59]
 ds_read_b128 v[128:131], v194 offset:2048
 v_mfma_f32_16x16x32_bf16 v[84:87], a[212:215], v[136:139], v[84:87]
 ds_read_b128 v[132:135], v194 offset:3072
 v_mfma_f32_16x16x32_bf16 v[84:87], a[220:223], v[140:143], v[84:87]
 ds_read_b128 v[136:139], v194 offset:4096
 v_mfma_f32_16x16x32_bf16 v[60:63], a[208:211], v[144:147], v[60:63]
 ds_read_b128 v[140:143], v194 offset:5120
 v_mfma_f32_16x16x32_bf16 v[60:63], a[216:219], v[148:151], v[60:63]
 s_add_u32 m0, s33, 90112
 v_mfma_f32_16x16x32_bf16 v[88:91], a[212:215], v[144:147], v[88:91]
 s_bfe_u32 s28, s5, 262168
 v_mfma_f32_16x16x32_bf16 v[88:91], a[220:223], v[148:151], v[88:91]
 ds_read_b128 v[144:147], v194 offset:6144
 v_mfma_f32_16x16x32_bf16 v[64:67], a[208:211], v[152:155], v[64:67]
 ds_read_b128 v[148:151], v194 offset:7168
 v_mfma_f32_16x16x32_bf16 v[64:67], a[216:219], v[156:159], v[64:67]
 s_mul_i32 s28, s28, 28672
 v_mfma_f32_16x16x32_bf16 v[92:95], a[212:215], v[152:155], v[92:95]
 v_mfma_f32_16x16x32_bf16 v[92:95], a[220:223], v[156:159], v[92:95]
 ds_read_b128 v[152:155], v194 offset:8192
 v_mfma_f32_16x16x32_bf16 v[68:71], a[208:211], v[160:163], v[68:71]
 ds_read_b128 v[156:159], v194 offset:9216
 v_mfma_f32_16x16x32_bf16 v[68:71], a[216:219], v[164:167], v[68:71]
 buffer_load_dwordx4 v192, s[20:23], s28 offen sc1 lds
 v_mfma_f32_16x16x32_bf16 v[96:99], a[212:215], v[160:163], v[96:99]
 v_mfma_f32_16x16x32_bf16 v[96:99], a[220:223], v[164:167], v[96:99]
 ds_read_b128 v[160:163], v194 offset:10240
 v_mfma_f32_16x16x32_bf16 v[72:75], a[208:211], v[168:171], v[72:75]
 ds_read_b128 v[164:167], v194 offset:11264
 v_mfma_f32_16x16x32_bf16 v[72:75], a[216:219], v[172:175], v[72:75]
 buffer_load_dwordx4 v192, s[20:23], s28 offen offset:1024 sc1 lds
 v_mfma_f32_16x16x32_bf16 v[100:103], a[212:215], v[168:171], v[100:103]
 v_mfma_f32_16x16x32_bf16 v[100:103], a[220:223], v[172:175], v[100:103]
 ds_read_b128 v[168:171], v194 offset:12288
 v_mfma_f32_16x16x32_bf16 v[76:79], a[208:211], v[176:179], v[76:79]
 ds_read_b128 v[172:175], v194 offset:13312
 v_mfma_f32_16x16x32_bf16 v[76:79], a[216:219], v[180:183], v[76:79]
 v_mfma_f32_16x16x32_bf16 v[104:107], a[212:215], v[176:179], v[104:107]
 buffer_load_dwordx4 v193, s[20:23], s28 offen offset:2048 sc1 lds
 v_mfma_f32_16x16x32_bf16 v[104:107], a[220:223], v[180:183], v[104:107]
 v_mfma_f32_16x16x32_bf16 v[80:83], a[208:211], v[112:115], v[80:83]
 v_mfma_f32_16x16x32_bf16 v[80:83], a[216:219], v[116:119], v[80:83]
 buffer_load_dwordx4 v193, s[20:23], s28 offen offset:3072 sc1 lds
 v_mfma_f32_16x16x32_bf16 v[108:111], a[212:215], v[112:115], v[108:111]
 v_mfma_f32_16x16x32_bf16 v[108:111], a[220:223], v[116:119], v[108:111]
 s_waitcnt vmcnt(36) lgkmcnt(0)
 s_barrier
 v_mfma_f32_16x16x32_bf16 v[56:59], a[224:227], v[120:123], v[56:59]
 ds_read_b128 v[176:179], v209 offset:32768
 ds_read_b128 v[180:183], v209 offset:33792
 v_mfma_f32_16x16x32_bf16 v[56:59], a[232:235], v[124:127], v[56:59]
 ds_read_b128 v[112:115], v209 offset:34816
 s_add_u32 m0, s33, 0
 s_bfe_u32 s28, s5, 262172
 v_mfma_f32_16x16x32_bf16 v[84:87], a[228:231], v[120:123], v[84:87]
 ds_read_b128 v[116:119], v209 offset:35840
 s_mul_i32 s28, s28, 28672
 v_mfma_f32_16x16x32_bf16 v[84:87], a[236:239], v[124:127], v[84:87]
 ds_read_b128 v[120:123], v209 offset:36864
 buffer_load_dwordx4 v192, s[20:23], s28 offen sc1 lds
 v_mfma_f32_16x16x32_bf16 v[60:63], a[224:227], v[128:131], v[60:63]
 ds_read_b128 v[124:127], v209 offset:37888
 v_mfma_f32_16x16x32_bf16 v[60:63], a[232:235], v[132:135], v[60:63]
 buffer_load_dwordx4 v192, s[20:23], s28 offen offset:1024 sc1 lds
 v_mfma_f32_16x16x32_bf16 v[88:91], a[228:231], v[128:131], v[88:91]
 buffer_load_dwordx4 v193, s[20:23], s28 offen offset:2048 sc1 lds
 v_mfma_f32_16x16x32_bf16 v[88:91], a[236:239], v[132:135], v[88:91]
 ds_read_b128 v[128:131], v209 offset:38912
 buffer_load_dwordx4 v193, s[20:23], s28 offen offset:3072 sc1 lds
 v_mfma_f32_16x16x32_bf16 v[64:67], a[224:227], v[136:139], v[64:67]
 ds_read_b128 v[132:135], v209 offset:39936
 v_mov_b32 v220, -1
 v_mfma_f32_16x16x32_bf16 v[64:67], a[232:235], v[140:143], v[64:67]
 v_mov_b32 v221, -1
 v_mov_b32 v222, -1
 v_mov_b32 v223, -1
 v_mfma_f32_16x16x32_bf16 v[92:95], a[228:231], v[136:139], v[92:95]
 s_mul_i32 s54, s49, 21504
 s_mul_i32 s55, s30, 5120
 s_add_u32 s54, s54, s55
 v_mfma_f32_16x16x32_bf16 v[92:95], a[236:239], v[140:143], v[92:95]
 ds_read_b128 v[136:139], v209 offset:40960
 s_add_u32 s54, s54, 86016
 v_mfma_f32_16x16x32_bf16 v[68:71], a[224:227], v[144:147], v[68:71]
 ds_read_b128 v[140:143], v209 offset:41984
 s_add_u32 s55, s54, 4096
 v_mfma_f32_16x16x32_bf16 v[68:71], a[232:235], v[148:151], v[68:71]
 buffer_store_dwordx4 v[220:223], v194, s[44:47], s54 offen offset:0 sc1
 v_mfma_f32_16x16x32_bf16 v[96:99], a[228:231], v[144:147], v[96:99]
 v_mfma_f32_16x16x32_bf16 v[96:99], a[236:239], v[148:151], v[96:99]
 ds_read_b128 v[144:147], v209 offset:43008
 v_mfma_f32_16x16x32_bf16 v[72:75], a[224:227], v[152:155], v[72:75]
 ds_read_b128 v[148:151], v209 offset:44032
 buffer_store_dwordx4 v[220:223], v194, s[44:47], s54 offen offset:1024 sc1
 v_mfma_f32_16x16x32_bf16 v[72:75], a[232:235], v[156:159], v[72:75]
 v_mfma_f32_16x16x32_bf16 v[100:103], a[228:231], v[152:155], v[100:103]
 buffer_store_dwordx4 v[220:223], v194, s[44:47], s54 offen offset:2048 sc1
 v_mfma_f32_16x16x32_bf16 v[100:103], a[236:239], v[156:159], v[100:103]
 ds_read_b128 v[152:155], v209 offset:45056
 v_mfma_f32_16x16x32_bf16 v[76:79], a[224:227], v[160:163], v[76:79]
 ds_read_b128 v[156:159], v209 offset:46080
 v_mfma_f32_16x16x32_bf16 v[76:79], a[232:235], v[164:167], v[76:79]
 buffer_store_dwordx4 v[220:223], v194, s[44:47], s54 offen offset:3072 sc1
 v_mfma_f32_16x16x32_bf16 v[104:107], a[228:231], v[160:163], v[104:107]
 v_mfma_f32_16x16x32_bf16 v[104:107], a[236:239], v[164:167], v[104:107]
 buffer_store_dwordx4 v[220:223], v194, s[44:47], s55 offen offset:0 sc1
 v_mfma_f32_16x16x32_bf16 v[80:83], a[224:227], v[168:171], v[80:83]
 v_mfma_f32_16x16x32_bf16 v[80:83], a[232:235], v[172:175], v[80:83]
 buffer_store_dwordx4 v[220:223], v194, s[44:47], s55 offen offset:1024 sc1
 v_mfma_f32_16x16x32_bf16 v[108:111], a[228:231], v[168:171], v[108:111]
 v_mfma_f32_16x16x32_bf16 v[108:111], a[236:239], v[172:175], v[108:111]
 s_waitcnt vmcnt(42) lgkmcnt(0)
 s_barrier
 v_mfma_f32_16x16x32_bf16 v[56:59], a[240:243], v[176:179], v[56:59]
 ds_read_b128 v[160:163], v209 offset:0
 ds_read_b128 v[164:167], v209 offset:1024
 v_mfma_f32_16x16x32_bf16 v[56:59], a[248:251], v[180:183], v[56:59]
 ds_read_b128 v[168:171], v209 offset:2048
 v_mfma_f32_16x16x32_bf16 v[84:87], a[244:247], v[176:179], v[84:87]
 ds_read_b128 v[172:175], v209 offset:3072
 v_mfma_f32_16x16x32_bf16 v[84:87], a[252:255], v[180:183], v[84:87]
 ds_read_b128 v[176:179], v209 offset:4096
 v_mfma_f32_16x16x32_bf16 v[60:63], a[240:243], v[112:115], v[60:63]
 ds_read_b128 v[180:183], v209 offset:5120
 v_mfma_f32_16x16x32_bf16 v[60:63], a[248:251], v[116:119], v[60:63]
 v_mfma_f32_16x16x32_bf16 v[88:91], a[244:247], v[112:115], v[88:91]
 v_mfma_f32_16x16x32_bf16 v[88:91], a[252:255], v[116:119], v[88:91]
 ds_read_b128 v[112:115], v209 offset:6144
 v_mfma_f32_16x16x32_bf16 v[64:67], a[240:243], v[120:123], v[64:67]
 ds_read_b128 v[116:119], v209 offset:7168
 v_mfma_f32_16x16x32_bf16 v[64:67], a[248:251], v[124:127], v[64:67]
 v_mfma_f32_16x16x32_bf16 v[92:95], a[244:247], v[120:123], v[92:95]
 v_mfma_f32_16x16x32_bf16 v[92:95], a[252:255], v[124:127], v[92:95]
 ds_read_b128 v[120:123], v209 offset:8192
 v_mfma_f32_16x16x32_bf16 v[68:71], a[240:243], v[128:131], v[68:71]
 ds_read_b128 v[124:127], v209 offset:9216
 v_mfma_f32_16x16x32_bf16 v[68:71], a[248:251], v[132:135], v[68:71]
 v_mfma_f32_16x16x32_bf16 v[96:99], a[244:247], v[128:131], v[96:99]
 v_mfma_f32_16x16x32_bf16 v[96:99], a[252:255], v[132:135], v[96:99]
 ds_read_b128 v[128:131], v209 offset:10240
 v_mfma_f32_16x16x32_bf16 v[72:75], a[240:243], v[136:139], v[72:75]
 ds_read_b128 v[132:135], v209 offset:11264
 v_mfma_f32_16x16x32_bf16 v[72:75], a[248:251], v[140:143], v[72:75]
 v_mfma_f32_16x16x32_bf16 v[100:103], a[244:247], v[136:139], v[100:103]
 v_mfma_f32_16x16x32_bf16 v[100:103], a[252:255], v[140:143], v[100:103]
 ds_read_b128 v[136:139], v209 offset:12288
 v_mfma_f32_16x16x32_bf16 v[76:79], a[240:243], v[144:147], v[76:79]
 ds_read_b128 v[140:143], v209 offset:13312
 v_mfma_f32_16x16x32_bf16 v[76:79], a[248:251], v[148:151], v[76:79]
 v_mfma_f32_16x16x32_bf16 v[104:107], a[244:247], v[144:147], v[104:107]
 v_mfma_f32_16x16x32_bf16 v[104:107], a[252:255], v[148:151], v[104:107]
 v_mfma_f32_16x16x32_bf16 v[80:83], a[240:243], v[152:155], v[80:83]
 v_mfma_f32_16x16x32_bf16 v[80:83], a[248:251], v[156:159], v[80:83]
 v_mfma_f32_16x16x32_bf16 v[108:111], a[244:247], v[152:155], v[108:111]
 v_mfma_f32_16x16x32_bf16 v[108:111], a[252:255], v[156:159], v[108:111]
 s_waitcnt vmcnt(38) lgkmcnt(0)
 s_barrier
 v_mfma_f32_16x16x32_bf16 v[56:59], a[0:3], v[160:163], v[56:59]
 ds_read_b128 v[144:147], v194 offset:49152
 ds_read_b128 v[148:151], v194 offset:50176
 v_mfma_f32_16x16x32_bf16 v[56:59], a[8:11], v[164:167], v[56:59]
 ds_read_b128 v[152:155], v194 offset:51200
 v_mfma_f32_16x16x32_bf16 v[84:87], a[4:7], v[160:163], v[84:87]
 ds_read_b128 v[156:159], v194 offset:52224
 v_mfma_f32_16x16x32_bf16 v[84:87], a[12:15], v[164:167], v[84:87]
 ds_read_b128 v[160:163], v194 offset:53248
 v_mfma_f32_16x16x32_bf16 v[60:63], a[0:3], v[168:171], v[60:63]
 ds_read_b128 v[164:167], v194 offset:54272
 v_mfma_f32_16x16x32_bf16 v[60:63], a[8:11], v[172:175], v[60:63]
 v_mfma_f32_16x16x32_bf16 v[88:91], a[4:7], v[168:171], v[88:91]
 v_mfma_f32_16x16x32_bf16 v[88:91], a[12:15], v[172:175], v[88:91]
 ds_read_b128 v[168:171], v194 offset:55296
 v_mfma_f32_16x16x32_bf16 v[64:67], a[0:3], v[176:179], v[64:67]
 ds_read_b128 v[172:175], v194 offset:56320
 v_mfma_f32_16x16x32_bf16 v[64:67], a[8:11], v[180:183], v[64:67]
 v_mfma_f32_16x16x32_bf16 v[92:95], a[4:7], v[176:179], v[92:95]
 v_mfma_f32_16x16x32_bf16 v[92:95], a[12:15], v[180:183], v[92:95]
 ds_read_b128 v[176:179], v194 offset:57344
 v_mfma_f32_16x16x32_bf16 v[68:71], a[0:3], v[112:115], v[68:71]
 ds_read_b128 v[180:183], v194 offset:58368
 v_mfma_f32_16x16x32_bf16 v[68:71], a[8:11], v[116:119], v[68:71]
 v_mfma_f32_16x16x32_bf16 v[96:99], a[4:7], v[112:115], v[96:99]
 v_mfma_f32_16x16x32_bf16 v[96:99], a[12:15], v[116:119], v[96:99]
 ds_read_b128 v[112:115], v194 offset:59392
 v_mfma_f32_16x16x32_bf16 v[72:75], a[0:3], v[120:123], v[72:75]
 ds_read_b128 v[116:119], v194 offset:60416
 v_mfma_f32_16x16x32_bf16 v[72:75], a[8:11], v[124:127], v[72:75]
 v_mfma_f32_16x16x32_bf16 v[100:103], a[4:7], v[120:123], v[100:103]
 v_mfma_f32_16x16x32_bf16 v[100:103], a[12:15], v[124:127], v[100:103]
 ds_read_b128 v[120:123], v194 offset:61440
 v_mfma_f32_16x16x32_bf16 v[76:79], a[0:3], v[128:131], v[76:79]
 ds_read_b128 v[124:127], v194 offset:62464
 v_mfma_f32_16x16x32_bf16 v[76:79], a[8:11], v[132:135], v[76:79]
 v_mfma_f32_16x16x32_bf16 v[104:107], a[4:7], v[128:131], v[104:107]
 v_mfma_f32_16x16x32_bf16 v[104:107], a[12:15], v[132:135], v[104:107]
 v_mfma_f32_16x16x32_bf16 v[80:83], a[0:3], v[136:139], v[80:83]
 v_mfma_f32_16x16x32_bf16 v[80:83], a[8:11], v[140:143], v[80:83]
 v_mfma_f32_16x16x32_bf16 v[108:111], a[4:7], v[136:139], v[108:111]
 v_mfma_f32_16x16x32_bf16 v[108:111], a[12:15], v[140:143], v[108:111]
 s_waitcnt vmcnt(0) lgkmcnt(0)
 s_barrier
 v_mfma_f32_16x16x32_bf16 v[56:59], a[16:19], v[144:147], v[56:59]
 ds_read_b128 v[128:131], v194 offset:16384
 ds_read_b128 v[132:135], v194 offset:17408
 v_mfma_f32_16x16x32_bf16 v[56:59], a[24:27], v[148:151], v[56:59]
 ds_read_b128 v[136:139], v194 offset:18432
 v_mfma_f32_16x16x32_bf16 v[84:87], a[20:23], v[144:147], v[84:87]
 ds_read_b128 v[140:143], v194 offset:19456
 v_mfma_f32_16x16x32_bf16 v[84:87], a[28:31], v[148:151], v[84:87]
 ds_read_b128 v[144:147], v194 offset:20480
 v_mfma_f32_16x16x32_bf16 v[60:63], a[16:19], v[152:155], v[60:63]
 ds_read_b128 v[148:151], v194 offset:21504
 v_mfma_f32_16x16x32_bf16 v[60:63], a[24:27], v[156:159], v[60:63]
 v_mfma_f32_16x16x32_bf16 v[88:91], a[20:23], v[152:155], v[88:91]
 v_mfma_f32_16x16x32_bf16 v[88:91], a[28:31], v[156:159], v[88:91]
 ds_read_b128 v[152:155], v194 offset:22528
 v_mfma_f32_16x16x32_bf16 v[64:67], a[16:19], v[160:163], v[64:67]
 ds_read_b128 v[156:159], v194 offset:23552
 v_mfma_f32_16x16x32_bf16 v[64:67], a[24:27], v[164:167], v[64:67]
 v_mfma_f32_16x16x32_bf16 v[92:95], a[20:23], v[160:163], v[92:95]
 v_mfma_f32_16x16x32_bf16 v[92:95], a[28:31], v[164:167], v[92:95]
 ds_read_b128 v[160:163], v194 offset:24576
 v_mfma_f32_16x16x32_bf16 v[68:71], a[16:19], v[168:171], v[68:71]
 ds_read_b128 v[164:167], v194 offset:25600
 v_mfma_f32_16x16x32_bf16 v[68:71], a[24:27], v[172:175], v[68:71]
 v_mfma_f32_16x16x32_bf16 v[96:99], a[20:23], v[168:171], v[96:99]
 v_mfma_f32_16x16x32_bf16 v[96:99], a[28:31], v[172:175], v[96:99]
 ds_read_b128 v[168:171], v194 offset:26624
 v_mfma_f32_16x16x32_bf16 v[72:75], a[16:19], v[176:179], v[72:75]
 ds_read_b128 v[172:175], v194 offset:27648
 v_mfma_f32_16x16x32_bf16 v[72:75], a[24:27], v[180:183], v[72:75]
 buffer_store_dword v198, v196, s[96:99], 0 offen offset:0 sc1
 v_mfma_f32_16x16x32_bf16 v[100:103], a[20:23], v[176:179], v[100:103]
 v_mfma_f32_16x16x32_bf16 v[100:103], a[28:31], v[180:183], v[100:103]
 ds_read_b128 v[176:179], v194 offset:28672
 v_mfma_f32_16x16x32_bf16 v[76:79], a[16:19], v[112:115], v[76:79]
 ds_read_b128 v[180:183], v194 offset:29696
 v_mfma_f32_16x16x32_bf16 v[76:79], a[24:27], v[116:119], v[76:79]
 v_mfma_f32_16x16x32_bf16 v[104:107], a[20:23], v[112:115], v[104:107]
 v_mfma_f32_16x16x32_bf16 v[104:107], a[28:31], v[116:119], v[104:107]
 v_mfma_f32_16x16x32_bf16 v[80:83], a[16:19], v[120:123], v[80:83]
 v_mfma_f32_16x16x32_bf16 v[80:83], a[24:27], v[124:127], v[80:83]
 v_mfma_f32_16x16x32_bf16 v[108:111], a[20:23], v[120:123], v[108:111]
 v_mfma_f32_16x16x32_bf16 v[108:111], a[28:31], v[124:127], v[108:111]
 s_waitcnt lgkmcnt(0)
 s_barrier
 v_mfma_f32_16x16x32_bf16 v[56:59], a[32:35], v[128:131], v[56:59]
 ds_read_b128 v[112:115], v209 offset:49152
 ds_read_b128 v[116:119], v209 offset:50176
 v_mfma_f32_16x16x32_bf16 v[56:59], a[40:43], v[132:135], v[56:59]
 ds_read_b128 v[120:123], v209 offset:51200
 v_mfma_f32_16x16x32_bf16 v[84:87], a[36:39], v[128:131], v[84:87]
 ds_read_b128 v[124:127], v209 offset:52224
 v_mfma_f32_16x16x32_bf16 v[84:87], a[44:47], v[132:135], v[84:87]
 ds_read_b128 v[128:131], v209 offset:53248
 v_mfma_f32_16x16x32_bf16 v[60:63], a[32:35], v[136:139], v[60:63]
 ds_read_b128 v[132:135], v209 offset:54272
 v_mfma_f32_16x16x32_bf16 v[60:63], a[40:43], v[140:143], v[60:63]
 v_mfma_f32_16x16x32_bf16 v[88:91], a[36:39], v[136:139], v[88:91]
 v_mfma_f32_16x16x32_bf16 v[88:91], a[44:47], v[140:143], v[88:91]
 ds_read_b128 v[136:139], v209 offset:55296
 v_mfma_f32_16x16x32_bf16 v[64:67], a[32:35], v[144:147], v[64:67]
 ds_read_b128 v[140:143], v209 offset:56320
 v_mfma_f32_16x16x32_bf16 v[64:67], a[40:43], v[148:151], v[64:67]
 v_mfma_f32_16x16x32_bf16 v[92:95], a[36:39], v[144:147], v[92:95]
 v_mfma_f32_16x16x32_bf16 v[92:95], a[44:47], v[148:151], v[92:95]
 ds_read_b128 v[144:147], v209 offset:57344
 v_mfma_f32_16x16x32_bf16 v[68:71], a[32:35], v[152:155], v[68:71]
 ds_read_b128 v[148:151], v209 offset:58368
 v_mfma_f32_16x16x32_bf16 v[68:71], a[40:43], v[156:159], v[68:71]
 v_mfma_f32_16x16x32_bf16 v[96:99], a[36:39], v[152:155], v[96:99]
 v_mfma_f32_16x16x32_bf16 v[96:99], a[44:47], v[156:159], v[96:99]
 ds_read_b128 v[152:155], v209 offset:59392
 v_mfma_f32_16x16x32_bf16 v[72:75], a[32:35], v[160:163], v[72:75]
 ds_read_b128 v[156:159], v209 offset:60416
 v_mfma_f32_16x16x32_bf16 v[72:75], a[40:43], v[164:167], v[72:75]
 v_mfma_f32_16x16x32_bf16 v[100:103], a[36:39], v[160:163], v[100:103]
 v_mfma_f32_16x16x32_bf16 v[100:103], a[44:47], v[164:167], v[100:103]
 ds_read_b128 v[160:163], v209 offset:61440
 v_mfma_f32_16x16x32_bf16 v[76:79], a[32:35], v[168:171], v[76:79]
 ds_read_b128 v[164:167], v209 offset:62464
 v_mfma_f32_16x16x32_bf16 v[76:79], a[40:43], v[172:175], v[76:79]
 v_mfma_f32_16x16x32_bf16 v[104:107], a[36:39], v[168:171], v[104:107]
 v_mfma_f32_16x16x32_bf16 v[104:107], a[44:47], v[172:175], v[104:107]
 v_mfma_f32_16x16x32_bf16 v[80:83], a[32:35], v[176:179], v[80:83]
 v_mfma_f32_16x16x32_bf16 v[80:83], a[40:43], v[180:183], v[80:83]
 v_mfma_f32_16x16x32_bf16 v[108:111], a[36:39], v[176:179], v[108:111]
 v_mfma_f32_16x16x32_bf16 v[108:111], a[44:47], v[180:183], v[108:111]
 s_waitcnt lgkmcnt(13)
 v_mfma_f32_16x16x32_bf16 v[56:59], a[48:51], v[112:115], v[56:59]
 ds_read_b128 v[168:171], v194 offset:32768
 ds_read_b128 v[172:175], v194 offset:33792
 s_waitcnt lgkmcnt(14)
 v_mfma_f32_16x16x32_bf16 v[56:59], a[56:59], v[116:119], v[56:59]
 ds_read_b128 v[176:179], v194 offset:34816
 v_mfma_f32_16x16x32_bf16 v[84:87], a[52:55], v[112:115], v[84:87]
 ds_read_b128 v[180:183], v194 offset:35840
 v_mfma_f32_16x16x32_bf16 v[84:87], a[60:63], v[116:119], v[84:87]
 ds_read_b128 v[112:115], v194 offset:36864
 s_waitcnt lgkmcnt(15)
 v_mfma_f32_16x16x32_bf16 v[60:63], a[48:51], v[120:123], v[60:63]
 ds_read_b128 v[116:119], v194 offset:37888
 v_mfma_f32_16x16x32_bf16 v[60:63], a[56:59], v[124:127], v[60:63]
 v_mfma_f32_16x16x32_bf16 v[88:91], a[52:55], v[120:123], v[88:91]
 v_mfma_f32_16x16x32_bf16 v[88:91], a[60:63], v[124:127], v[88:91]
 ds_read_b128 v[120:123], v194 offset:38912
 s_waitcnt lgkmcnt(15)
 v_mfma_f32_16x16x32_bf16 v[64:67], a[48:51], v[128:131], v[64:67]
 ds_read_b128 v[124:127], v194 offset:39936
 v_mfma_f32_16x16x32_bf16 v[64:67], a[56:59], v[132:135], v[64:67]
 v_mfma_f32_16x16x32_bf16 v[92:95], a[52:55], v[128:131], v[92:95]
 v_mfma_f32_16x16x32_bf16 v[92:95], a[60:63], v[132:135], v[92:95]
 ds_read_b128 v[128:131], v194 offset:40960
 s_waitcnt lgkmcnt(15)
 v_mfma_f32_16x16x32_bf16 v[68:71], a[48:51], v[136:139], v[68:71]
 ds_read_b128 v[132:135], v194 offset:41984
 v_mfma_f32_16x16x32_bf16 v[68:71], a[56:59], v[140:143], v[68:71]
 v_mfma_f32_16x16x32_bf16 v[96:99], a[52:55], v[136:139], v[96:99]
 v_mfma_f32_16x16x32_bf16 v[96:99], a[60:63], v[140:143], v[96:99]
 ds_read_b128 v[136:139], v194 offset:43008
 s_waitcnt lgkmcnt(15)
 v_mfma_f32_16x16x32_bf16 v[72:75], a[48:51], v[144:147], v[72:75]
 ds_read_b128 v[140:143], v194 offset:44032
 v_mfma_f32_16x16x32_bf16 v[72:75], a[56:59], v[148:151], v[72:75]
 v_mfma_f32_16x16x32_bf16 v[100:103], a[52:55], v[144:147], v[100:103]
 v_mfma_f32_16x16x32_bf16 v[100:103], a[60:63], v[148:151], v[100:103]
 ds_read_b128 v[144:147], v194 offset:45056
 s_waitcnt lgkmcnt(15)
 v_mfma_f32_16x16x32_bf16 v[76:79], a[48:51], v[152:155], v[76:79]
 ds_read_b128 v[148:151], v194 offset:46080
 v_mfma_f32_16x16x32_bf16 v[76:79], a[56:59], v[156:159], v[76:79]
 v_mfma_f32_16x16x32_bf16 v[104:107], a[52:55], v[152:155], v[104:107]
 v_mfma_f32_16x16x32_bf16 v[104:107], a[60:63], v[156:159], v[104:107]
 s_waitcnt lgkmcnt(15)
 v_mfma_f32_16x16x32_bf16 v[80:83], a[48:51], v[160:163], v[80:83]
 s_waitcnt lgkmcnt(14)
 v_mfma_f32_16x16x32_bf16 v[80:83], a[56:59], v[164:167], v[80:83]
 v_mfma_f32_16x16x32_bf16 v[108:111], a[52:55], v[160:163], v[108:111]
 v_mfma_f32_16x16x32_bf16 v[108:111], a[60:63], v[164:167], v[108:111]
 s_waitcnt lgkmcnt(0)
 s_barrier
 v_mfma_f32_16x16x32_bf16 v[56:59], a[64:67], v[168:171], v[56:59]
 ds_read_b128 v[152:155], v210 offset:0
 ds_read_b128 v[156:159], v210 offset:1024
 v_mfma_f32_16x16x32_bf16 v[56:59], a[72:75], v[172:175], v[56:59]
 ds_read_b128 v[160:163], v210 offset:2048
 v_mfma_f32_16x16x32_bf16 v[84:87], a[68:71], v[168:171], v[84:87]
 ds_read_b128 v[164:167], v210 offset:3072
 v_mfma_f32_16x16x32_bf16 v[84:87], a[76:79], v[172:175], v[84:87]
 ds_read_b128 v[168:171], v210 offset:4096
 v_mfma_f32_16x16x32_bf16 v[60:63], a[64:67], v[176:179], v[60:63]
 ds_read_b128 v[172:175], v210 offset:5120
 v_mfma_f32_16x16x32_bf16 v[60:63], a[72:75], v[180:183], v[60:63]
 v_mfma_f32_16x16x32_bf16 v[88:91], a[68:71], v[176:179], v[88:91]
 v_mfma_f32_16x16x32_bf16 v[88:91], a[76:79], v[180:183], v[88:91]
 ds_read_b128 v[176:179], v210 offset:6144
 v_mfma_f32_16x16x32_bf16 v[64:67], a[64:67], v[112:115], v[64:67]
 ds_read_b128 v[180:183], v210 offset:7168
 v_mfma_f32_16x16x32_bf16 v[64:67], a[72:75], v[116:119], v[64:67]
 v_mfma_f32_16x16x32_bf16 v[92:95], a[68:71], v[112:115], v[92:95]
 v_mfma_f32_16x16x32_bf16 v[92:95], a[76:79], v[116:119], v[92:95]
 ds_read_b128 v[112:115], v210 offset:8192
 v_mfma_f32_16x16x32_bf16 v[68:71], a[64:67], v[120:123], v[68:71]
 ds_read_b128 v[116:119], v210 offset:9216
 v_mfma_f32_16x16x32_bf16 v[68:71], a[72:75], v[124:127], v[68:71]
 v_mfma_f32_16x16x32_bf16 v[96:99], a[68:71], v[120:123], v[96:99]
 v_mfma_f32_16x16x32_bf16 v[96:99], a[76:79], v[124:127], v[96:99]
 ds_read_b128 v[120:123], v210 offset:10240
 v_mfma_f32_16x16x32_bf16 v[72:75], a[64:67], v[128:131], v[72:75]
 ds_read_b128 v[124:127], v210 offset:11264
 v_mfma_f32_16x16x32_bf16 v[72:75], a[72:75], v[132:135], v[72:75]
 buffer_load_dword v216, v197, s[96:99], 0 offen offset:0 sc1
 v_mfma_f32_16x16x32_bf16 v[100:103], a[68:71], v[128:131], v[100:103]
 v_mfma_f32_16x16x32_bf16 v[100:103], a[76:79], v[132:135], v[100:103]
 ds_read_b128 v[128:131], v210 offset:12288
 v_mfma_f32_16x16x32_bf16 v[76:79], a[64:67], v[136:139], v[76:79]
 ds_read_b128 v[132:135], v210 offset:13312
 v_mfma_f32_16x16x32_bf16 v[76:79], a[72:75], v[140:143], v[76:79]
 v_mfma_f32_16x16x32_bf16 v[104:107], a[68:71], v[136:139], v[104:107]
 v_mfma_f32_16x16x32_bf16 v[104:107], a[76:79], v[140:143], v[104:107]
 v_mfma_f32_16x16x32_bf16 v[80:83], a[64:67], v[144:147], v[80:83]
 v_mfma_f32_16x16x32_bf16 v[80:83], a[72:75], v[148:151], v[80:83]
 v_mfma_f32_16x16x32_bf16 v[108:111], a[68:71], v[144:147], v[108:111]
 v_mfma_f32_16x16x32_bf16 v[108:111], a[76:79], v[148:151], v[108:111]
 s_waitcnt lgkmcnt(13)
 v_mfma_f32_16x16x32_bf16 v[56:59], a[80:83], v[152:155], v[56:59]
 ds_read_b128 v[136:139], v209 offset:16384
 ds_read_b128 v[140:143], v209 offset:17408
 s_waitcnt lgkmcnt(14)
 v_mfma_f32_16x16x32_bf16 v[56:59], a[88:91], v[156:159], v[56:59]
 ds_read_b128 v[144:147], v209 offset:18432
 v_mfma_f32_16x16x32_bf16 v[84:87], a[84:87], v[152:155], v[84:87]
 ds_read_b128 v[148:151], v209 offset:19456
 v_mfma_f32_16x16x32_bf16 v[84:87], a[92:95], v[156:159], v[84:87]
 ds_read_b128 v[152:155], v209 offset:20480
 s_waitcnt lgkmcnt(15)
 v_mfma_f32_16x16x32_bf16 v[60:63], a[80:83], v[160:163], v[60:63]
 ds_read_b128 v[156:159], v209 offset:21504
 v_mfma_f32_16x16x32_bf16 v[60:63], a[88:91], v[164:167], v[60:63]
 v_mfma_f32_16x16x32_bf16 v[88:91], a[84:87], v[160:163], v[88:91]
 v_mfma_f32_16x16x32_bf16 v[88:91], a[92:95], v[164:167], v[88:91]
 ds_read_b128 v[160:163], v209 offset:22528
 s_waitcnt lgkmcnt(15)
 v_mfma_f32_16x16x32_bf16 v[64:67], a[80:83], v[168:171], v[64:67]
 ds_read_b128 v[164:167], v209 offset:23552
 v_mfma_f32_16x16x32_bf16 v[64:67], a[88:91], v[172:175], v[64:67]
 v_mfma_f32_16x16x32_bf16 v[92:95], a[84:87], v[168:171], v[92:95]
 v_mfma_f32_16x16x32_bf16 v[92:95], a[92:95], v[172:175], v[92:95]
 ds_read_b128 v[168:171], v209 offset:24576
 s_waitcnt lgkmcnt(15)
 v_mfma_f32_16x16x32_bf16 v[68:71], a[80:83], v[176:179], v[68:71]
 ds_read_b128 v[172:175], v209 offset:25600
 v_mfma_f32_16x16x32_bf16 v[68:71], a[88:91], v[180:183], v[68:71]
 v_mfma_f32_16x16x32_bf16 v[96:99], a[84:87], v[176:179], v[96:99]
 v_mfma_f32_16x16x32_bf16 v[96:99], a[92:95], v[180:183], v[96:99]
 ds_read_b128 v[176:179], v209 offset:26624
 s_waitcnt lgkmcnt(15)
 v_mfma_f32_16x16x32_bf16 v[72:75], a[80:83], v[112:115], v[72:75]
 ds_read_b128 v[180:183], v209 offset:27648
 v_mfma_f32_16x16x32_bf16 v[72:75], a[88:91], v[116:119], v[72:75]
 v_mfma_f32_16x16x32_bf16 v[100:103], a[84:87], v[112:115], v[100:103]
 v_mfma_f32_16x16x32_bf16 v[100:103], a[92:95], v[116:119], v[100:103]
 ds_read_b128 v[112:115], v209 offset:28672
 s_waitcnt lgkmcnt(15)
 v_mfma_f32_16x16x32_bf16 v[76:79], a[80:83], v[120:123], v[76:79]
 ds_read_b128 v[116:119], v209 offset:29696
 v_mfma_f32_16x16x32_bf16 v[76:79], a[88:91], v[124:127], v[76:79]
 v_mfma_f32_16x16x32_bf16 v[104:107], a[84:87], v[120:123], v[104:107]
 v_mfma_f32_16x16x32_bf16 v[104:107], a[92:95], v[124:127], v[104:107]
 s_waitcnt lgkmcnt(15)
 v_mfma_f32_16x16x32_bf16 v[80:83], a[80:83], v[128:131], v[80:83]
 s_waitcnt lgkmcnt(14)
 v_mfma_f32_16x16x32_bf16 v[80:83], a[88:91], v[132:135], v[80:83]
 v_mfma_f32_16x16x32_bf16 v[108:111], a[84:87], v[128:131], v[108:111]
 v_mfma_f32_16x16x32_bf16 v[108:111], a[92:95], v[132:135], v[108:111]
 s_waitcnt lgkmcnt(0)
 s_barrier
 v_mfma_f32_16x16x32_bf16 v[56:59], a[96:99], v[136:139], v[56:59]
 ds_read_b128 v[120:123], v194 offset:0
 ds_read_b128 v[124:127], v194 offset:1024
 v_mfma_f32_16x16x32_bf16 v[56:59], a[104:107], v[140:143], v[56:59]
 ds_read_b128 v[128:131], v194 offset:2048
 v_mfma_f32_16x16x32_bf16 v[84:87], a[100:103], v[136:139], v[84:87]
 ds_read_b128 v[132:135], v194 offset:3072
 s_waitcnt vmcnt(0)
 v_cmp_eq_u32 vcc, 1, v216
 s_and_b32 s42, vcc_lo, 15
 s_cmp_eq_u32 s42, 15
 s_cbranch_scc0 L_spin3
L_spun3:
 v_mfma_f32_16x16x32_bf16 v[84:87], a[108:111], v[140:143], v[84:87]
 ds_read_b128 v[136:139], v194 offset:4096
 v_mfma_f32_16x16x32_bf16 v[60:63], a[96:99], v[144:147], v[60:63]
 ds_read_b128 v[140:143], v194 offset:5120
 s_add_u32 s59, s58, 0
 v_mfma_f32_16x16x32_bf16 v[60:63], a[104:107], v[148:151], v[60:63]
 buffer_load_dwordx4 v[28:31], v254, s[44:47], s59 offen offset:0 sc1
 v_mfma_f32_16x16x32_bf16 v[88:91], a[100:103], v[144:147], v[88:91]
 buffer_load_dwordx4 v[32:35], v254, s[44:47], s59 offen offset:1024 sc1
 v_mfma_f32_16x16x32_bf16 v[88:91], a[108:111], v[148:151], v[88:91]
 ds_read_b128 v[144:147], v194 offset:6144
 v_mfma_f32_16x16x32_bf16 v[64:67], a[96:99], v[152:155], v[64:67]
 ds_read_b128 v[148:151], v194 offset:7168
 buffer_load_dwordx4 v[36:39], v254, s[44:47], s59 offen offset:2048 sc1
 v_mfma_f32_16x16x32_bf16 v[64:67], a[104:107], v[156:159], v[64:67]
 v_mov_b32 v42, 0
 v_mfma_f32_16x16x32_bf16 v[92:95], a[100:103], v[152:155], v[92:95]
 v_mov_b32 v43, 0
 v_mfma_f32_16x16x32_bf16 v[92:95], a[108:111], v[156:159], v[92:95]
 ds_read_b128 v[152:155], v194 offset:8192
 buffer_load_dwordx2 v[40:41], v255, s[44:47], s59 offen offset:0 sc1
 v_mfma_f32_16x16x32_bf16 v[68:71], a[96:99], v[160:163], v[68:71]
 ds_read_b128 v[156:159], v194 offset:9216
 s_add_u32 s59, s58, 7168
 v_mfma_f32_16x16x32_bf16 v[68:71], a[104:107], v[164:167], v[68:71]
 buffer_load_dwordx4 v[44:47], v254, s[44:47], s59 offen offset:0 sc1
 v_mfma_f32_16x16x32_bf16 v[96:99], a[100:103], v[160:163], v[96:99]
 buffer_load_dwordx4 v[48:51], v254, s[44:47], s59 offen offset:1024 sc1
 v_mfma_f32_16x16x32_bf16 v[96:99], a[108:111], v[164:167], v[96:99]
 ds_read_b128 v[160:163], v194 offset:10240
 v_mfma_f32_16x16x32_bf16 v[72:75], a[96:99], v[168:171], v[72:75]
 ds_read_b128 v[164:167], v194 offset:11264
 buffer_load_dwordx4 v[52:55], v254, s[44:47], s59 offen offset:2048 sc1
 v_mfma_f32_16x16x32_bf16 v[72:75], a[104:107], v[172:175], v[72:75]
 v_mov_b32 v222, 0
 v_mfma_f32_16x16x32_bf16 v[100:103], a[100:103], v[168:171], v[100:103]
 v_mov_b32 v223, 0
 v_mfma_f32_16x16x32_bf16 v[100:103], a[108:111], v[172:175], v[100:103]
 ds_read_b128 v[168:171], v194 offset:12288
 buffer_load_dwordx2 v[220:221], v255, s[44:47], s59 offen offset:0 sc1
 v_mfma_f32_16x16x32_bf16 v[76:79], a[96:99], v[176:179], v[76:79]
 ds_read_b128 v[172:175], v194 offset:13312
 s_add_u32 s59, s58, 14336
 v_mfma_f32_16x16x32_bf16 v[76:79], a[104:107], v[180:183], v[76:79]
 buffer_load_dwordx4 v[224:227], v254, s[44:47], s59 offen offset:0 sc1
 v_mfma_f32_16x16x32_bf16 v[104:107], a[100:103], v[176:179], v[104:107]
 buffer_load_dwordx4 v[228:231], v254, s[44:47], s59 offen offset:1024 sc1
 v_mfma_f32_16x16x32_bf16 v[104:107], a[108:111], v[180:183], v[104:107]
 v_mfma_f32_16x16x32_bf16 v[80:83], a[96:99], v[112:115], v[80:83]
 buffer_load_dwordx4 v[232:235], v254, s[44:47], s59 offen offset:2048 sc1
 v_mfma_f32_16x16x32_bf16 v[80:83], a[104:107], v[116:119], v[80:83]
 v_mov_b32 v238, 0
 v_mov_b32 v239, 0
 v_mfma_f32_16x16x32_bf16 v[108:111], a[100:103], v[112:115], v[108:111]
 buffer_load_dwordx2 v[236:237], v255, s[44:47], s59 offen offset:0 sc1
 v_mfma_f32_16x16x32_bf16 v[108:111], a[108:111], v[116:119], v[108:111]
 s_waitcnt lgkmcnt(13)
 v_mfma_f32_16x16x32_bf16 v[84:87], a[116:119], v[120:123], v[84:87]
 s_waitcnt lgkmcnt(12)
 v_mfma_f32_16x16x32_bf16 v[84:87], a[124:127], v[124:127], v[84:87]
 s_waitcnt lgkmcnt(11)
 v_mfma_f32_16x16x32_bf16 v[88:91], a[116:119], v[128:131], v[88:91]
 s_waitcnt lgkmcnt(10)
 v_mfma_f32_16x16x32_bf16 v[88:91], a[124:127], v[132:135], v[88:91]
 s_waitcnt lgkmcnt(9)
 v_mfma_f32_16x16x32_bf16 v[92:95], a[116:119], v[136:139], v[92:95]
 s_waitcnt lgkmcnt(8)
 v_mfma_f32_16x16x32_bf16 v[92:95], a[124:127], v[140:143], v[92:95]
 s_waitcnt lgkmcnt(7)
 v_mfma_f32_16x16x32_bf16 v[96:99], a[116:119], v[144:147], v[96:99]
 s_waitcnt lgkmcnt(6)
 v_mfma_f32_16x16x32_bf16 v[96:99], a[124:127], v[148:151], v[96:99]
 s_waitcnt lgkmcnt(5)
 v_mfma_f32_16x16x32_bf16 v[100:103], a[116:119], v[152:155], v[100:103]
 s_waitcnt lgkmcnt(4)
 v_mfma_f32_16x16x32_bf16 v[100:103], a[124:127], v[156:159], v[100:103]
 s_waitcnt lgkmcnt(3)
 v_mfma_f32_16x16x32_bf16 v[104:107], a[116:119], v[160:163], v[104:107]
 s_waitcnt lgkmcnt(2)
 v_mfma_f32_16x16x32_bf16 v[104:107], a[124:127], v[164:167], v[104:107]
 s_waitcnt lgkmcnt(1)
 v_mfma_f32_16x16x32_bf16 v[108:111], a[116:119], v[168:171], v[108:111]
 v_cvt_pk_bf16_f32 v84, v84, v85
 v_cvt_pk_bf16_f32 v85, v86, v87
 v_cvt_pk_bf16_f32 v86, v88, v89
 s_waitcnt lgkmcnt(0)
 v_mfma_f32_16x16x32_bf16 v[108:111], a[124:127], v[172:175], v[108:111]
 v_cvt_pk_bf16_f32 v87, v90, v91
 v_min_u32 v84, -2, v84
 v_mfma_f32_16x16x32_bf16 v[56:59], a[112:115], v[120:123], v[56:59]
 v_min_u32 v85, -2, v85
 v_min_u32 v86, -2, v86
 v_min_u32 v87, -2, v87
 v_mfma_f32_16x16x32_bf16 v[56:59], a[120:123], v[124:127], v[56:59]
 buffer_store_dwordx4 v[84:87], v250, s[44:47], s57 offen offset:0 sc1
 v_mfma_f32_16x16x32_bf16 v[60:63], a[112:115], v[128:131], v[60:63]
 v_cvt_pk_bf16_f32 v92, v92, v93
 v_cvt_pk_bf16_f32 v93, v94, v95
 v_mfma_f32_16x16x32_bf16 v[60:63], a[120:123], v[132:135], v[60:63]
 v_cvt_pk_bf16_f32 v94, v96, v97
 v_cvt_pk_bf16_f32 v95, v98, v99
 v_mfma_f32_16x16x32_bf16 v[64:67], a[112:115], v[136:139], v[64:67]
 v_min_u32 v92, -2, v92
 v_min_u32 v93, -2, v93
 v_min_u32 v94, -2, v94
 v_mfma_f32_16x16x32_bf16 v[64:67], a[120:123], v[140:143], v[64:67]
 v_min_u32 v95, -2, v95
 buffer_store_dwordx4 v[92:95], v250, s[44:47], s57 offen offset:1024 sc1
 v_mfma_f32_16x16x32_bf16 v[68:71], a[112:115], v[144:147], v[68:71]
 v_cvt_pk_bf16_f32 v100, v100, v101
 v_mfma_f32_16x16x32_bf16 v[68:71], a[120:123], v[148:151], v[68:71]
 v_cvt_pk_bf16_f32 v101, v102, v103
 v_cvt_pk_bf16_f32 v102, v104, v105
 v_mfma_f32_16x16x32_bf16 v[72:75], a[112:115], v[152:155], v[72:75]
 v_cvt_pk_bf16_f32 v103, v106, v107
 v_min_u32 v100, -2, v100
 v_min_u32 v101, -2, v101
 v_mfma_f32_16x16x32_bf16 v[72:75], a[120:123], v[156:159], v[72:75]
 v_min_u32 v102, -2, v102
 v_min_u32 v103, -2, v103
 v_mfma_f32_16x16x32_bf16 v[76:79], a[112:115], v[160:163], v[76:79]
 buffer_store_dwordx4 v[100:103], v250, s[44:47], s57 offen offset:2048 sc1
 v_mfma_f32_16x16x32_bf16 v[76:79], a[120:123], v[164:167], v[76:79]
 v_cvt_pk_bf16_f32 v108, v108, v109
 v_cvt_pk_bf16_f32 v109, v110, v111
 v_mfma_f32_16x16x32_bf16 v[80:83], a[112:115], v[168:171], v[80:83]
 v_min_u32 v108, -2, v108
 v_min_u32 v109, -2, v109
 buffer_store_dwordx2 v[108:109], v251, s[44:47], s57 offen offset:0 sc1
 v_mfma_f32_16x16x32_bf16 v[80:83], a[120:123], v[172:175], v[80:83]
 v_cvt_pk_bf16_f32 v88, v56, v57
 v_cvt_pk_bf16_f32 v89, v58, v59
 v_cvt_pk_bf16_f32 v90, v60, v61
 v_cvt_pk_bf16_f32 v91, v62, v63
 v_min_u32 v88, -2, v88
 v_min_u32 v89, -2, v89
 v_min_u32 v90, -2, v90
 v_min_u32 v91, -2, v91
 buffer_store_dwordx4 v[88:91], v252, s[44:47], s56 offen offset:0 sc1
 v_cvt_pk_bf16_f32 v96, v64, v65
 v_cvt_pk_bf16_f32 v97, v66, v67
 v_cvt_pk_bf16_f32 v98, v68, v69
 v_cvt_pk_bf16_f32 v99, v70, v71
 v_min_u32 v96, -2, v96
 v_min_u32 v97, -2, v97
 v_min_u32 v98, -2, v98
 v_min_u32 v99, -2, v99
 buffer_store_dwordx4 v[96:99], v252, s[44:47], s56 offen offset:1024 sc1
 v_cvt_pk_bf16_f32 v104, v72, v73
 v_cvt_pk_bf16_f32 v105, v74, v75
 v_cvt_pk_bf16_f32 v106, v76, v77
 v_cvt_pk_bf16_f32 v107, v78, v79
 v_min_u32 v104, -2, v104
 v_min_u32 v105, -2, v105
 v_min_u32 v106, -2, v106
 v_min_u32 v107, -2, v107
 buffer_store_dwordx4 v[104:107], v252, s[44:47], s56 offen offset:2048 sc1
 v_cvt_pk_bf16_f32 v110, v80, v81
 v_cvt_pk_bf16_f32 v111, v82, v83
 v_min_u32 v110, -2, v110
 v_min_u32 v111, -2, v111
 buffer_store_dwordx2 v[110:111], v253, s[44:47], s56 offen offset:0 sc1
 s_add_u32 s59, s58, 86016
 buffer_load_dwordx4 v[112:115], v254, s[44:47], s59 offen offset:0 sc1
 buffer_load_dwordx4 v[116:119], v254, s[44:47], s59 offen offset:1024 sc1
 buffer_load_dwordx4 v[120:123], v254, s[44:47], s59 offen offset:2048 sc1
 v_mov_b32 v126, 0
 v_mov_b32 v127, 0
 buffer_load_dwordx2 v[124:125], v255, s[44:47], s59 offen offset:0 sc1
 s_add_u32 s59, s58, 93184
 buffer_load_dwordx4 v[128:131], v254, s[44:47], s59 offen offset:0 sc1
 buffer_load_dwordx4 v[132:135], v254, s[44:47], s59 offen offset:1024 sc1
 buffer_load_dwordx4 v[136:139], v254, s[44:47], s59 offen offset:2048 sc1
 v_mov_b32 v142, 0
 v_mov_b32 v143, 0
 buffer_load_dwordx2 v[140:141], v255, s[44:47], s59 offen offset:0 sc1
 s_add_u32 s59, s58, 100352
 buffer_load_dwordx4 v[144:147], v254, s[44:47], s59 offen offset:0 sc1
 buffer_load_dwordx4 v[148:151], v254, s[44:47], s59 offen offset:1024 sc1
 buffer_load_dwordx4 v[152:155], v254, s[44:47], s59 offen offset:2048 sc1
 v_mov_b32 v158, 0
 v_mov_b32 v159, 0
 buffer_load_dwordx2 v[156:157], v255, s[44:47], s59 offen offset:0 sc1
 s_waitcnt vmcnt(31)
 v_mfma_f32_16x16x32_bf16 v[0:3], v[246:249], v[28:31], v[0:3]
 s_waitcnt vmcnt(27)
 v_mfma_f32_16x16x32_bf16 v[0:3], v[246:249], v[44:47], v[0:3]
 s_waitcnt vmcnt(23)
 v_mfma_f32_16x16x32_bf16 v[0:3], v[246:249], v[224:227], v[0:3]
 v_mfma_f32_16x16x32_bf16 v[4:7], v[244:247], v[28:31], v[4:7]
 v_mfma_f32_16x16x32_bf16 v[4:7], v[244:247], v[44:47], v[4:7]
 v_mfma_f32_16x16x32_bf16 v[4:7], v[244:247], v[224:227], v[4:7]
 v_mfma_f32_16x16x32_bf16 v[8:11], v[246:249], v[32:35], v[8:11]
 v_mfma_f32_16x16x32_bf16 v[8:11], v[246:249], v[48:51], v[8:11]
 s_waitcnt vmcnt(22)
 v_mfma_f32_16x16x32_bf16 v[8:11], v[246:249], v[228:231], v[8:11]
 v_mfma_f32_16x16x32_bf16 v[12:15], v[244:247], v[32:35], v[12:15]
 v_mfma_f32_16x16x32_bf16 v[12:15], v[244:247], v[48:51], v[12:15]
 v_mfma_f32_16x16x32_bf16 v[12:15], v[244:247], v[228:231], v[12:15]
 v_mfma_f32_16x16x32_bf16 v[16:19], v[246:249], v[36:39], v[16:19]
 v_mfma_f32_16x16x32_bf16 v[16:19], v[246:249], v[52:55], v[16:19]
 s_waitcnt vmcnt(21)
 v_mfma_f32_16x16x32_bf16 v[16:19], v[246:249], v[232:235], v[16:19]
 v_mfma_f32_16x16x32_bf16 v[20:23], v[244:247], v[36:39], v[20:23]
 v_mfma_f32_16x16x32_bf16 v[20:23], v[244:247], v[52:55], v[20:23]
 v_mfma_f32_16x16x32_bf16 v[20:23], v[244:247], v[232:235], v[20:23]
 v_mfma_f32_16x16x32_bf16 v[24:27], v[246:249], v[40:43], v[24:27]
 v_mfma_f32_16x16x32_bf16 v[24:27], v[246:249], v[220:223], v[24:27]
 s_waitcnt vmcnt(20)
 v_mfma_f32_16x16x32_bf16 v[24:27], v[246:249], v[236:239], v[24:27]
 v_cvt_pk_bf16_f32 v0, v0, v1
 v_cvt_pk_bf16_f32 v1, v2, v3
 s_mov_b32 s55, 0
 buffer_store_dwordx2 v[0:1], v211, s[16:19], s55 offen
 v_cvt_pk_bf16_f32 v4, v4, v5
 v_cvt_pk_bf16_f32 v5, v6, v7
 s_mov_b32 s55, 65536
 buffer_store_dwordx2 v[4:5], v211, s[16:19], s55 offen
 v_cvt_pk_bf16_f32 v8, v8, v9
 v_cvt_pk_bf16_f32 v9, v10, v11
 s_mov_b32 s55, 131072
 buffer_store_dwordx2 v[8:9], v211, s[16:19], s55 offen
 v_cvt_pk_bf16_f32 v12, v12, v13
 v_cvt_pk_bf16_f32 v13, v14, v15
 s_mov_b32 s55, 196608
 buffer_store_dwordx2 v[12:13], v211, s[16:19], s55 offen
 v_cvt_pk_bf16_f32 v16, v16, v17
 v_cvt_pk_bf16_f32 v17, v18, v19
 s_mov_b32 s55, 262144
 buffer_store_dwordx2 v[16:17], v211, s[16:19], s55 offen
 v_cvt_pk_bf16_f32 v20, v20, v21
 v_cvt_pk_bf16_f32 v21, v22, v23
 s_mov_b32 s55, 327680
 buffer_store_dwordx2 v[20:21], v211, s[16:19], s55 offen
 v_cvt_pk_bf16_f32 v24, v24, v25
 v_cvt_pk_bf16_f32 v25, v26, v27
 s_mov_b32 s55, 393216
 buffer_store_dwordx2 v[24:25], v211, s[16:19], s55 offen
 s_waitcnt vmcnt(18)
 v_max3_u32 v185, v112, v113, v114
 s_waitcnt vmcnt(17)
 v_max3_u32 v185, v185, v115, v116
 v_max3_u32 v185, v185, v117, v118
 s_waitcnt vmcnt(16)
 v_max3_u32 v185, v185, v119, v120
 v_max3_u32 v185, v185, v121, v122
 s_waitcnt vmcnt(15)
 v_max3_u32 v185, v185, v123, v124
 s_waitcnt vmcnt(14)
 v_max3_u32 v185, v185, v125, v128
 v_max3_u32 v185, v185, v129, v130
 s_waitcnt vmcnt(13)
 v_max3_u32 v185, v185, v131, v132
 v_max3_u32 v185, v185, v133, v134
 s_waitcnt vmcnt(12)
 v_max3_u32 v185, v185, v135, v136
 v_max3_u32 v185, v185, v137, v138
 s_waitcnt vmcnt(11)
 v_max3_u32 v185, v185, v139, v140
 s_waitcnt vmcnt(10)
 v_max3_u32 v185, v185, v141, v144
 v_max3_u32 v185, v185, v145, v146
 s_waitcnt vmcnt(9)
 v_max3_u32 v185, v185, v147, v148
 v_max3_u32 v185, v185, v149, v150
 s_waitcnt vmcnt(8)
 v_max3_u32 v185, v185, v151, v152
 v_max3_u32 v185, v185, v153, v154
 s_waitcnt vmcnt(7)
 v_max3_u32 v185, v185, v155, v156
 v_max3_u32 v185, v185, v157, v157
 v_cmp_eq_u32 vcc, -1, v185
 s_cbranch_vccnz L_refetch
L_fetched:
 v_mfma_f32_16x16x32_bf16 v[56:59], v[246:249], v[112:115], v[56:59]
 v_mfma_f32_16x16x32_bf16 v[56:59], v[246:249], v[128:131], v[56:59]
 v_mfma_f32_16x16x32_bf16 v[56:59], v[246:249], v[144:147], v[56:59]
 v_mfma_f32_16x16x32_bf16 v[60:63], v[244:247], v[112:115], v[60:63]
 v_mfma_f32_16x16x32_bf16 v[60:63], v[244:247], v[128:131], v[60:63]
 v_mfma_f32_16x16x32_bf16 v[60:63], v[244:247], v[144:147], v[60:63]
 v_mfma_f32_16x16x32_bf16 v[64:67], v[246:249], v[116:119], v[64:67]
 v_mfma_f32_16x16x32_bf16 v[64:67], v[246:249], v[132:135], v[64:67]
 v_mfma_f32_16x16x32_bf16 v[64:67], v[246:249], v[148:151], v[64:67]
 v_mfma_f32_16x16x32_bf16 v[68:71], v[244:247], v[116:119], v[68:71]
 s_nop 0
 v_cvt_pk_bf16_f32 v56, v56, v57
 v_cvt_pk_bf16_f32 v57, v58, v59
 v_mfma_f32_16x16x32_bf16 v[68:71], v[244:247], v[132:135], v[68:71]
 s_mov_b32 s55, 458752
 buffer_store_dwordx2 v[56:57], v211, s[16:19], s55 offen
 v_mfma_f32_16x16x32_bf16 v[68:71], v[244:247], v[148:151], v[68:71]
 v_mfma_f32_16x16x32_bf16 v[72:75], v[246:249], v[120:123], v[72:75]
 v_cvt_pk_bf16_f32 v60, v60, v61
 v_cvt_pk_bf16_f32 v61, v62, v63
 v_mfma_f32_16x16x32_bf16 v[72:75], v[246:249], v[136:139], v[72:75]
 s_mov_b32 s55, 524288
 buffer_store_dwordx2 v[60:61], v211, s[16:19], s55 offen
 v_mfma_f32_16x16x32_bf16 v[72:75], v[246:249], v[152:155], v[72:75]
 v_mfma_f32_16x16x32_bf16 v[76:79], v[244:247], v[120:123], v[76:79]
 v_cvt_pk_bf16_f32 v64, v64, v65
 v_cvt_pk_bf16_f32 v65, v66, v67
 v_mfma_f32_16x16x32_bf16 v[76:79], v[244:247], v[136:139], v[76:79]
 s_mov_b32 s55, 589824
 buffer_store_dwordx2 v[64:65], v211, s[16:19], s55 offen
 v_mfma_f32_16x16x32_bf16 v[76:79], v[244:247], v[152:155], v[76:79]
 v_mfma_f32_16x16x32_bf16 v[80:83], v[246:249], v[124:127], v[80:83]
 v_cvt_pk_bf16_f32 v68, v68, v69
 v_cvt_pk_bf16_f32 v69, v70, v71
 v_mfma_f32_16x16x32_bf16 v[80:83], v[246:249], v[140:143], v[80:83]
 s_mov_b32 s55, 655360
 buffer_store_dwordx2 v[68:69], v211, s[16:19], s55 offen
 v_mfma_f32_16x16x32_bf16 v[80:83], v[246:249], v[156:159], v[80:83]
 v_cvt_pk_bf16_f32 v72, v72, v73
 v_cvt_pk_bf16_f32 v73, v74, v75
 s_mov_b32 s55, 720896
 buffer_store_dwordx2 v[72:73], v211, s[16:19], s55 offen
 v_cvt_pk_bf16_f32 v76, v76, v77
 v_cvt_pk_bf16_f32 v77, v78, v79
 s_mov_b32 s55, 786432
 buffer_store_dwordx2 v[76:77], v211, s[16:19], s55 offen
 v_cvt_pk_bf16_f32 v80, v80, v81
 v_cvt_pk_bf16_f32 v81, v82, v83
 s_mov_b32 s55, 851968
 buffer_store_dwordx2 v[80:81], v211, s[16:19], s55 offen
L_end:
 s_endpgm
L_refetch:
 s_mov_b32 s43, 0x40000
L_refetch_l:
 s_add_u32 s59, s58, 86016
 buffer_load_dwordx4 v[112:115], v254, s[44:47], s59 offen offset:0 sc1
 buffer_load_dwordx4 v[116:119], v254, s[44:47], s59 offen offset:1024 sc1
 buffer_load_dwordx4 v[120:123], v254, s[44:47], s59 offen offset:2048 sc1
 v_mov_b32 v126, 0
 v_mov_b32 v127, 0
 buffer_load_dwordx2 v[124:125], v255, s[44:47], s59 offen offset:0 sc1
 s_add_u32 s59, s58, 93184
 buffer_load_dwordx4 v[128:131], v254, s[44:47], s59 offen offset:0 sc1
 buffer_load_dwordx4 v[132:135], v254, s[44:47], s59 offen offset:1024 sc1
 buffer_load_dwordx4 v[136:139], v254, s[44:47], s59 offen offset:2048 sc1
 v_mov_b32 v142, 0
 v_mov_b32 v143, 0
 buffer_load_dwordx2 v[140:141], v255, s[44:47], s59 offen offset:0 sc1
 s_add_u32 s59, s58, 100352
 buffer_load_dwordx4 v[144:147], v254, s[44:47], s59 offen offset:0 sc1
 buffer_load_dwordx4 v[148:151], v254, s[44:47], s59 offen offset:1024 sc1
 buffer_load_dwordx4 v[152:155], v254, s[44:47], s59 offen offset:2048 sc1
 v_mov_b32 v158, 0
 v_mov_b32 v159, 0
 buffer_load_dwordx2 v[156:157], v255, s[44:47], s59 offen offset:0 sc1
 s_waitcnt vmcnt(0)
 v_max3_u32 v185, v112, v113, v114
 v_max3_u32 v185, v185, v115, v116
 v_max3_u32 v185, v185, v117, v118
 v_max3_u32 v185, v185, v119, v120
 v_max3_u32 v185, v185, v121, v122
 v_max3_u32 v185, v185, v123, v124
 v_max3_u32 v185, v185, v125, v128
 v_max3_u32 v185, v185, v129, v130
 v_max3_u32 v185, v185, v131, v132
 v_max3_u32 v185, v185, v133, v134
 v_max3_u32 v185, v185, v135, v136
 v_max3_u32 v185, v185, v137, v138
 v_max3_u32 v185, v185, v139, v140
 v_max3_u32 v185, v185, v141, v144
 v_max3_u32 v185, v185, v145, v146
 v_max3_u32 v185, v185, v147, v148
 v_max3_u32 v185, v185, v149, v150
 v_max3_u32 v185, v185, v151, v152
 v_max3_u32 v185, v185, v153, v154
 v_max3_u32 v185, v185, v155, v156
 v_max3_u32 v185, v185, v157, v157
 v_cmp_eq_u32 vcc, -1, v185
 s_cbranch_vccz L_fetched
 s_sub_u32 s43, s43, 1
 s_cmp_lg_u32 s43, 0
 s_cbranch_scc1 L_refetch_l
 s_branch L_fetched
L_spin0:
 s_mov_b32 s43, 0x100000
L_spin0_l:
 buffer_load_dword v216, v197, s[92:95], 0 offen offset:0 sc1
 s_waitcnt vmcnt(0)
 v_cmp_eq_u32 vcc, 1, v216
 s_nop 3
 s_and_b32 s42, vcc_lo, 1
 s_cmp_eq_u32 s42, 1
 s_cbranch_scc1 L_spun0
 s_sleep 1
 s_sub_u32 s43, s43, 1
 s_cmp_lg_u32 s43, 0
 s_cbranch_scc1 L_spin0_l
 s_branch L_spun0
L_spin1:
 s_mov_b32 s43, 0x100000
L_spin1_l:
 buffer_load_dword v216, v197, s[92:95], 0 offen offset:0 sc1
 s_waitcnt vmcnt(0)
 v_cmp_eq_u32 vcc, 1, v216
 s_nop 3
 s_and_b32 s42, vcc_lo, 255
 s_cmp_eq_u32 s42, 255
 s_cbranch_scc1 L_spun1
 s_sleep 1
 s_sub_u32 s43, s43, 1
 s_cmp_lg_u32 s43, 0
 s_cbranch_scc1 L_spin1_l
 s_branch L_spun1
L_spin2:
 s_mov_b32 s43, 0x100000
L_spin2_l:
 buffer_load_dword v216, v197, s[92:95], 0 offen offset:32 sc1
 s_waitcnt vmcnt(0)
 v_cmp_eq_u32 vcc, 1, v216
 s_nop 3
 s_and_b32 s42, vcc_lo, 255
 s_cmp_eq_u32 s42, 255
 s_cbranch_scc1 L_spun2
 s_sleep 1
 s_sub_u32 s43, s43, 1
 s_cmp_lg_u32 s43, 0
 s_cbranch_scc1 L_spin2_l
 s_branch L_spun2
L_spin3:
 s_mov_b32 s43, 0x100000
L_spin3_l:
 buffer_load_dword v216, v197, s[96:99], 0 offen offset:0 sc1
 s_waitcnt vmcnt(0)
 v_cmp_eq_u32 vcc, 1, v216
 s_nop 3
 s_and_b32 s42, vcc_lo, 15
 s_cmp_eq_u32 s42, 15
 s_cbranch_scc1 L_spun3
 s_sleep 1
 s_sub_u32 s43, s43, 1
 s_cmp_lg_u32 s43, 0
 s_cbranch_scc1 L_spin3_l
 s_branch L_spun3
L_stub0:
 s_call_b64 s[40:41], L_rare011
 s_branch L_back0
L_stub1:
 s_call_b64 s[40:41], L_rare001
 s_branch L_back1
L_stub2:
 s_call_b64 s[40:41], L_rare011
 s_branch L_back2
L_stub3:
 s_call_b64 s[40:41], L_rare001
 s_branch L_back3
L_stub4:
 s_call_b64 s[40:41], L_rare011
 s_branch L_back4
L_stub5:
 s_call_b64 s[40:41], L_rare001
 s_branch L_back5
L_stub6:
 s_call_b64 s[40:41], L_rare011
 s_branch L_back6
L_stub7:
 s_call_b64 s[40:41], L_rare001
 s_branch L_back7
L_stub8:
 s_call_b64 s[40:41], L_rare011
 s_branch L_back8
L_stub9:
 s_call_b64 s[40:41], L_rare001
 s_branch L_back9
L_stub10:
 s_call_b64 s[40:41], L_rare011
 s_branch L_back10
L_stub11:
 s_call_b64 s[40:41], L_rare001
 s_branch L_back11
L_stub12:
 s_call_b64 s[40:41], L_rare011
 s_branch L_back12
L_stub13:
 s_call_b64 s[40:41], L_rare001
 s_branch L_back13
L_stub14:
 s_call_b64 s[40:41], L_rare010
 s_branch L_back14
L_stub15:
 s_call_b64 s[40:41], L_rare111
 s_branch L_back15
L_stub16:
 s_call_b64 s[40:41], L_rare101
 s_branch L_back16
L_stub17:
 s_call_b64 s[40:41], L_rare111
 s_branch L_back17
L_stub18:
 s_call_b64 s[40:41], L_rare101
 s_branch L_back18
L_stub19:
 s_call_b64 s[40:41], L_rare111
 s_branch L_back19
L_stub20:
 s_call_b64 s[40:41], L_rare101
 s_branch L_back20
L_stub21:
 s_call_b64 s[40:41], L_rare111
 s_branch L_back21
L_stub22:
 s_call_b64 s[40:41], L_rare101
 s_branch L_back22
L_stub23:
 s_call_b64 s[40:41], L_rare111
 s_branch L_back23
L_stub24:
 s_call_b64 s[40:41], L_rare101
 s_branch L_back24
L_stub25:
 s_call_b64 s[40:41], L_rare111
 s_branch L_back25
L_stub26:
 s_call_b64 s[40:41], L_rare101
 s_branch L_back26
L_stub27:
 s_call_b64 s[40:41], L_rare111
 s_branch L_back27
L_stub28:
 s_call_b64 s[40:41], L_rare101
 s_branch L_back28
L_stub29:
 s_call_b64 s[40:41], L_rare110
 s_branch L_back29
L_rare011:
 s_nop 11
 v_max3_f32 v185, v16, v17, v18
 v_max3_f32 v185, v185, v19, v20
 v_max3_f32 v185, v185, v21, v22
 v_max3_f32 v185, v185, v23, v24
 v_max3_f32 v185, v185, v25, v26
 v_max3_f32 v185, v185, v27, v28
 v_max3_f32 v185, v185, v29, v30
 v_max_f32 v185, v185, v31
 v_mov_b32 v186, v185
 s_nop 1
 v_permlane32_swap_b32 v185, v186
 v_max3_f32 v185, v185, v186, 0
 v_sub_f32 v217, 0, v185
 v_exp_f32 v217, v217
 v_sub_f32 v128, v128, v185
 v_sub_f32 v16, v16, v185
 v_sub_f32 v0, v0, v185
 v_sub_f32 v129, v129, v185
 v_sub_f32 v17, v17, v185
 v_sub_f32 v1, v1, v185
 v_sub_f32 v130, v130, v185
 v_sub_f32 v18, v18, v185
 v_sub_f32 v2, v2, v185
 v_sub_f32 v131, v131, v185
 v_sub_f32 v19, v19, v185
 v_sub_f32 v3, v3, v185
 v_sub_f32 v132, v132, v185
 v_sub_f32 v20, v20, v185
 v_sub_f32 v4, v4, v185
 v_sub_f32 v133, v133, v185
 v_sub_f32 v21, v21, v185
 v_sub_f32 v5, v5, v185
 v_sub_f32 v134, v134, v185
 v_sub_f32 v22, v22, v185
 v_sub_f32 v6, v6, v185
 v_sub_f32 v135, v135, v185
 v_sub_f32 v23, v23, v185
 v_sub_f32 v7, v7, v185
 v_sub_f32 v136, v136, v185
 v_sub_f32 v24, v24, v185
 v_sub_f32 v8, v8, v185
 v_sub_f32 v137, v137, v185
 v_sub_f32 v25, v25, v185
 v_sub_f32 v9, v9, v185
 v_sub_f32 v138, v138, v185
 v_sub_f32 v26, v26, v185
 v_sub_f32 v10, v10, v185
 v_sub_f32 v139, v139, v185
 v_sub_f32 v27, v27, v185
 v_sub_f32 v11, v11, v185
 v_sub_f32 v140, v140, v185
 v_sub_f32 v28, v28, v185
 v_sub_f32 v12, v12, v185
 v_sub_f32 v141, v141, v185
 v_sub_f32 v29, v29, v185
 v_sub_f32 v13, v13, v185
 v_sub_f32 v142, v142, v185
 v_sub_f32 v30, v30, v185
 v_sub_f32 v14, v14, v185
 v_sub_f32 v143, v143, v185
 v_sub_f32 v31, v31, v185
 v_sub_f32 v15, v15, v185
 v_mul_f32 v218, v217, v218
 v_mul_f32 v48, v217, v48
 v_mul_f32 v49, v217, v49
 v_mul_f32 v50, v217, v50
 v_mul_f32 v51, v217, v51
 v_mul_f32 v52, v217, v52
 v_mul_f32 v53, v217, v53
 v_mul_f32 v54, v217, v54
 v_mul_f32 v55, v217, v55
 v_mul_f32 v56, v217, v56
 v_mul_f32 v57, v217, v57
 v_mul_f32 v58, v217, v58
 v_mul_f32 v59, v217, v59
 v_mul_f32 v60, v217, v60
 v_mul_f32 v61, v217, v61
 v_mul_f32 v62, v217, v62
 v_mul_f32 v63, v217, v63
 v_mul_f32 v64, v217, v64
 v_mul_f32 v65, v217, v65
 v_mul_f32 v66, v217, v66
 v_mul_f32 v67, v217, v67
 v_mul_f32 v68, v217, v68
 v_mul_f32 v69, v217, v69
 v_mul_f32 v70, v217, v70
 v_mul_f32 v71, v217, v71
 v_mul_f32 v72, v217, v72
 v_mul_f32 v73, v217, v73
 v_mul_f32 v74, v217, v74
 v_mul_f32 v75, v217, v75
 v_mul_f32 v76, v217, v76
 v_mul_f32 v77, v217, v77
 v_mul_f32 v78, v217, v78
 v_mul_f32 v79, v217, v79
 v_mul_f32 v80, v217, v80
 v_mul_f32 v81, v217, v81
 v_mul_f32 v82, v217, v82
 v_mul_f32 v83, v217, v83
 v_mul_f32 v84, v217, v84
 v_mul_f32 v85, v217, v85
 v_mul_f32 v86, v217, v86
 v_mul_f32 v87, v217, v87
 v_mul_f32 v88, v217, v88
 v_mul_f32 v89, v217, v89
 v_mul_f32 v90, v217, v90
 v_mul_f32 v91, v217, v91
 v_mul_f32 v92, v217, v92
 v_mul_f32 v93, v217, v93
 v_mul_f32 v94, v217, v94
 v_mul_f32 v95, v217, v95
 v_mul_f32 v96, v217, v96
 v_mul_f32 v97, v217, v97
 v_mul_f32 v98, v217, v98
 v_mul_f32 v99, v217, v99
 v_mul_f32 v100, v217, v100
 v_mul_f32 v101, v217, v101
 v_mul_f32 v102, v217, v102
 v_mul_f32 v103, v217, v103
 v_mul_f32 v104, v217, v104
 v_mul_f32 v105, v217, v105
 v_mul_f32 v106, v217, v106
 v_mul_f32 v107, v217, v107
 v_mul_f32 v108, v217, v108
 v_mul_f32 v109, v217, v109
 v_mul_f32 v110, v217, v110
 v_mul_f32 v111, v217, v111
 v_exp_f32 v112, v16
 v_exp_f32 v113, v17
 v_exp_f32 v114, v18
 v_exp_f32 v115, v19
 v_add_f32 v215, v112, v113
 v_cvt_pk_bf16_f32 v40, v112, v113
 v_exp_f32 v116, v20
 v_exp_f32 v117, v21
 v_add_f32 v215, v215, v114
 v_add_f32 v215, v215, v115
 v_cvt_pk_bf16_f32 v41, v114, v115
 v_exp_f32 v118, v22
 v_exp_f32 v119, v23
 v_add_f32 v215, v215, v116
 v_add_f32 v215, v215, v117
 v_cvt_pk_bf16_f32 v42, v116, v117
 v_exp_f32 v120, v24
 v_exp_f32 v121, v25
 v_add_f32 v215, v215, v118
 v_add_f32 v215, v215, v119
 v_cvt_pk_bf16_f32 v43, v118, v119
 v_exp_f32 v122, v26
 v_exp_f32 v123, v27
 v_add_f32 v215, v215, v120
 v_add_f32 v215, v215, v121
 v_cvt_pk_bf16_f32 v44, v120, v121
 v_exp_f32 v124, v28
 v_exp_f32 v125, v29
 v_add_f32 v215, v215, v122
 v_add_f32 v215, v215, v123
 v_cvt_pk_bf16_f32 v45, v122, v123
 v_exp_f32 v126, v30
 v_exp_f32 v127, v31
 v_add_f32 v215, v215, v124
 v_add_f32 v215, v215, v125
 v_cvt_pk_bf16_f32 v46, v124, v125
 v_add_f32 v215, v215, v126
 v_add_f32 v215, v215, v127
 v_cvt_pk_bf16_f32 v47, v126, v127
 s_nop 1
 s_setpc_b64 s[40:41]
L_rare001:
 s_nop 11
 v_max3_f32 v185, v0, v1, v2
 v_max3_f32 v185, v185, v3, v4
 v_max3_f32 v185, v185, v5, v6
 v_max3_f32 v185, v185, v7, v8
 v_max3_f32 v185, v185, v9, v10
 v_max3_f32 v185, v185, v11, v12
 v_max3_f32 v185, v185, v13, v14
 v_max_f32 v185, v185, v15
 v_mov_b32 v186, v185
 s_nop 1
 v_permlane32_swap_b32 v185, v186
 v_max3_f32 v185, v185, v186, 0
 v_sub_f32 v217, 0, v185
 v_exp_f32 v217, v217
 v_sub_f32 v128, v128, v185
 v_sub_f32 v0, v0, v185
 v_sub_f32 v16, v16, v185
 v_sub_f32 v129, v129, v185
 v_sub_f32 v1, v1, v185
 v_sub_f32 v17, v17, v185
 v_sub_f32 v130, v130, v185
 v_sub_f32 v2, v2, v185
 v_sub_f32 v18, v18, v185
 v_sub_f32 v131, v131, v185
 v_sub_f32 v3, v3, v185
 v_sub_f32 v19, v19, v185
 v_sub_f32 v132, v132, v185
 v_sub_f32 v4, v4, v185
 v_sub_f32 v20, v20, v185
 v_sub_f32 v133, v133, v185
 v_sub_f32 v5, v5, v185
 v_sub_f32 v21, v21, v185
 v_sub_f32 v134, v134, v185
 v_sub_f32 v6, v6, v185
 v_sub_f32 v22, v22, v185
 v_sub_f32 v135, v135, v185
 v_sub_f32 v7, v7, v185
 v_sub_f32 v23, v23, v185
 v_sub_f32 v136, v136, v185
 v_sub_f32 v8, v8, v185
 v_sub_f32 v24, v24, v185
 v_sub_f32 v137, v137, v185
 v_sub_f32 v9, v9, v185
 v_sub_f32 v25, v25, v185
 v_sub_f32 v138, v138, v185
 v_sub_f32 v10, v10, v185
 v_sub_f32 v26, v26, v185
 v_sub_f32 v139, v139, v185
 v_sub_f32 v11, v11, v185
 v_sub_f32 v27, v27, v185
 v_sub_f32 v140, v140, v185
 v_sub_f32 v12, v12, v185
 v_sub_f32 v28, v28, v185
 v_sub_f32 v141, v141, v185
 v_sub_f32 v13, v13, v185
 v_sub_f32 v29, v29, v185
 v_sub_f32 v142, v142, v185
 v_sub_f32 v14, v14, v185
 v_sub_f32 v30, v30, v185
 v_sub_f32 v143, v143, v185
 v_sub_f32 v15, v15, v185
 v_sub_f32 v31, v31, v185
 v_mul_f32 v218, v217, v218
 v_mul_f32 v48, v217, v48
 v_mul_f32 v49, v217, v49
 v_mul_f32 v50, v217, v50
 v_mul_f32 v51, v217, v51
 v_mul_f32 v52, v217, v52
 v_mul_f32 v53, v217, v53
 v_mul_f32 v54, v217, v54
 v_mul_f32 v55, v217, v55
 v_mul_f32 v56, v217, v56
 v_mul_f32 v57, v217, v57
 v_mul_f32 v58, v217, v58
 v_mul_f32 v59, v217, v59
 v_mul_f32 v60, v217, v60
 v_mul_f32 v61, v217, v61
 v_mul_f32 v62, v217, v62
 v_mul_f32 v63, v217, v63
 v_mul_f32 v64, v217, v64
 v_mul_f32 v65, v217, v65
 v_mul_f32 v66, v217, v66
 v_mul_f32 v67, v217, v67
 v_mul_f32 v68, v217, v68
 v_mul_f32 v69, v217, v69
 v_mul_f32 v70, v217, v70
 v_mul_f32 v71, v217, v71
 v_mul_f32 v72, v217, v72
 v_mul_f32 v73, v217, v73
 v_mul_f32 v74, v217, v74
 v_mul_f32 v75, v217, v75
 v_mul_f32 v76, v217, v76
 v_mul_f32 v77, v217, v77
 v_mul_f32 v78, v217, v78
 v_mul_f32 v79, v217, v79
 v_mul_f32 v80, v217, v80
 v_mul_f32 v81, v217, v81
 v_mul_f32 v82, v217, v82
 v_mul_f32 v83, v217, v83
 v_mul_f32 v84, v217, v84
 v_mul_f32 v85, v217, v85
 v_mul_f32 v86, v217, v86
 v_mul_f32 v87, v217, v87
 v_mul_f32 v88, v217, v88
 v_mul_f32 v89, v217, v89
 v_mul_f32 v90, v217, v90
 v_mul_f32 v91, v217, v91
 v_mul_f32 v92, v217, v92
 v_mul_f32 v93, v217, v93
 v_mul_f32 v94, v217, v94
 v_mul_f32 v95, v217, v95
 v_mul_f32 v96, v217, v96
 v_mul_f32 v97, v217, v97
 v_mul_f32 v98, v217, v98
 v_mul_f32 v99, v217, v99
 v_mul_f32 v100, v217, v100
 v_mul_f32 v101, v217, v101
 v_mul_f32 v102, v217, v102
 v_mul_f32 v103, v217, v103
 v_mul_f32 v104, v217, v104
 v_mul_f32 v105, v217, v105
 v_mul_f32 v106, v217, v106
 v_mul_f32 v107, v217, v107
 v_mul_f32 v108, v217, v108
 v_mul_f32 v109, v217, v109
 v_mul_f32 v110, v217, v110
 v_mul_f32 v111, v217, v111
 v_exp_f32 v112, v0
 v_exp_f32 v113, v1
 v_exp_f32 v114, v2
 v_exp_f32 v115, v3
 v_add_f32 v215, v112, v113
 v_cvt_pk_bf16_f32 v32, v112, v113
 v_exp_f32 v116, v4
 v_exp_f32 v117, v5
 v_add_f32 v215, v215, v114
 v_add_f32 v215, v215, v115
 v_cvt_pk_bf16_f32 v33, v114, v115
 v_exp_f32 v118, v6
 v_exp_f32 v119, v7
 v_add_f32 v215, v215, v116
 v_add_f32 v215, v215, v117
 v_cvt_pk_bf16_f32 v34, v116, v117
 v_exp_f32 v120, v8
 v_exp_f32 v121, v9
 v_add_f32 v215, v215, v118
 v_add_f32 v215, v215, v119
 v_cvt_pk_bf16_f32 v35, v118, v119
 v_exp_f32 v122, v10
 v_exp_f32 v123, v11
 v_add_f32 v215, v215, v120
 v_add_f32 v215, v215, v121
 v_cvt_pk_bf16_f32 v36, v120, v121
 v_exp_f32 v124, v12
 v_exp_f32 v125, v13
 v_add_f32 v215, v215, v122
 v_add_f32 v215, v215, v123
 v_cvt_pk_bf16_f32 v37, v122, v123
 v_exp_f32 v126, v14
 v_exp_f32 v127, v15
 v_add_f32 v215, v215, v124
 v_add_f32 v215, v215, v125
 v_cvt_pk_bf16_f32 v38, v124, v125
 v_add_f32 v215, v215, v126
 v_add_f32 v215, v215, v127
 v_cvt_pk_bf16_f32 v39, v126, v127
 s_nop 1
 s_setpc_b64 s[40:41]
L_rare010:
 s_nop 11
 v_max3_f32 v185, v16, v17, v18
 v_max3_f32 v185, v185, v19, v20
 v_max3_f32 v185, v185, v21, v22
 v_max3_f32 v185, v185, v23, v24
 v_max3_f32 v185, v185, v25, v26
 v_max3_f32 v185, v185, v27, v28
 v_max3_f32 v185, v185, v29, v30
 v_max_f32 v185, v185, v31
 v_mov_b32 v186, v185
 s_nop 1
 v_permlane32_swap_b32 v185, v186
 v_max3_f32 v185, v185, v186, 0
 v_sub_f32 v217, 0, v185
 v_exp_f32 v217, v217
 v_sub_f32 v128, v128, v185
 v_sub_f32 v16, v16, v185
 v_sub_f32 v129, v129, v185
 v_sub_f32 v17, v17, v185
 v_sub_f32 v130, v130, v185
 v_sub_f32 v18, v18, v185
 v_sub_f32 v131, v131, v185
 v_sub_f32 v19, v19, v185
 v_sub_f32 v132, v132, v185
 v_sub_f32 v20, v20, v185
 v_sub_f32 v133, v133, v185
 v_sub_f32 v21, v21, v185
 v_sub_f32 v134, v134, v185
 v_sub_f32 v22, v22, v185
 v_sub_f32 v135, v135, v185
 v_sub_f32 v23, v23, v185
 v_sub_f32 v136, v136, v185
 v_sub_f32 v24, v24, v185
 v_sub_f32 v137, v137, v185
 v_sub_f32 v25, v25, v185
 v_sub_f32 v138, v138, v185
 v_sub_f32 v26, v26, v185
 v_sub_f32 v139, v139, v185
 v_sub_f32 v27, v27, v185
 v_sub_f32 v140, v140, v185
 v_sub_f32 v28, v28, v185
 v_sub_f32 v141, v141, v185
 v_sub_f32 v29, v29, v185
 v_sub_f32 v142, v142, v185
 v_sub_f32 v30, v30, v185
 v_sub_f32 v143, v143, v185
 v_sub_f32 v31, v31, v185
 v_mul_f32 v218, v217, v218
 v_mul_f32 v48, v217, v48
 v_mul_f32 v49, v217, v49
 v_mul_f32 v50, v217, v50
 v_mul_f32 v51, v217, v51
 v_mul_f32 v52, v217, v52
 v_mul_f32 v53, v217, v53
 v_mul_f32 v54, v217, v54
 v_mul_f32 v55, v217, v55
 v_mul_f32 v56, v217, v56
 v_mul_f32 v57, v217, v57
 v_mul_f32 v58, v217, v58
 v_mul_f32 v59, v217, v59
 v_mul_f32 v60, v217, v60
 v_mul_f32 v61, v217, v61
 v_mul_f32 v62, v217, v62
 v_mul_f32 v63, v217, v63
 v_mul_f32 v64, v217, v64
 v_mul_f32 v65, v217, v65
 v_mul_f32 v66, v217, v66
 v_mul_f32 v67, v217, v67
 v_mul_f32 v68, v217, v68
 v_mul_f32 v69, v217, v69
 v_mul_f32 v70, v217, v70
 v_mul_f32 v71, v217, v71
 v_mul_f32 v72, v217, v72
 v_mul_f32 v73, v217, v73
 v_mul_f32 v74, v217, v74
 v_mul_f32 v75, v217, v75
 v_mul_f32 v76, v217, v76
 v_mul_f32 v77, v217, v77
 v_mul_f32 v78, v217, v78
 v_mul_f32 v79, v217, v79
 v_mul_f32 v80, v217, v80
 v_mul_f32 v81, v217, v81
 v_mul_f32 v82, v217, v82
 v_mul_f32 v83, v217, v83
 v_mul_f32 v84, v217, v84
 v_mul_f32 v85, v217, v85
 v_mul_f32 v86, v217, v86
 v_mul_f32 v87, v217, v87
 v_mul_f32 v88, v217, v88
 v_mul_f32 v89, v217, v89
 v_mul_f32 v90, v217, v90
 v_mul_f32 v91, v217, v91
 v_mul_f32 v92, v217, v92
 v_mul_f32 v93, v217, v93
 v_mul_f32 v94, v217, v94
 v_mul_f32 v95, v217, v95
 v_mul_f32 v96, v217, v96
 v_mul_f32 v97, v217, v97
 v_mul_f32 v98, v217, v98
 v_mul_f32 v99, v217, v99
 v_mul_f32 v100, v217, v100
 v_mul_f32 v101, v217, v101
 v_mul_f32 v102, v217, v102
 v_mul_f32 v103, v217, v103
 v_mul_f32 v104, v217, v104
 v_mul_f32 v105, v217, v105
 v_mul_f32 v106, v217, v106
 v_mul_f32 v107, v217, v107
 v_mul_f32 v108, v217, v108
 v_mul_f32 v109, v217, v109
 v_mul_f32 v110, v217, v110
 v_mul_f32 v111, v217, v111
 v_exp_f32 v112, v16
 v_exp_f32 v113, v17
 v_exp_f32 v114, v18
 v_exp_f32 v115, v19
 v_add_f32 v215, v112, v113
 v_cvt_pk_bf16_f32 v40, v112, v113
 v_exp_f32 v116, v20
 v_exp_f32 v117, v21
 v_add_f32 v215, v215, v114
 v_add_f32 v215, v215, v115
 v_cvt_pk_bf16_f32 v41, v114, v115
 v_exp_f32 v118, v22
 v_exp_f32 v119, v23
 v_add_f32 v215, v215, v116
 v_add_f32 v215, v215, v117
 v_cvt_pk_bf16_f32 v42, v116, v117
 v_exp_f32 v120, v24
 v_exp_f32 v121, v25
 v_add_f32 v215, v215, v118
 v_add_f32 v215, v215, v119
 v_cvt_pk_bf16_f32 v43, v118, v119
 v_exp_f32 v122, v26
 v_exp_f32 v123, v27
 v_add_f32 v215, v215, v120
 v_add_f32 v215, v215, v121
 v_cvt_pk_bf16_f32 v44, v120, v121
 v_exp_f32 v124, v28
 v_exp_f32 v125, v29
 v_add_f32 v215, v215, v122
 v_add_f32 v215, v215, v123
 v_cvt_pk_bf16_f32 v45, v122, v123
 v_exp_f32 v126, v30
 v_exp_f32 v127, v31
 v_add_f32 v215, v215, v124
 v_add_f32 v215, v215, v125
 v_cvt_pk_bf16_f32 v46, v124, v125
 v_add_f32 v215, v215, v126
 v_add_f32 v215, v215, v127
 v_cvt_pk_bf16_f32 v47, v126, v127
 s_nop 1
 s_setpc_b64 s[40:41]
L_rare111:
 s_nop 11
 v_max3_f32 v185, v16, v17, v18
 v_max3_f32 v185, v185, v19, v20
 v_max3_f32 v185, v185, v21, v22
 v_max3_f32 v185, v185, v23, v24
 v_max3_f32 v185, v185, v25, v26
 v_max3_f32 v185, v185, v27, v28
 v_max3_f32 v185, v185, v29, v30
 v_max_f32 v185, v185, v31
 v_mov_b32 v186, v185
 s_nop 1
 v_permlane32_swap_b32 v185, v186
 v_max3_f32 v185, v185, v186, 0
 v_sub_f32 v217, 0, v185
 v_exp_f32 v217, v217
 v_sub_f32 v128, v128, v185
 v_sub_f32 v16, v16, v185
 v_sub_f32 v0, v0, v185
 v_sub_f32 v129, v129, v185
 v_sub_f32 v17, v17, v185
 v_sub_f32 v1, v1, v185
 v_sub_f32 v130, v130, v185
 v_sub_f32 v18, v18, v185
 v_sub_f32 v2, v2, v185
 v_sub_f32 v131, v131, v185
 v_sub_f32 v19, v19, v185
 v_sub_f32 v3, v3, v185
 v_sub_f32 v132, v132, v185
 v_sub_f32 v20, v20, v185
 v_sub_f32 v4, v4, v185
 v_sub_f32 v133, v133, v185
 v_sub_f32 v21, v21, v185
 v_sub_f32 v5, v5, v185
 v_sub_f32 v134, v134, v185
 v_sub_f32 v22, v22, v185
 v_sub_f32 v6, v6, v185
 v_sub_f32 v135, v135, v185
 v_sub_f32 v23, v23, v185
 v_sub_f32 v7, v7, v185
 v_sub_f32 v136, v136, v185
 v_sub_f32 v24, v24, v185
 v_sub_f32 v8, v8, v185
 v_sub_f32 v137, v137, v185
 v_sub_f32 v25, v25, v185
 v_sub_f32 v9, v9, v185
 v_sub_f32 v138, v138, v185
 v_sub_f32 v26, v26, v185
 v_sub_f32 v10, v10, v185
 v_sub_f32 v139, v139, v185
 v_sub_f32 v27, v27, v185
 v_sub_f32 v11, v11, v185
 v_sub_f32 v140, v140, v185
 v_sub_f32 v28, v28, v185
 v_sub_f32 v12, v12, v185
 v_sub_f32 v141, v141, v185
 v_sub_f32 v29, v29, v185
 v_sub_f32 v13, v13, v185
 v_sub_f32 v142, v142, v185
 v_sub_f32 v30, v30, v185
 v_sub_f32 v14, v14, v185
 v_sub_f32 v143, v143, v185
 v_sub_f32 v31, v31, v185
 v_sub_f32 v15, v15, v185
 v_mul_f32 v219, v217, v219
 v_mul_f32 v48, v217, v48
 v_mul_f32 v49, v217, v49
 v_mul_f32 v50, v217, v50
 v_mul_f32 v51, v217, v51
 v_mul_f32 v52, v217, v52
 v_mul_f32 v53, v217, v53
 v_mul_f32 v54, v217, v54
 v_mul_f32 v55, v217, v55
 v_mul_f32 v56, v217, v56
 v_mul_f32 v57, v217, v57
 v_mul_f32 v58, v217, v58
 v_mul_f32 v59, v217, v59
 v_mul_f32 v60, v217, v60
 v_mul_f32 v61, v217, v61
 v_mul_f32 v62, v217, v62
 v_mul_f32 v63, v217, v63
 v_mul_f32 v64, v217, v64
 v_mul_f32 v65, v217, v65
 v_mul_f32 v66, v217, v66
 v_mul_f32 v67, v217, v67
 v_mul_f32 v68, v217, v68
 v_mul_f32 v69, v217, v69
 v_mul_f32 v70, v217, v70
 v_mul_f32 v71, v217, v71
 v_mul_f32 v72, v217, v72
 v_mul_f32 v73, v217, v73
 v_mul_f32 v74, v217, v74
 v_mul_f32 v75, v217, v75
 v_mul_f32 v76, v217, v76
 v_mul_f32 v77, v217, v77
 v_mul_f32 v78, v217, v78
 v_mul_f32 v79, v217, v79
 v_mul_f32 v80, v217, v80
 v_mul_f32 v81, v217, v81
 v_mul_f32 v82, v217, v82
 v_mul_f32 v83, v217, v83
 v_mul_f32 v84, v217, v84
 v_mul_f32 v85, v217, v85
 v_mul_f32 v86, v217, v86
 v_mul_f32 v87, v217, v87
 v_mul_f32 v88, v217, v88
 v_mul_f32 v89, v217, v89
 v_mul_f32 v90, v217, v90
 v_mul_f32 v91, v217, v91
 v_mul_f32 v92, v217, v92
 v_mul_f32 v93, v217, v93
 v_mul_f32 v94, v217, v94
 v_mul_f32 v95, v217, v95
 v_mul_f32 v96, v217, v96
 v_mul_f32 v97, v217, v97
 v_mul_f32 v98, v217, v98
 v_mul_f32 v99, v217, v99
 v_mul_f32 v100, v217, v100
 v_mul_f32 v101, v217, v101
 v_mul_f32 v102, v217, v102
 v_mul_f32 v103, v217, v103
 v_mul_f32 v104, v217, v104
 v_mul_f32 v105, v217, v105
 v_mul_f32 v106, v217, v106
 v_mul_f32 v107, v217, v107
 v_mul_f32 v108, v217, v108
 v_mul_f32 v109, v217, v109
 v_mul_f32 v110, v217, v110
 v_mul_f32 v111, v217, v111
 v_exp_f32 v112, v16
 v_exp_f32 v113, v17
 v_exp_f32 v114, v18
 v_exp_f32 v115, v19
 v_add_f32 v215, v112, v113
 v_cvt_pk_bf16_f32 v40, v112, v113
 v_exp_f32 v116, v20
 v_exp_f32 v117, v21
 v_add_f32 v215, v215, v114
 v_add_f32 v215, v215, v115
 v_cvt_pk_bf16_f32 v41, v114, v115
 v_exp_f32 v118, v22
 v_exp_f32 v119, v23
 v_add_f32 v215, v215, v116
 v_add_f32 v215, v215, v117
 v_cvt_pk_bf16_f32 v42, v116, v117
 v_exp_f32 v120, v24
 v_exp_f32 v121, v25
 v_add_f32 v215, v215, v118
 v_add_f32 v215, v215, v119
 v_cvt_pk_bf16_f32 v43, v118, v119
 v_exp_f32 v122, v26
 v_exp_f32 v123, v27
 v_add_f32 v215, v215, v120
 v_add_f32 v215, v215, v121
 v_cvt_pk_bf16_f32 v44, v120, v121
 v_exp_f32 v124, v28
 v_exp_f32 v125, v29
 v_add_f32 v215, v215, v122
 v_add_f32 v215, v215, v123
 v_cvt_pk_bf16_f32 v45, v122, v123
 v_exp_f32 v126, v30
 v_exp_f32 v127, v31
 v_add_f32 v215, v215, v124
 v_add_f32 v215, v215, v125
 v_cvt_pk_bf16_f32 v46, v124, v125
 v_add_f32 v215, v215, v126
 v_add_f32 v215, v215, v127
 v_cvt_pk_bf16_f32 v47, v126, v127
 s_nop 1
 s_setpc_b64 s[40:41]
L_rare101:
 s_nop 11
 v_max3_f32 v185, v0, v1, v2
 v_max3_f32 v185, v185, v3, v4
 v_max3_f32 v185, v185, v5, v6
 v_max3_f32 v185, v185, v7, v8
 v_max3_f32 v185, v185, v9, v10
 v_max3_f32 v185, v185, v11, v12
 v_max3_f32 v185, v185, v13, v14
 v_max_f32 v185, v185, v15
 v_mov_b32 v186, v185
 s_nop 1
 v_permlane32_swap_b32 v185, v186
 v_max3_f32 v185, v185, v186, 0
 v_sub_f32 v217, 0, v185
 v_exp_f32 v217, v217
 v_sub_f32 v128, v128, v185
 v_sub_f32 v0, v0, v185
 v_sub_f32 v16, v16, v185
 v_sub_f32 v129, v129, v185
 v_sub_f32 v1, v1, v185
 v_sub_f32 v17, v17, v185
 v_sub_f32 v130, v130, v185
 v_sub_f32 v2, v2, v185
 v_sub_f32 v18, v18, v185
 v_sub_f32 v131, v131, v185
 v_sub_f32 v3, v3, v185
 v_sub_f32 v19, v19, v185
 v_sub_f32 v132, v132, v185
 v_sub_f32 v4, v4, v185
 v_sub_f32 v20, v20, v185
 v_sub_f32 v133, v133, v185
 v_sub_f32 v5, v5, v185
 v_sub_f32 v21, v21, v185
 v_sub_f32 v134, v134, v185
 v_sub_f32 v6, v6, v185
 v_sub_f32 v22, v22, v185
 v_sub_f32 v135, v135, v185
 v_sub_f32 v7, v7, v185
 v_sub_f32 v23, v23, v185
 v_sub_f32 v136, v136, v185
 v_sub_f32 v8, v8, v185
 v_sub_f32 v24, v24, v185
 v_sub_f32 v137, v137, v185
 v_sub_f32 v9, v9, v185
 v_sub_f32 v25, v25, v185
 v_sub_f32 v138, v138, v185
 v_sub_f32 v10, v10, v185
 v_sub_f32 v26, v26, v185
 v_sub_f32 v139, v139, v185
 v_sub_f32 v11, v11, v185
 v_sub_f32 v27, v27, v185
 v_sub_f32 v140, v140, v185
 v_sub_f32 v12, v12, v185
 v_sub_f32 v28, v28, v185
 v_sub_f32 v141, v141, v185
 v_sub_f32 v13, v13, v185
 v_sub_f32 v29, v29, v185
 v_sub_f32 v142, v142, v185
 v_sub_f32 v14, v14, v185
 v_sub_f32 v30, v30, v185
 v_sub_f32 v143, v143, v185
 v_sub_f32 v15, v15, v185
 v_sub_f32 v31, v31, v185
 v_mul_f32 v219, v217, v219
 v_mul_f32 v48, v217, v48
 v_mul_f32 v49, v217, v49
 v_mul_f32 v50, v217, v50
 v_mul_f32 v51, v217, v51
 v_mul_f32 v52, v217, v52
 v_mul_f32 v53, v217, v53
 v_mul_f32 v54, v217, v54
 v_mul_f32 v55, v217, v55
 v_mul_f32 v56, v217, v56
 v_mul_f32 v57, v217, v57
 v_mul_f32 v58, v217, v58
 v_mul_f32 v59, v217, v59
 v_mul_f32 v60, v217, v60
 v_mul_f32 v61, v217, v61
 v_mul_f32 v62, v217, v62
 v_mul_f32 v63, v217, v63
 v_mul_f32 v64, v217, v64
 v_mul_f32 v65, v217, v65
 v_mul_f32 v66, v217, v66
 v_mul_f32 v67, v217, v67
 v_mul_f32 v68, v217, v68
 v_mul_f32 v69, v217, v69
 v_mul_f32 v70, v217, v70
 v_mul_f32 v71, v217, v71
 v_mul_f32 v72, v217, v72
 v_mul_f32 v73, v217, v73
 v_mul_f32 v74, v217, v74
 v_mul_f32 v75, v217, v75
 v_mul_f32 v76, v217, v76
 v_mul_f32 v77, v217, v77
 v_mul_f32 v78, v217, v78
 v_mul_f32 v79, v217, v79
 v_mul_f32 v80, v217, v80
 v_mul_f32 v81, v217, v81
 v_mul_f32 v82, v217, v82
 v_mul_f32 v83, v217, v83
 v_mul_f32 v84, v217, v84
 v_mul_f32 v85, v217, v85
 v_mul_f32 v86, v217, v86
 v_mul_f32 v87, v217, v87
 v_mul_f32 v88, v217, v88
 v_mul_f32 v89, v217, v89
 v_mul_f32 v90, v217, v90
 v_mul_f32 v91, v217, v91
 v_mul_f32 v92, v217, v92
 v_mul_f32 v93, v217, v93
 v_mul_f32 v94, v217, v94
 v_mul_f32 v95, v217, v95
 v_mul_f32 v96, v217, v96
 v_mul_f32 v97, v217, v97
 v_mul_f32 v98, v217, v98
 v_mul_f32 v99, v217, v99
 v_mul_f32 v100, v217, v100
 v_mul_f32 v101, v217, v101
 v_mul_f32 v102, v217, v102
 v_mul_f32 v103, v217, v103
 v_mul_f32 v104, v217, v104
 v_mul_f32 v105, v217, v105
 v_mul_f32 v106, v217, v106
 v_mul_f32 v107, v217, v107
 v_mul_f32 v108, v217, v108
 v_mul_f32 v109, v217, v109
 v_mul_f32 v110, v217, v110
 v_mul_f32 v111, v217, v111
 v_exp_f32 v112, v0
 v_exp_f32 v113, v1
 v_exp_f32 v114, v2
 v_exp_f32 v115, v3
 v_add_f32 v215, v112, v113
 v_cvt_pk_bf16_f32 v32, v112, v113
 v_exp_f32 v116, v4
 v_exp_f32 v117, v5
 v_add_f32 v215, v215, v114
 v_add_f32 v215, v215, v115
 v_cvt_pk_bf16_f32 v33, v114, v115
 v_exp_f32 v118, v6
 v_exp_f32 v119, v7
 v_add_f32 v215, v215, v116
 v_add_f32 v215, v215, v117
 v_cvt_pk_bf16_f32 v34, v116, v117
 v_exp_f32 v120, v8
 v_exp_f32 v121, v9
 v_add_f32 v215, v215, v118
 v_add_f32 v215, v215, v119
 v_cvt_pk_bf16_f32 v35, v118, v119
 v_exp_f32 v122, v10
 v_exp_f32 v123, v11
 v_add_f32 v215, v215, v120
 v_add_f32 v215, v215, v121
 v_cvt_pk_bf16_f32 v36, v120, v121
 v_exp_f32 v124, v12
 v_exp_f32 v125, v13
 v_add_f32 v215, v215, v122
 v_add_f32 v215, v215, v123
 v_cvt_pk_bf16_f32 v37, v122, v123
 v_exp_f32 v126, v14
 v_exp_f32 v127, v15
 v_add_f32 v215, v215, v124
 v_add_f32 v215, v215, v125
 v_cvt_pk_bf16_f32 v38, v124, v125
 v_add_f32 v215, v215, v126
 v_add_f32 v215, v215, v127
 v_cvt_pk_bf16_f32 v39, v126, v127
 s_nop 1
 s_setpc_b64 s[40:41]
L_rare110:
 s_nop 11
 v_max3_f32 v185, v16, v17, v18
 v_max3_f32 v185, v185, v19, v20
 v_max3_f32 v185, v185, v21, v22
 v_max3_f32 v185, v185, v23, v24
 v_max3_f32 v185, v185, v25, v26
 v_max3_f32 v185, v185, v27, v28
 v_max3_f32 v185, v185, v29, v30
 v_max_f32 v185, v185, v31
 v_mov_b32 v186, v185
 s_nop 1
 v_permlane32_swap_b32 v185, v186
 v_max3_f32 v185, v185, v186, 0
 v_sub_f32 v217, 0, v185
 v_exp_f32 v217, v217
 v_sub_f32 v128, v128, v185
 v_sub_f32 v16, v16, v185
 v_sub_f32 v129, v129, v185
 v_sub_f32 v17, v17, v185
 v_sub_f32 v130, v130, v185
 v_sub_f32 v18, v18, v185
 v_sub_f32 v131, v131, v185
 v_sub_f32 v19, v19, v185
 v_sub_f32 v132, v132, v185
 v_sub_f32 v20, v20, v185
 v_sub_f32 v133, v133, v185
 v_sub_f32 v21, v21, v185
 v_sub_f32 v134, v134, v185
 v_sub_f32 v22, v22, v185
 v_sub_f32 v135, v135, v185
 v_sub_f32 v23, v23, v185
 v_sub_f32 v136, v136, v185
 v_sub_f32 v24, v24, v185
 v_sub_f32 v137, v137, v185
 v_sub_f32 v25, v25, v185
 v_sub_f32 v138, v138, v185
 v_sub_f32 v26, v26, v185
 v_sub_f32 v139, v139, v185
 v_sub_f32 v27, v27, v185
 v_sub_f32 v140, v140, v185
 v_sub_f32 v28, v28, v185
 v_sub_f32 v141, v141, v185
 v_sub_f32 v29, v29, v185
 v_sub_f32 v142, v142, v185
 v_sub_f32 v30, v30, v185
 v_sub_f32 v143, v143, v185
 v_sub_f32 v31, v31, v185
 v_mul_f32 v219, v217, v219
 v_mul_f32 v48, v217, v48
 v_mul_f32 v49, v217, v49
 v_mul_f32 v50, v217, v50
 v_mul_f32 v51, v217, v51
 v_mul_f32 v52, v217, v52
 v_mul_f32 v53, v217, v53
 v_mul_f32 v54, v217, v54
 v_mul_f32 v55, v217, v55
 v_mul_f32 v56, v217, v56
 v_mul_f32 v57, v217, v57
 v_mul_f32 v58, v217, v58
 v_mul_f32 v59, v217, v59
 v_mul_f32 v60, v217, v60
 v_mul_f32 v61, v217, v61
 v_mul_f32 v62, v217, v62
 v_mul_f32 v63, v217, v63
 v_mul_f32 v64, v217, v64
 v_mul_f32 v65, v217, v65
 v_mul_f32 v66, v217, v66
 v_mul_f32 v67, v217, v67
 v_mul_f32 v68, v217, v68
 v_mul_f32 v69, v217, v69
 v_mul_f32 v70, v217, v70
 v_mul_f32 v71, v217, v71
 v_mul_f32 v72, v217, v72
 v_mul_f32 v73, v217, v73
 v_mul_f32 v74, v217, v74
 v_mul_f32 v75, v217, v75
 v_mul_f32 v76, v217, v76
 v_mul_f32 v77, v217, v77
 v_mul_f32 v78, v217, v78
 v_mul_f32 v79, v217, v79
 v_mul_f32 v80, v217, v80
 v_mul_f32 v81, v217, v81
 v_mul_f32 v82, v217, v82
 v_mul_f32 v83, v217, v83
 v_mul_f32 v84, v217, v84
 v_mul_f32 v85, v217, v85
 v_mul_f32 v86, v217, v86
 v_mul_f32 v87, v217, v87
 v_mul_f32 v88, v217, v88
 v_mul_f32 v89, v217, v89
 v_mul_f32 v90, v217, v90
 v_mul_f32 v91, v217, v91
 v_mul_f32 v92, v217, v92
 v_mul_f32 v93, v217, v93
 v_mul_f32 v94, v217, v94
 v_mul_f32 v95, v217, v95
 v_mul_f32 v96, v217, v96
 v_mul_f32 v97, v217, v97
 v_mul_f32 v98, v217, v98
 v_mul_f32 v99, v217, v99
 v_mul_f32 v100, v217, v100
 v_mul_f32 v101, v217, v101
 v_mul_f32 v102, v217, v102
 v_mul_f32 v103, v217, v103
 v_mul_f32 v104, v217, v104
 v_mul_f32 v105, v217, v105
 v_mul_f32 v106, v217, v106
 v_mul_f32 v107, v217, v107
 v_mul_f32 v108, v217, v108
 v_mul_f32 v109, v217, v109
 v_mul_f32 v110, v217, v110
 v_mul_f32 v111, v217, v111
 v_exp_f32 v112, v16
 v_exp_f32 v113, v17
 v_exp_f32 v114, v18
 v_exp_f32 v115, v19
 v_add_f32 v215, v112, v113
 v_cvt_pk_bf16_f32 v40, v112, v113
 v_exp_f32 v116, v20
 v_exp_f32 v117, v21
 v_add_f32 v215, v215, v114
 v_add_f32 v215, v215, v115
 v_cvt_pk_bf16_f32 v41, v114, v115
 v_exp_f32 v118, v22
 v_exp_f32 v119, v23
 v_add_f32 v215, v215, v116
 v_add_f32 v215, v215, v117
 v_cvt_pk_bf16_f32 v42, v116, v117
 v_exp_f32 v120, v24
 v_exp_f32 v121, v25
 v_add_f32 v215, v215, v118
 v_add_f32 v215, v215, v119
 v_cvt_pk_bf16_f32 v43, v118, v119
 v_exp_f32 v122, v26
 v_exp_f32 v123, v27
 v_add_f32 v215, v215, v120
 v_add_f32 v215, v215, v121
 v_cvt_pk_bf16_f32 v44, v120, v121
 v_exp_f32 v124, v28
 v_exp_f32 v125, v29
 v_add_f32 v215, v215, v122
 v_add_f32 v215, v215, v123
 v_cvt_pk_bf16_f32 v45, v122, v123
 v_exp_f32 v126, v30
 v_exp_f32 v127, v31
 v_add_f32 v215, v215, v124
 v_add_f32 v215, v215, v125
 v_cvt_pk_bf16_f32 v46, v124, v125
 v_add_f32 v215, v215, v126
 v_add_f32 v215, v215, v127
 v_cvt_pk_bf16_f32 v47, v126, v127
 s_nop 1
 s_setpc_b64 s[40:41]
.section .rodata,"a"
.p2align 6
.amdhsa_kernel concat_heads__mha_block_cached__gqa_block_cached__near_ridge_kernel
  .amdhsa_next_free_vgpr 512
  .amdhsa_next_free_sgpr 102
  .amdhsa_accum_offset 256
  .amdhsa_group_segment_fixed_size 0
  .amdhsa_kernarg_size 104
  .amdhsa_user_sgpr_count 2
  .amdhsa_user_sgpr_kernarg_segment_ptr 1
  .amdhsa_system_sgpr_workgroup_id_x 1
  .amdhsa_float_denorm_mode_32 3
.end_amdhsa_kernel
```
